```python
import torch

def _softmax(x, axis=-1):
    return torch.softmax(x, dim=axis)

def _gelu(x):
    return torch.nn.functional.gelu(x, approximate='tanh')

def _silu(x):
    return torch.nn.functional.silu(x)

def _sigmoid(x):
    return torch.sigmoid(x)

def _layernorm(x, axis=-1, eps=1e-05):
    m = x.mean(dim=axis, keepdim=True)
    v = x.var(dim=axis, keepdim=True, unbiased=False)
    return (x - m) / torch.sqrt(v + eps)

def _scatter_add(tgt, idx, src, axis=0):
    return tgt.clone().index_add_(axis, idx, src)

def _segment_sum(src, seg, n):
    out = torch.zeros((n,) + src.shape[1:], dtype=src.dtype)
    return out.index_add_(0, seg, src)

def _pad(x, pw):
    flat = tuple((v for pair in reversed(pw) for v in pair))
    return torch.nn.functional.pad(x, flat)
kernel_name = 'standalone__varlen_attn_packed__ragged'

def setup_inputs():

    _w = lambda a: (lambda t: t.to(torch.bfloat16) if t.is_floating_point() else t)(torch.as_tensor(a))
    cu = torch.tensor([0, 828, 1660, 3299, 3744], dtype=torch.int64)
    T, H, D = (int(cu[-1]), 16, 128)
    return {'q': _w((lambda *s: torch.randn(*s, dtype=torch.bfloat16) * 0.8)(T, H, D)), 'k': _w((lambda *s: torch.randn(*s, dtype=torch.bfloat16) * 0.8)(T, H, D)), 'v': _w((lambda *s: torch.randn(*s, dtype=torch.bfloat16) * 0.05)(T, H, D)), 'cu': _w(cu)}

def reference(q, k, v, cu):
    T, H, D = q.shape
    out = torch.zeros_like(q)
    scale = D ** (-0.5)
    outs = []
    for i in range(len(cu) - 1):
        s, e = (int(cu[i]), int(cu[i + 1]))
        qi, ki, vi = (q[s:e].clone(), k[s:e].clone(), v[s:e].clone())
        p = _softmax(torch.einsum('qhd,khd->hqk', qi, ki) * scale, axis=-1)
        outs.append(torch.einsum('hqk,khd->qhd', p, vi))
    return torch.concatenate(outs, axis=0)
```

```asm
; @launch grid=(256,1,1) block=(256,1,1) lds=163840
.amdgcn_target "amdgcn-amd-amdhsa--gfx950"
.macro QK d,a,b,c
v_mfma_f32_16x16x32_bf16 v[\d:\d+3], a[\a:\a+3], a[\b:\b+3], v[\c:\c+3]
.endm
.macro PV d,a,p
v_mfma_f32_16x16x32_bf16 v[\d:\d+3], a[\a:\a+3], v[\p:\p+3], v[\d:\d+3]
.endm
.macro LM d,p
v_mfma_f32_16x16x32_bf16 a[\d:\d+3], v[84:87], v[\p:\p+3], a[\d:\d+3]
.endm
.macro EX r
v_exp_f32 v\r, v\r
.endm
.macro CV d,s,t
v_cvt_pk_bf16_f32 v\d, v\s, v\t
.endm
.macro KR a,v,o
ds_read_b128 a[\a:\a+3], v\v offset:\o
.endm
.macro VR a,v,o
ds_read_b64_tr_b16 a[\a:\a+1], v\v offset:\o
.endm
.text
.globl standalone__varlen_attn_packed__ragged_kernel
.p2align 8
.type standalone__varlen_attn_packed__ragged_kernel,@function
standalone__varlen_attn_packed__ragged_kernel:
s_cmp_ge_u32 s2, 256
s_cbranch_scc1 END0
s_load_dwordx4 s[4:7], s[0:1], 0
s_load_dwordx2 s[78:79], s[0:1], 16
s_load_dwordx2 s[80:81], s[0:1], 32
v_lshrrev_b32 v40, 6, v0
s_and_b32 s96, s2, 7
v_readfirstlane_b32 s24, v40
s_lshr_b32 s3, s2, 3
s_lshl_b32 s96, s96, 9
s_bitcmp1_b32 s3, 4
s_cbranch_scc1 RT_1
s_bitcmp1_b32 s3, 3
s_cbranch_scc1 RT_2
s_bitcmp1_b32 s3, 2
s_cbranch_scc1 RT_3
s_bitcmp1_b32 s3, 1
s_cbranch_scc1 RT_4
s_bitcmp1_b32 s3, 0
s_cbranch_scc1 RT_5
s_add_u32 s44, s96, 6799360
s_mov_b32 s45, 26
s_mov_b32 s46, 13512704
s_mov_b32 s47, 12
s_mov_b32 s48, 39
s_add_u32 s82, s96, 6799360
s_mov_b32 s31, 0
s_branch ROLE_DONE
RT_5:
s_add_u32 s44, s96, 6799616
s_mov_b32 s45, 26
s_mov_b32 s46, 13512704
s_mov_b32 s47, 12
s_mov_b32 s48, 39
s_add_u32 s82, s96, 6799616
s_mov_b32 s31, 0
s_branch ROLE_DONE
RT_4:
s_bitcmp1_b32 s3, 0
s_cbranch_scc1 RT_6
s_add_u32 s44, s96, 6799360
s_mov_b32 s45, 26
s_mov_b32 s46, 13512704
s_mov_b32 s47, 12
s_mov_b32 s48, 39
s_add_u32 s82, s96, 7585792
s_mov_b32 s31, 0
s_branch ROLE_DONE
RT_6:
s_add_u32 s44, s96, 6799616
s_mov_b32 s45, 26
s_mov_b32 s46, 13512704
s_mov_b32 s47, 12
s_mov_b32 s48, 39
s_add_u32 s82, s96, 7586048
s_mov_b32 s31, 0
s_branch ROLE_DONE
RT_3:
s_bitcmp1_b32 s3, 1
s_cbranch_scc1 RT_7
s_bitcmp1_b32 s3, 0
s_cbranch_scc1 RT_8
s_add_u32 s44, s96, 6799360
s_mov_b32 s45, 26
s_mov_b32 s46, 13512704
s_mov_b32 s47, 12
s_mov_b32 s48, 39
s_add_u32 s82, s96, 8372224
s_mov_b32 s31, 0
s_branch ROLE_DONE
RT_8:
s_add_u32 s44, s96, 6799616
s_mov_b32 s45, 26
s_mov_b32 s46, 13512704
s_mov_b32 s47, 12
s_mov_b32 s48, 39
s_add_u32 s82, s96, 8372480
s_mov_b32 s31, 0
s_branch ROLE_DONE
RT_7:
s_bitcmp1_b32 s3, 0
s_cbranch_scc1 RT_9
s_add_u32 s44, s96, 6799360
s_mov_b32 s45, 26
s_mov_b32 s46, 13512704
s_mov_b32 s47, 12
s_mov_b32 s48, 39
s_add_u32 s82, s96, 9158656
s_mov_b32 s31, 0
s_branch ROLE_DONE
RT_9:
s_add_u32 s44, s96, 6799616
s_mov_b32 s45, 26
s_mov_b32 s46, 13512704
s_mov_b32 s47, 12
s_mov_b32 s48, 39
s_add_u32 s82, s96, 9158912
s_mov_b32 s31, 0
s_branch ROLE_DONE
RT_2:
s_bitcmp1_b32 s3, 2
s_cbranch_scc1 RT_10
s_bitcmp1_b32 s3, 1
s_cbranch_scc1 RT_11
s_bitcmp1_b32 s3, 0
s_cbranch_scc1 RT_12
s_add_u32 s44, s96, 6799360
s_mov_b32 s45, 26
s_mov_b32 s46, 13512704
s_mov_b32 s47, 12
s_mov_b32 s48, 39
s_add_u32 s82, s96, 9945088
s_mov_b32 s31, 0
s_branch ROLE_DONE
RT_12:
s_add_u32 s44, s96, 6799616
s_mov_b32 s45, 26
s_mov_b32 s46, 13512704
s_mov_b32 s47, 12
s_mov_b32 s48, 39
s_add_u32 s82, s96, 9945344
s_mov_b32 s31, 0
s_branch ROLE_DONE
RT_11:
s_bitcmp1_b32 s3, 0
s_cbranch_scc1 RT_13
s_add_u32 s44, s96, 6799360
s_mov_b32 s45, 26
s_mov_b32 s46, 13512704
s_mov_b32 s47, 12
s_mov_b32 s48, 39
s_add_u32 s82, s96, 10731520
s_mov_b32 s31, 0
s_branch ROLE_DONE
RT_13:
s_add_u32 s44, s96, 6799616
s_mov_b32 s45, 26
s_mov_b32 s46, 13512704
s_mov_b32 s47, 12
s_mov_b32 s48, 39
s_add_u32 s82, s96, 10731776
s_mov_b32 s31, 0
s_branch ROLE_DONE
RT_10:
s_bitcmp1_b32 s3, 1
s_cbranch_scc1 RT_14
s_bitcmp1_b32 s3, 0
s_cbranch_scc1 RT_15
s_add_u32 s44, s96, 6799360
s_mov_b32 s45, 26
s_mov_b32 s46, 13512704
s_mov_b32 s47, 12
s_mov_b32 s48, 39
s_add_u32 s82, s96, 11517952
s_mov_b32 s31, 0
s_branch ROLE_DONE
RT_15:
s_add_u32 s44, s96, 6799616
s_mov_b32 s45, 26
s_mov_b32 s46, 13512704
s_mov_b32 s47, 12
s_mov_b32 s48, 39
s_add_u32 s82, s96, 11518208
s_mov_b32 s31, 0
s_branch ROLE_DONE
RT_14:
s_bitcmp1_b32 s3, 0
s_cbranch_scc1 RT_16
s_add_u32 s44, s96, 6799360
s_mov_b32 s45, 26
s_mov_b32 s46, 13512704
s_mov_b32 s47, 10
s_mov_b32 s48, 39
s_add_u32 s82, s96, 12304384
s_mov_b32 s31, 0
s_branch ROLE_DONE
RT_16:
s_add_u32 s44, s96, 6799616
s_mov_b32 s45, 26
s_mov_b32 s46, 13512704
s_mov_b32 s47, 10
s_mov_b32 s48, 39
s_add_u32 s82, s96, 12304640
s_mov_b32 s31, 0
s_branch ROLE_DONE
RT_1:
s_bitcmp1_b32 s3, 3
s_cbranch_scc1 RT_17
s_bitcmp1_b32 s3, 2
s_cbranch_scc1 RT_18
s_bitcmp1_b32 s3, 1
s_cbranch_scc1 RT_19
s_bitcmp1_b32 s3, 0
s_cbranch_scc1 RT_20
s_add_u32 s44, s96, 6799360
s_mov_b32 s45, 26
s_mov_b32 s46, 13512704
s_mov_b32 s47, 10
s_mov_b32 s48, 39
s_add_u32 s82, s96, 12959744
s_mov_b32 s31, 0
s_branch ROLE_DONE
RT_20:
s_add_u32 s44, s96, 6799616
s_mov_b32 s45, 26
s_mov_b32 s46, 13512704
s_mov_b32 s47, 10
s_mov_b32 s48, 39
s_add_u32 s82, s96, 12960000
s_mov_b32 s31, 0
s_branch ROLE_DONE
RT_19:
s_bitcmp1_b32 s3, 0
s_cbranch_scc1 RT_21
s_add_u32 s44, s96, 0
s_mov_b32 s45, 13
s_mov_b32 s46, 3391488
s_mov_b32 s47, 20
s_mov_b32 s48, 60
s_add_u32 s82, s96, 0
s_mov_b32 s31, 0
s_branch ROLE_DONE
RT_21:
s_add_u32 s44, s96, 256
s_mov_b32 s45, 13
s_mov_b32 s46, 3391488
s_mov_b32 s47, 20
s_mov_b32 s48, 60
s_add_u32 s82, s96, 256
s_mov_b32 s31, 0
s_branch ROLE_DONE
RT_18:
s_bitcmp1_b32 s3, 1
s_cbranch_scc1 RT_22
s_bitcmp1_b32 s3, 0
s_cbranch_scc1 RT_23
s_add_u32 s44, s96, 0
s_mov_b32 s45, 13
s_mov_b32 s46, 3391488
s_mov_b32 s47, 16
s_mov_b32 s48, 60
s_add_u32 s82, s96, 1310720
s_mov_b32 s31, 0
s_branch ROLE_DONE
RT_23:
s_add_u32 s44, s96, 256
s_mov_b32 s45, 13
s_mov_b32 s46, 3391488
s_mov_b32 s47, 16
s_mov_b32 s48, 60
s_add_u32 s82, s96, 1310976
s_mov_b32 s31, 0
s_branch ROLE_DONE
RT_22:
s_bitcmp1_b32 s3, 0
s_cbranch_scc1 RT_24
s_add_u32 s44, s96, 0
s_mov_b32 s45, 13
s_mov_b32 s46, 3391488
s_mov_b32 s47, 16
s_mov_b32 s48, 60
s_add_u32 s82, s96, 2359296
s_mov_b32 s31, 0
s_branch ROLE_DONE
RT_24:
s_add_u32 s44, s96, 256
s_mov_b32 s45, 13
s_mov_b32 s46, 3391488
s_mov_b32 s47, 16
s_mov_b32 s48, 60
s_add_u32 s82, s96, 2359552
s_mov_b32 s31, 0
s_branch ROLE_DONE
RT_17:
s_bitcmp1_b32 s3, 2
s_cbranch_scc1 RT_25
s_bitcmp1_b32 s3, 1
s_cbranch_scc1 RT_26
s_bitcmp1_b32 s3, 0
s_cbranch_scc1 RT_27
s_add_u32 s44, s96, 3391488
s_mov_b32 s45, 13
s_mov_b32 s46, 6799360
s_mov_b32 s47, 20
s_mov_b32 s48, 64
s_add_u32 s82, s96, 3391488
s_mov_b32 s31, 0
s_branch ROLE_DONE
RT_27:
s_add_u32 s44, s96, 3391744
s_mov_b32 s45, 13
s_mov_b32 s46, 6799360
s_mov_b32 s47, 20
s_mov_b32 s48, 64
s_add_u32 s82, s96, 3391744
s_mov_b32 s31, 0
s_branch ROLE_DONE
RT_26:
s_bitcmp1_b32 s3, 0
s_cbranch_scc1 RT_28
s_add_u32 s44, s96, 3391488
s_mov_b32 s45, 13
s_mov_b32 s46, 6799360
s_mov_b32 s47, 16
s_mov_b32 s48, 64
s_add_u32 s82, s96, 4702208
s_mov_b32 s31, 0
s_branch ROLE_DONE
RT_28:
s_add_u32 s44, s96, 3391744
s_mov_b32 s45, 13
s_mov_b32 s46, 6799360
s_mov_b32 s47, 16
s_mov_b32 s48, 64
s_add_u32 s82, s96, 4702464
s_mov_b32 s31, 0
s_branch ROLE_DONE
RT_25:
s_bitcmp1_b32 s3, 1
s_cbranch_scc1 RT_29
s_bitcmp1_b32 s3, 0
s_cbranch_scc1 RT_30
s_add_u32 s44, s96, 3391488
s_mov_b32 s45, 13
s_mov_b32 s46, 6799360
s_mov_b32 s47, 16
s_mov_b32 s48, 64
s_add_u32 s82, s96, 5750784
s_mov_b32 s31, 0
s_branch ROLE_DONE
RT_30:
s_add_u32 s44, s96, 3391744
s_mov_b32 s45, 13
s_mov_b32 s46, 6799360
s_mov_b32 s47, 16
s_mov_b32 s48, 64
s_add_u32 s82, s96, 5751040
s_mov_b32 s31, 0
s_branch ROLE_DONE
RT_29:
s_bitcmp1_b32 s3, 0
s_cbranch_scc1 RT_31
s_add_u32 s44, s96, 13512704
s_mov_b32 s45, 7
s_mov_b32 s46, 15335424
s_mov_b32 s47, 16
s_mov_b32 s48, 61
s_add_u32 s82, s96, 13512704
s_mov_b32 s31, 12422
s_branch ROLE_DONE
RT_31:
s_add_u32 s44, s96, 13512960
s_mov_b32 s45, 7
s_mov_b32 s46, 15335424
s_mov_b32 s47, 16
s_mov_b32 s48, 61
s_add_u32 s82, s96, 13512960
s_mov_b32 s31, 12423
s_branch ROLE_DONE
END0:
s_endpgm
ROLE_DONE:
v_and_b32 v40, 63, v0
v_and_b32 v41, 15, v40
v_lshrrev_b32 v42, 4, v40
s_lshl_b32 s35, s24, 16
s_and_b32 s25, s24, 1
s_lshl_b32 s26, s24, 12
s_add_u32 s27, s26, 65536
s_lshr_b32 s83, s47, 2
s_mul_i32 s84, s83, s35
s_add_u32 s84, s84, s82
s_lshl_b32 s85, s83, 2
s_lshr_b32 s86, s24, 1
s_add_u32 s85, s85, s86
s_lshl_b32 s85, s85, 16
s_add_u32 s85, s85, s82
s_add_u32 s49, s84, 0
s_add_u32 s50, s84, 65536
s_add_u32 s51, s84, 131072
s_cmp_eq_u32 s83, 2
s_cselect_b32 s51, s85, s51
s_add_u32 s52, s84, 196608
s_cmp_eq_u32 s83, 3
s_cselect_b32 s52, s85, s52
s_add_u32 s53, s84, 262144
s_add_u32 s30, s35, 49152
s_lshl_b32 s83, s24, 14
s_add_u32 s83, s83, 98304
s_cmp_ge_u32 s24, 2
s_cselect_b32 s30, s83, s30
v_add_u32 v43, 0, v42
v_xor_b32 v44, v41, v43
v_lshlrev_b32 v44, 4, v44
v_lshl_add_u32 v44, v43, 12, v44
v_subrev_u32 v88, 0, v44
v_add_u32 v20, s35, v88
v_add_u32 v43, 4, v42
v_xor_b32 v44, v41, v43
v_lshlrev_b32 v44, 4, v44
v_lshl_add_u32 v44, v43, 12, v44
v_subrev_u32 v89, 1024, v44
v_add_u32 v21, s35, v89
v_add_u32 v43, 8, v42
v_xor_b32 v44, v41, v43
v_lshlrev_b32 v44, 4, v44
v_lshl_add_u32 v44, v43, 12, v44
v_subrev_u32 v90, 2048, v44
v_add_u32 v22, s35, v90
v_add_u32 v43, 12, v42
v_xor_b32 v44, v41, v43
v_lshlrev_b32 v44, 4, v44
v_lshl_add_u32 v44, v43, 12, v44
v_subrev_u32 v91, 3072, v44
v_add_u32 v23, s35, v91
s_mov_b32 s28, s44
s_mov_b32 s14, s46
s_mov_b32 s29, s44
s_mov_b32 s18, s46
s_mov_b32 s10, s46
s_mov_b32 s22, s46
s_mov_b32 s11, 0x00020000
s_mov_b32 s15, 0x00020000
s_mov_b32 s19, 0x00020000
s_mov_b32 s23, 0x00020000
s_waitcnt lgkmcnt(0)
s_mov_b32 s8, s4
s_and_b32 s9, s5, 0xffff
s_mov_b32 s12, s6
s_and_b32 s13, s7, 0xffff
s_mov_b32 s16, s78
s_and_b32 s17, s79, 0xffff
s_mov_b32 s20, s80
s_and_b32 s21, s81, 0xffff
s_add_u32 m0, s26, 0
s_nop 0
buffer_load_dwordx4 v20, s[12:15], s28 offen offset:0 nt lds
buffer_load_dwordx4 v21, s[12:15], s28 offen offset:1024 nt lds
buffer_load_dwordx4 v22, s[12:15], s28 offen offset:2048 nt lds
buffer_load_dwordx4 v23, s[12:15], s28 offen offset:3072 nt lds
s_add_u32 s28, s28, 0x40000
s_cmp_lg_u32 s47, 16
s_cbranch_scc1 NODELAY
s_waitcnt vmcnt(0)
NODELAY:
s_cmp_lt_u32 s47, 9
s_cbranch_scc1 QL_SKIP
s_add_u32 m0, s30, 8192
s_nop 0
buffer_load_dwordx4 v88, s[8:11], s51 offen offset:0 nt lds
buffer_load_dwordx4 v89, s[8:11], s51 offen offset:1024 nt lds
buffer_load_dwordx4 v90, s[8:11], s51 offen offset:2048 nt lds
buffer_load_dwordx4 v91, s[8:11], s51 offen offset:3072 nt lds
s_cmp_lt_u32 s47, 13
s_cbranch_scc1 QL_SKIP
s_add_u32 m0, s30, 12288
s_nop 0
buffer_load_dwordx4 v88, s[8:11], s52 offen offset:0 nt lds
buffer_load_dwordx4 v89, s[8:11], s52 offen offset:1024 nt lds
buffer_load_dwordx4 v90, s[8:11], s52 offen offset:2048 nt lds
buffer_load_dwordx4 v91, s[8:11], s52 offen offset:3072 nt lds
s_cmp_lt_u32 s47, 17
s_cbranch_scc1 QL_SKIP
s_add_u32 m0, s27, 32768
s_nop 0
buffer_load_dwordx4 v88, s[8:11], s53 offen offset:0 nt lds
buffer_load_dwordx4 v89, s[8:11], s53 offen offset:1024 nt lds
buffer_load_dwordx4 v90, s[8:11], s53 offen offset:2048 nt lds
buffer_load_dwordx4 v91, s[8:11], s53 offen offset:3072 nt lds
QL_SKIP:
s_add_u32 m0, s30, 0
s_nop 0
buffer_load_dwordx4 v88, s[8:11], s49 offen offset:0 nt lds
buffer_load_dwordx4 v89, s[8:11], s49 offen offset:1024 nt lds
buffer_load_dwordx4 v90, s[8:11], s49 offen offset:2048 nt lds
buffer_load_dwordx4 v91, s[8:11], s49 offen offset:3072 nt lds
s_add_u32 m0, s30, 4096
s_nop 0
buffer_load_dwordx4 v88, s[8:11], s50 offen offset:0 nt lds
buffer_load_dwordx4 v89, s[8:11], s50 offen offset:1024 nt lds
buffer_load_dwordx4 v90, s[8:11], s50 offen offset:2048 nt lds
buffer_load_dwordx4 v91, s[8:11], s50 offen offset:3072 nt lds
v_add_u32 v43, 0, v42
v_and_b32 v44, 7, v43
v_lshlrev_b32 v44, 1, v44
v_xor_b32 v44, v41, v44
v_lshlrev_b32 v44, 4, v44
v_lshl_add_u32 v44, v43, 12, v44
v_add_u32 v44, s35, v44
v_subrev_u32 v24, 0, v44
v_add_u32 v43, 4, v42
v_and_b32 v44, 7, v43
v_lshlrev_b32 v44, 1, v44
v_xor_b32 v44, v41, v44
v_lshlrev_b32 v44, 4, v44
v_lshl_add_u32 v44, v43, 12, v44
v_add_u32 v44, s35, v44
v_subrev_u32 v25, 1024, v44
v_add_u32 v43, 8, v42
v_and_b32 v44, 7, v43
v_lshlrev_b32 v44, 1, v44
v_xor_b32 v44, v41, v44
v_lshlrev_b32 v44, 4, v44
v_lshl_add_u32 v44, v43, 12, v44
v_add_u32 v44, s35, v44
v_subrev_u32 v26, 2048, v44
v_add_u32 v43, 12, v42
v_and_b32 v44, 7, v43
v_lshlrev_b32 v44, 1, v44
v_xor_b32 v44, v41, v44
v_lshlrev_b32 v44, 4, v44
v_lshl_add_u32 v44, v43, 12, v44
v_add_u32 v44, s35, v44
v_subrev_u32 v27, 3072, v44
s_sub_u32 s72, s2, s2
s_mov_b32 s74, 1040356334
s_mov_b32 s75, 1040356334
s_mov_b32 s76, 1400897536
s_sub_u32 s73, s2, s2
s_add_u32 s31, s31, 0
s_and_b32 s83, s31, 1
s_lshl_b32 s83, s83, 8
s_add_u32 s83, s83, s96
s_bfe_u32 s84, s31, 131073
s_mov_b32 s85, 0
s_mov_b32 s86, 828
s_cmp_eq_u32 s84, 1
s_cselect_b32 s85, 828, s85
s_cselect_b32 s86, 1660, s86
s_cmp_eq_u32 s84, 2
s_cselect_b32 s85, 1660, s85
s_cselect_b32 s86, 3299, s86
s_cmp_eq_u32 s84, 3
s_cselect_b32 s85, 3299, s85
s_cselect_b32 s86, 3744, s86
s_lshl_b32 s54, s85, 12
s_add_u32 s54, s54, s83
s_sub_u32 s87, s86, s85
s_add_u32 s55, s87, 63
s_lshr_b32 s55, s55, 6
s_lshl_b32 s56, s86, 12
s_lshr_b32 s57, s31, 10
s_sub_u32 s88, s55, 1
s_lshl_b32 s88, s88, 6
s_sub_u32 s58, s87, s88
s_cmp_eq_u32 s57, 0
s_cselect_b32 s55, 0, s55
s_cselect_b32 s56, 0, s56
s_bfe_u32 s88, s31, 458755
s_lshl_b32 s88, s88, 16
s_add_u32 s88, s88, s54
s_lshr_b32 s89, s57, 2
s_mul_i32 s90, s89, s35
s_add_u32 s90, s90, s88
s_lshl_b32 s91, s89, 2
s_lshr_b32 s92, s24, 1
s_add_u32 s91, s91, s92
s_lshl_b32 s91, s91, 16
s_add_u32 s91, s91, s88
s_add_u32 s59, s90, 0
s_add_u32 s60, s90, 65536
s_add_u32 s61, s90, 131072
s_cmp_eq_u32 s89, 2
s_cselect_b32 s61, s91, s61
s_add_u32 s62, s90, 196608
s_cmp_eq_u32 s89, 3
s_cselect_b32 s62, s91, s62
s_add_u32 s63, s90, 262144
s_mov_b32 s10, s56
v_mov_b32 v7, 0
s_add_u32 m0, s27, 0
v_mov_b32 v31, 0xff800000
buffer_load_dwordx4 v24, s[16:19], s29 offen offset:0 nt lds
v_lshlrev_b32 v30, 2, v42
v_and_b32 v43, 3, v40
v_lshlrev_b32 v43, 13, v43
v_add_u32 v28, 135424, v43
s_lshl_b32 s40, s24, 13
v_lshlrev_b32 v6, 4, v40
v_add_u32 v6, 131072, v6
v_lshlrev_b32 v5, 2, v40
v_add_u32 v5, 135168, v5
v_mov_b32 v84, 0x3f803f80
v_mov_b32 v85, 0x3f803f80
buffer_load_dwordx4 v25, s[16:19], s29 offen offset:1024 nt lds
v_mov_b32 v86, 0x3f803f80
v_mov_b32 v87, 0x3f803f80
v_lshlrev_b32 v43, 4, v41
v_lshl_add_u32 v29, v42, 12, v43
v_mul_u32_u24 v44, 272, v42
v_add_u32 v3, v44, v43
v_add_u32 v3, 131072, v3
v_mul_u32_u24 v44, 272, v41
v_lshl_add_u32 v4, v42, 3, v44
v_add_u32 v4, 131072, v4
v_lshrrev_b32 v43, 3, v40
buffer_load_dwordx4 v26, s[16:19], s29 offen offset:2048 nt lds
v_and_b32 v44, 7, v40
v_lshlrev_b32 v44, 4, v44
v_lshl_add_u32 v2, v43, 12, v44
v_mul_u32_u24 v43, 272, v43
v_add_u32 v1, v43, v44
v_add_u32 v1, 131072, v1
s_add_u32 s83, s27, 32768
v_add_u32 v43, 0, v42
v_xor_b32 v43, v43, v41
v_lshlrev_b32 v43, 4, v43
v_lshl_add_u32 v8, v41, 8, v43
buffer_load_dwordx4 v27, s[16:19], s29 offen offset:3072 nt lds
v_add_u32 v48, s30, v8
v_add_u32 v52, s83, v8
v_add_u32 v43, 4, v42
v_xor_b32 v43, v43, v41
v_lshlrev_b32 v43, 4, v43
v_lshl_add_u32 v9, v41, 8, v43
v_add_u32 v49, s30, v9
v_add_u32 v53, s83, v9
v_add_u32 v43, 8, v42
v_xor_b32 v43, v43, v41
v_lshlrev_b32 v43, 4, v43
s_add_u32 s29, s29, 0x40000
v_lshl_add_u32 v10, v41, 8, v43
s_add_u32 m0, s26, 16384
v_add_u32 v50, s30, v10
buffer_load_dwordx4 v20, s[12:15], s28 offen offset:0 nt lds
v_add_u32 v54, s83, v10
v_add_u32 v43, 12, v42
v_xor_b32 v43, v43, v41
v_lshlrev_b32 v43, 4, v43
v_lshl_add_u32 v11, v41, 8, v43
v_add_u32 v51, s30, v11
v_add_u32 v55, s83, v11
v_bfe_u32 v43, v40, 2, 2
v_add_u32 v43, v30, v43
v_and_b32 v44, 7, v43
v_lshlrev_b32 v44, 1, v44
buffer_load_dwordx4 v21, s[12:15], s28 offen offset:1024 nt lds
v_lshlrev_b32 v43, 8, v43
v_add_u32 v43, 65536, v43
v_and_b32 v42, 1, v40
v_lshl_add_u32 v43, v42, 3, v43
v_bfe_u32 v42, v40, 1, 1
v_add_u32 v37, 0, v42
v_xor_b32 v37, v37, v44
v_lshl_add_u32 v12, v37, 4, v43
v_add_u32 v37, 2, v42
v_xor_b32 v37, v37, v44
v_lshl_add_u32 v13, v37, 4, v43
buffer_load_dwordx4 v22, s[12:15], s28 offen offset:2048 nt lds
v_add_u32 v37, 4, v42
v_xor_b32 v37, v37, v44
v_lshl_add_u32 v14, v37, 4, v43
v_add_u32 v37, 6, v42
v_xor_b32 v37, v37, v44
v_lshl_add_u32 v15, v37, 4, v43
v_add_u32 v37, 8, v42
v_xor_b32 v37, v37, v44
v_lshl_add_u32 v16, v37, 4, v43
v_add_u32 v37, 10, v42
v_xor_b32 v37, v37, v44
buffer_load_dwordx4 v23, s[12:15], s28 offen offset:3072 nt lds
v_lshl_add_u32 v17, v37, 4, v43
v_add_u32 v37, 12, v42
v_xor_b32 v37, v37, v44
v_lshl_add_u32 v18, v37, 4, v43
v_add_u32 v37, 14, v42
v_xor_b32 v37, v37, v44
v_lshl_add_u32 v19, v37, 4, v43
s_sub_u32 s86, s48, 32
v_cmp_gt_i32 s[78:79], s86, v30
s_sub_u32 s86, s48, 33
v_cmp_gt_i32 s[80:81], s86, v30
s_sub_u32 s86, s48, 34
v_cmp_gt_i32 s[82:83], s86, v30
s_sub_u32 s86, s48, 35
v_cmp_gt_i32 s[84:85], s86, v30
s_nop 1
v_cndmask_b32 v76, v31, v7, s[78:79]
v_cndmask_b32 v77, v31, v7, s[80:81]
v_cndmask_b32 v78, v31, v7, s[82:83]
v_cndmask_b32 v79, v31, v7, s[84:85]
s_sub_u32 s86, s48, 48
v_cmp_gt_i32 s[78:79], s86, v30
s_sub_u32 s86, s48, 49
v_cmp_gt_i32 s[80:81], s86, v30
s_sub_u32 s86, s48, 50
v_cmp_gt_i32 s[82:83], s86, v30
s_sub_u32 s86, s48, 51
v_cmp_gt_i32 s[84:85], s86, v30
s_nop 1
v_cndmask_b32 v80, v31, v7, s[78:79]
v_cndmask_b32 v81, v31, v7, s[80:81]
v_cndmask_b32 v82, v31, v7, s[82:83]
v_cndmask_b32 v83, v31, v7, s[84:85]
s_add_u32 s28, s28, 0x40000
v_accvgpr_write_b32 a176, 0
s_add_u32 m0, s27, 16384
v_accvgpr_write_b32 a177, 0
buffer_load_dwordx4 v24, s[16:19], s29 offen offset:0 nt lds
v_accvgpr_write_b32 a178, 0
v_accvgpr_write_b32 a179, 0
v_accvgpr_write_b32 a180, 0
v_accvgpr_write_b32 a181, 0
v_accvgpr_write_b32 a182, 0
v_accvgpr_write_b32 a183, 0
v_accvgpr_write_b32 a184, 0
v_accvgpr_write_b32 a185, 0
v_accvgpr_write_b32 a186, 0
v_accvgpr_write_b32 a187, 0
v_accvgpr_write_b32 a188, 0
buffer_load_dwordx4 v25, s[16:19], s29 offen offset:1024 nt lds
v_accvgpr_write_b32 a189, 0
v_accvgpr_write_b32 a190, 0
v_accvgpr_write_b32 a191, 0
v_accvgpr_write_b32 a192, 0
v_accvgpr_write_b32 a193, 0
v_accvgpr_write_b32 a194, 0
v_accvgpr_write_b32 a195, 0
v_accvgpr_write_b32 a196, 0
v_accvgpr_write_b32 a197, 0
v_accvgpr_write_b32 a198, 0
v_accvgpr_write_b32 a199, 0
buffer_load_dwordx4 v26, s[16:19], s29 offen offset:2048 nt lds
v_accvgpr_write_b32 a200, 0
v_accvgpr_write_b32 a201, 0
v_accvgpr_write_b32 a202, 0
v_accvgpr_write_b32 a203, 0
v_accvgpr_write_b32 a204, 0
v_accvgpr_write_b32 a205, 0
v_accvgpr_write_b32 a206, 0
v_accvgpr_write_b32 a207, 0
v_accvgpr_write_b32 a208, 0
v_accvgpr_write_b32 a209, 0
v_accvgpr_write_b32 a210, 0
buffer_load_dwordx4 v27, s[16:19], s29 offen offset:3072 nt lds
v_accvgpr_write_b32 a211, 0
v_accvgpr_write_b32 a212, 0
v_accvgpr_write_b32 a213, 0
v_accvgpr_write_b32 a214, 0
v_accvgpr_write_b32 a215, 0
v_accvgpr_write_b32 a216, 0
v_accvgpr_write_b32 a217, 0
v_accvgpr_write_b32 a218, 0
v_accvgpr_write_b32 a219, 0
v_accvgpr_write_b32 a220, 0
v_accvgpr_write_b32 a221, 0
s_add_u32 s29, s29, 0x40000
v_accvgpr_write_b32 a222, 0
v_accvgpr_write_b32 a223, 0
v_accvgpr_write_b32 a224, 0
v_accvgpr_write_b32 a225, 0
v_accvgpr_write_b32 a226, 0
v_accvgpr_write_b32 a227, 0
s_waitcnt vmcnt(12)
ds_read_b128 v[96:99], v48 offset:0
ds_read_b128 v[100:103], v49 offset:0
ds_read_b128 v[104:107], v50 offset:0
ds_read_b128 v[108:111], v51 offset:0
ds_read_b128 v[112:115], v48 offset:4096
ds_read_b128 v[116:119], v49 offset:4096
ds_read_b128 v[120:123], v50 offset:4096
ds_read_b128 v[124:127], v51 offset:4096
ds_read_b128 v[128:131], v48 offset:8192
ds_read_b128 v[132:135], v49 offset:8192
ds_read_b128 v[136:139], v50 offset:8192
ds_read_b128 v[140:143], v51 offset:8192
ds_read_b128 v[144:147], v48 offset:12288
ds_read_b128 v[148:151], v49 offset:12288
ds_read_b128 v[152:155], v50 offset:12288
ds_read_b128 v[156:159], v51 offset:12288
ds_read_b128 v[160:163], v52
ds_read_b128 v[164:167], v53
ds_read_b128 v[168:171], v54
ds_read_b128 v[172:175], v55
s_waitcnt lgkmcnt(0)
v_lshlrev_b32 v32, 16, v96
v_and_b32 v33, 0xffff0000, v96
v_lshlrev_b32 v34, 16, v97
v_and_b32 v35, 0xffff0000, v97
v_lshlrev_b32 v36, 16, v98
v_and_b32 v37, 0xffff0000, v98
v_lshlrev_b32 v38, 16, v99
v_and_b32 v39, 0xffff0000, v99
v_pk_mul_f32 v[32:33], v[32:33], s[74:75]
v_pk_mul_f32 v[34:35], v[34:35], s[74:75]
v_pk_mul_f32 v[36:37], v[36:37], s[74:75]
s_add_u32 m0, s26, 32768
v_pk_mul_f32 v[38:39], v[38:39], s[74:75]
buffer_load_dwordx4 v20, s[12:15], s28 offen offset:0 nt lds
CV 32,32,33
CV 34,34,35
CV 36,36,37
CV 38,38,39
v_accvgpr_write_b32 a0, v32
v_accvgpr_write_b32 a1, v34
v_accvgpr_write_b32 a2, v36
v_accvgpr_write_b32 a3, v38
v_lshlrev_b32 v32, 16, v100
v_and_b32 v33, 0xffff0000, v100
v_lshlrev_b32 v34, 16, v101
buffer_load_dwordx4 v21, s[12:15], s28 offen offset:1024 nt lds
v_and_b32 v35, 0xffff0000, v101
v_lshlrev_b32 v36, 16, v102
v_and_b32 v37, 0xffff0000, v102
v_lshlrev_b32 v38, 16, v103
v_and_b32 v39, 0xffff0000, v103
v_pk_mul_f32 v[32:33], v[32:33], s[74:75]
v_pk_mul_f32 v[34:35], v[34:35], s[74:75]
v_pk_mul_f32 v[36:37], v[36:37], s[74:75]
v_pk_mul_f32 v[38:39], v[38:39], s[74:75]
CV 32,32,33
CV 34,34,35
buffer_load_dwordx4 v22, s[12:15], s28 offen offset:2048 nt lds
CV 36,36,37
CV 38,38,39
v_accvgpr_write_b32 a4, v32
v_accvgpr_write_b32 a5, v34
v_accvgpr_write_b32 a6, v36
v_accvgpr_write_b32 a7, v38
v_lshlrev_b32 v32, 16, v104
v_and_b32 v33, 0xffff0000, v104
v_lshlrev_b32 v34, 16, v105
v_and_b32 v35, 0xffff0000, v105
v_lshlrev_b32 v36, 16, v106
buffer_load_dwordx4 v23, s[12:15], s28 offen offset:3072 nt lds
v_and_b32 v37, 0xffff0000, v106
v_lshlrev_b32 v38, 16, v107
v_and_b32 v39, 0xffff0000, v107
v_pk_mul_f32 v[32:33], v[32:33], s[74:75]
v_pk_mul_f32 v[34:35], v[34:35], s[74:75]
v_pk_mul_f32 v[36:37], v[36:37], s[74:75]
v_pk_mul_f32 v[38:39], v[38:39], s[74:75]
CV 32,32,33
CV 34,34,35
CV 36,36,37
CV 38,38,39
s_add_u32 s28, s28, 0x40000
v_accvgpr_write_b32 a8, v32
v_accvgpr_write_b32 a9, v34
v_accvgpr_write_b32 a10, v36
v_accvgpr_write_b32 a11, v38
v_lshlrev_b32 v32, 16, v108
v_and_b32 v33, 0xffff0000, v108
v_lshlrev_b32 v34, 16, v109
v_and_b32 v35, 0xffff0000, v109
v_lshlrev_b32 v36, 16, v110
v_and_b32 v37, 0xffff0000, v110
v_lshlrev_b32 v38, 16, v111
v_and_b32 v39, 0xffff0000, v111
v_pk_mul_f32 v[32:33], v[32:33], s[74:75]
v_pk_mul_f32 v[34:35], v[34:35], s[74:75]
v_pk_mul_f32 v[36:37], v[36:37], s[74:75]
v_pk_mul_f32 v[38:39], v[38:39], s[74:75]
CV 32,32,33
CV 34,34,35
CV 36,36,37
CV 38,38,39
v_accvgpr_write_b32 a12, v32
v_accvgpr_write_b32 a13, v34
v_accvgpr_write_b32 a14, v36
v_accvgpr_write_b32 a15, v38
v_lshlrev_b32 v32, 16, v112
v_and_b32 v33, 0xffff0000, v112
v_lshlrev_b32 v34, 16, v113
v_and_b32 v35, 0xffff0000, v113
v_lshlrev_b32 v36, 16, v114
v_and_b32 v37, 0xffff0000, v114
v_lshlrev_b32 v38, 16, v115
v_and_b32 v39, 0xffff0000, v115
v_pk_mul_f32 v[32:33], v[32:33], s[74:75]
v_pk_mul_f32 v[34:35], v[34:35], s[74:75]
v_pk_mul_f32 v[36:37], v[36:37], s[74:75]
v_pk_mul_f32 v[38:39], v[38:39], s[74:75]
CV 32,32,33
CV 34,34,35
CV 36,36,37
CV 38,38,39
v_accvgpr_write_b32 a16, v32
v_accvgpr_write_b32 a17, v34
v_accvgpr_write_b32 a18, v36
v_accvgpr_write_b32 a19, v38
v_lshlrev_b32 v32, 16, v116
v_and_b32 v33, 0xffff0000, v116
v_lshlrev_b32 v34, 16, v117
v_and_b32 v35, 0xffff0000, v117
v_lshlrev_b32 v36, 16, v118
v_and_b32 v37, 0xffff0000, v118
v_lshlrev_b32 v38, 16, v119
v_and_b32 v39, 0xffff0000, v119
v_pk_mul_f32 v[32:33], v[32:33], s[74:75]
v_pk_mul_f32 v[34:35], v[34:35], s[74:75]
v_pk_mul_f32 v[36:37], v[36:37], s[74:75]
v_pk_mul_f32 v[38:39], v[38:39], s[74:75]
CV 32,32,33
CV 34,34,35
CV 36,36,37
CV 38,38,39
v_accvgpr_write_b32 a20, v32
v_accvgpr_write_b32 a21, v34
v_accvgpr_write_b32 a22, v36
v_accvgpr_write_b32 a23, v38
v_lshlrev_b32 v32, 16, v120
v_and_b32 v33, 0xffff0000, v120
v_lshlrev_b32 v34, 16, v121
v_and_b32 v35, 0xffff0000, v121
v_lshlrev_b32 v36, 16, v122
v_and_b32 v37, 0xffff0000, v122
v_lshlrev_b32 v38, 16, v123
v_and_b32 v39, 0xffff0000, v123
v_pk_mul_f32 v[32:33], v[32:33], s[74:75]
v_pk_mul_f32 v[34:35], v[34:35], s[74:75]
v_pk_mul_f32 v[36:37], v[36:37], s[74:75]
v_pk_mul_f32 v[38:39], v[38:39], s[74:75]
CV 32,32,33
CV 34,34,35
CV 36,36,37
CV 38,38,39
v_accvgpr_write_b32 a24, v32
v_accvgpr_write_b32 a25, v34
v_accvgpr_write_b32 a26, v36
v_accvgpr_write_b32 a27, v38
v_lshlrev_b32 v32, 16, v124
v_and_b32 v33, 0xffff0000, v124
v_lshlrev_b32 v34, 16, v125
v_and_b32 v35, 0xffff0000, v125
v_lshlrev_b32 v36, 16, v126
v_and_b32 v37, 0xffff0000, v126
v_lshlrev_b32 v38, 16, v127
v_and_b32 v39, 0xffff0000, v127
v_pk_mul_f32 v[32:33], v[32:33], s[74:75]
v_pk_mul_f32 v[34:35], v[34:35], s[74:75]
v_pk_mul_f32 v[36:37], v[36:37], s[74:75]
v_pk_mul_f32 v[38:39], v[38:39], s[74:75]
CV 32,32,33
CV 34,34,35
CV 36,36,37
CV 38,38,39
v_accvgpr_write_b32 a28, v32
v_accvgpr_write_b32 a29, v34
v_accvgpr_write_b32 a30, v36
v_accvgpr_write_b32 a31, v38
s_cmp_lt_u32 s47, 9
s_cbranch_scc1 QC_DONE
v_lshlrev_b32 v32, 16, v128
v_and_b32 v33, 0xffff0000, v128
v_lshlrev_b32 v34, 16, v129
v_and_b32 v35, 0xffff0000, v129
v_lshlrev_b32 v36, 16, v130
v_and_b32 v37, 0xffff0000, v130
v_lshlrev_b32 v38, 16, v131
v_and_b32 v39, 0xffff0000, v131
v_pk_mul_f32 v[32:33], v[32:33], s[74:75]
v_pk_mul_f32 v[34:35], v[34:35], s[74:75]
v_pk_mul_f32 v[36:37], v[36:37], s[74:75]
v_pk_mul_f32 v[38:39], v[38:39], s[74:75]
CV 32,32,33
CV 34,34,35
CV 36,36,37
CV 38,38,39
v_accvgpr_write_b32 a32, v32
v_accvgpr_write_b32 a33, v34
v_accvgpr_write_b32 a34, v36
v_accvgpr_write_b32 a35, v38
v_lshlrev_b32 v32, 16, v132
v_and_b32 v33, 0xffff0000, v132
v_lshlrev_b32 v34, 16, v133
v_and_b32 v35, 0xffff0000, v133
v_lshlrev_b32 v36, 16, v134
v_and_b32 v37, 0xffff0000, v134
v_lshlrev_b32 v38, 16, v135
v_and_b32 v39, 0xffff0000, v135
v_pk_mul_f32 v[32:33], v[32:33], s[74:75]
v_pk_mul_f32 v[34:35], v[34:35], s[74:75]
v_pk_mul_f32 v[36:37], v[36:37], s[74:75]
v_pk_mul_f32 v[38:39], v[38:39], s[74:75]
CV 32,32,33
CV 34,34,35
CV 36,36,37
CV 38,38,39
v_accvgpr_write_b32 a36, v32
v_accvgpr_write_b32 a37, v34
v_accvgpr_write_b32 a38, v36
v_accvgpr_write_b32 a39, v38
v_lshlrev_b32 v32, 16, v136
v_and_b32 v33, 0xffff0000, v136
v_lshlrev_b32 v34, 16, v137
v_and_b32 v35, 0xffff0000, v137
v_lshlrev_b32 v36, 16, v138
v_and_b32 v37, 0xffff0000, v138
v_lshlrev_b32 v38, 16, v139
v_and_b32 v39, 0xffff0000, v139
v_pk_mul_f32 v[32:33], v[32:33], s[74:75]
v_pk_mul_f32 v[34:35], v[34:35], s[74:75]
v_pk_mul_f32 v[36:37], v[36:37], s[74:75]
v_pk_mul_f32 v[38:39], v[38:39], s[74:75]
CV 32,32,33
CV 34,34,35
CV 36,36,37
CV 38,38,39
v_accvgpr_write_b32 a40, v32
v_accvgpr_write_b32 a41, v34
v_accvgpr_write_b32 a42, v36
v_accvgpr_write_b32 a43, v38
v_lshlrev_b32 v32, 16, v140
v_and_b32 v33, 0xffff0000, v140
v_lshlrev_b32 v34, 16, v141
v_and_b32 v35, 0xffff0000, v141
v_lshlrev_b32 v36, 16, v142
v_and_b32 v37, 0xffff0000, v142
v_lshlrev_b32 v38, 16, v143
v_and_b32 v39, 0xffff0000, v143
v_pk_mul_f32 v[32:33], v[32:33], s[74:75]
v_pk_mul_f32 v[34:35], v[34:35], s[74:75]
v_pk_mul_f32 v[36:37], v[36:37], s[74:75]
v_pk_mul_f32 v[38:39], v[38:39], s[74:75]
CV 32,32,33
CV 34,34,35
CV 36,36,37
CV 38,38,39
v_accvgpr_write_b32 a44, v32
v_accvgpr_write_b32 a45, v34
v_accvgpr_write_b32 a46, v36
v_accvgpr_write_b32 a47, v38
s_cmp_lt_u32 s47, 13
s_cbranch_scc1 QC_DONE
v_lshlrev_b32 v32, 16, v144
v_and_b32 v33, 0xffff0000, v144
v_lshlrev_b32 v34, 16, v145
v_and_b32 v35, 0xffff0000, v145
v_lshlrev_b32 v36, 16, v146
v_and_b32 v37, 0xffff0000, v146
v_lshlrev_b32 v38, 16, v147
v_and_b32 v39, 0xffff0000, v147
v_pk_mul_f32 v[32:33], v[32:33], s[74:75]
v_pk_mul_f32 v[34:35], v[34:35], s[74:75]
v_pk_mul_f32 v[36:37], v[36:37], s[74:75]
v_pk_mul_f32 v[38:39], v[38:39], s[74:75]
CV 32,32,33
CV 34,34,35
CV 36,36,37
CV 38,38,39
v_accvgpr_write_b32 a48, v32
v_accvgpr_write_b32 a49, v34
v_accvgpr_write_b32 a50, v36
v_accvgpr_write_b32 a51, v38
v_lshlrev_b32 v32, 16, v148
v_and_b32 v33, 0xffff0000, v148
v_lshlrev_b32 v34, 16, v149
v_and_b32 v35, 0xffff0000, v149
v_lshlrev_b32 v36, 16, v150
v_and_b32 v37, 0xffff0000, v150
v_lshlrev_b32 v38, 16, v151
v_and_b32 v39, 0xffff0000, v151
v_pk_mul_f32 v[32:33], v[32:33], s[74:75]
v_pk_mul_f32 v[34:35], v[34:35], s[74:75]
v_pk_mul_f32 v[36:37], v[36:37], s[74:75]
v_pk_mul_f32 v[38:39], v[38:39], s[74:75]
CV 32,32,33
CV 34,34,35
CV 36,36,37
CV 38,38,39
v_accvgpr_write_b32 a52, v32
v_accvgpr_write_b32 a53, v34
v_accvgpr_write_b32 a54, v36
v_accvgpr_write_b32 a55, v38
v_lshlrev_b32 v32, 16, v152
v_and_b32 v33, 0xffff0000, v152
v_lshlrev_b32 v34, 16, v153
v_and_b32 v35, 0xffff0000, v153
v_lshlrev_b32 v36, 16, v154
v_and_b32 v37, 0xffff0000, v154
v_lshlrev_b32 v38, 16, v155
v_and_b32 v39, 0xffff0000, v155
v_pk_mul_f32 v[32:33], v[32:33], s[74:75]
v_pk_mul_f32 v[34:35], v[34:35], s[74:75]
v_pk_mul_f32 v[36:37], v[36:37], s[74:75]
v_pk_mul_f32 v[38:39], v[38:39], s[74:75]
CV 32,32,33
CV 34,34,35
CV 36,36,37
CV 38,38,39
v_accvgpr_write_b32 a56, v32
v_accvgpr_write_b32 a57, v34
v_accvgpr_write_b32 a58, v36
v_accvgpr_write_b32 a59, v38
v_lshlrev_b32 v32, 16, v156
v_and_b32 v33, 0xffff0000, v156
v_lshlrev_b32 v34, 16, v157
v_and_b32 v35, 0xffff0000, v157
v_lshlrev_b32 v36, 16, v158
v_and_b32 v37, 0xffff0000, v158
v_lshlrev_b32 v38, 16, v159
v_and_b32 v39, 0xffff0000, v159
v_pk_mul_f32 v[32:33], v[32:33], s[74:75]
v_pk_mul_f32 v[34:35], v[34:35], s[74:75]
v_pk_mul_f32 v[36:37], v[36:37], s[74:75]
v_pk_mul_f32 v[38:39], v[38:39], s[74:75]
CV 32,32,33
CV 34,34,35
CV 36,36,37
CV 38,38,39
v_accvgpr_write_b32 a60, v32
v_accvgpr_write_b32 a61, v34
v_accvgpr_write_b32 a62, v36
v_accvgpr_write_b32 a63, v38
s_cmp_lt_u32 s47, 17
s_cbranch_scc1 QC_DONE
v_lshlrev_b32 v32, 16, v160
v_and_b32 v33, 0xffff0000, v160
v_lshlrev_b32 v34, 16, v161
v_and_b32 v35, 0xffff0000, v161
v_lshlrev_b32 v36, 16, v162
v_and_b32 v37, 0xffff0000, v162
v_lshlrev_b32 v38, 16, v163
v_and_b32 v39, 0xffff0000, v163
v_pk_mul_f32 v[32:33], v[32:33], s[74:75]
v_pk_mul_f32 v[34:35], v[34:35], s[74:75]
v_pk_mul_f32 v[36:37], v[36:37], s[74:75]
v_pk_mul_f32 v[38:39], v[38:39], s[74:75]
CV 32,32,33
CV 34,34,35
CV 36,36,37
CV 38,38,39
v_accvgpr_write_b32 a64, v32
v_accvgpr_write_b32 a65, v34
v_accvgpr_write_b32 a66, v36
v_accvgpr_write_b32 a67, v38
v_lshlrev_b32 v32, 16, v164
v_and_b32 v33, 0xffff0000, v164
v_lshlrev_b32 v34, 16, v165
v_and_b32 v35, 0xffff0000, v165
v_lshlrev_b32 v36, 16, v166
v_and_b32 v37, 0xffff0000, v166
v_lshlrev_b32 v38, 16, v167
v_and_b32 v39, 0xffff0000, v167
v_pk_mul_f32 v[32:33], v[32:33], s[74:75]
v_pk_mul_f32 v[34:35], v[34:35], s[74:75]
v_pk_mul_f32 v[36:37], v[36:37], s[74:75]
v_pk_mul_f32 v[38:39], v[38:39], s[74:75]
CV 32,32,33
CV 34,34,35
CV 36,36,37
CV 38,38,39
v_accvgpr_write_b32 a68, v32
v_accvgpr_write_b32 a69, v34
v_accvgpr_write_b32 a70, v36
v_accvgpr_write_b32 a71, v38
v_lshlrev_b32 v32, 16, v168
v_and_b32 v33, 0xffff0000, v168
v_lshlrev_b32 v34, 16, v169
v_and_b32 v35, 0xffff0000, v169
v_lshlrev_b32 v36, 16, v170
v_and_b32 v37, 0xffff0000, v170
v_lshlrev_b32 v38, 16, v171
v_and_b32 v39, 0xffff0000, v171
v_pk_mul_f32 v[32:33], v[32:33], s[74:75]
v_pk_mul_f32 v[34:35], v[34:35], s[74:75]
v_pk_mul_f32 v[36:37], v[36:37], s[74:75]
v_pk_mul_f32 v[38:39], v[38:39], s[74:75]
CV 32,32,33
CV 34,34,35
CV 36,36,37
CV 38,38,39
v_accvgpr_write_b32 a72, v32
v_accvgpr_write_b32 a73, v34
v_accvgpr_write_b32 a74, v36
v_accvgpr_write_b32 a75, v38
v_lshlrev_b32 v32, 16, v172
v_and_b32 v33, 0xffff0000, v172
v_lshlrev_b32 v34, 16, v173
v_and_b32 v35, 0xffff0000, v173
v_lshlrev_b32 v36, 16, v174
v_and_b32 v37, 0xffff0000, v174
v_lshlrev_b32 v38, 16, v175
v_and_b32 v39, 0xffff0000, v175
v_pk_mul_f32 v[32:33], v[32:33], s[74:75]
v_pk_mul_f32 v[34:35], v[34:35], s[74:75]
v_pk_mul_f32 v[36:37], v[36:37], s[74:75]
v_pk_mul_f32 v[38:39], v[38:39], s[74:75]
CV 32,32,33
CV 34,34,35
CV 36,36,37
CV 38,38,39
v_accvgpr_write_b32 a76, v32
v_accvgpr_write_b32 a77, v34
v_accvgpr_write_b32 a78, v36
v_accvgpr_write_b32 a79, v38
QC_DONE:
s_waitcnt vmcnt(12)
s_barrier
KR 80,8,0
KR 84,9,0
KR 88,10,0
KR 92,11,0
KR 96,8,4096
KR 100,9,4096
KR 104,10,4096
KR 108,11,4096
s_add_u32 m0, s27, 32768
s_nop 0
buffer_load_dwordx4 v24, s[16:19], s29 offen offset:0 nt lds
buffer_load_dwordx4 v25, s[16:19], s29 offen offset:1024 nt lds
buffer_load_dwordx4 v26, s[16:19], s29 offen offset:2048 nt lds
buffer_load_dwordx4 v27, s[16:19], s29 offen offset:3072 nt lds
s_add_u32 s29, s29, 0x40000
DISPATCH0:
s_cmp_eq_u32 s47, 10
s_cbranch_scc0 DS_32
s_cmp_eq_u32 s25, 0
s_cbranch_scc1 PRO_V210
s_branch PRO_V211
DS_32:
s_cmp_eq_u32 s47, 12
s_cbranch_scc1 PRO_V300
s_cmp_eq_u32 s47, 16
s_cbranch_scc1 PRO_V400
s_cmp_eq_u32 s47, 20
s_cbranch_scc1 PRO_V500
s_endpgm
PRO_V300:
s_cmp_lg_u32 s73, 0
s_cbranch_scc1 PRO_V300_skipmax
s_waitcnt lgkmcnt(0)
v_mfma_f32_16x16x32_bf16 v[96:99], a[80:83], a[0:3], 0
v_mov_b64 v[160:161], 0
QK 96,84,4,96
v_mov_b64 v[162:163], 0
QK 96,88,8,96
v_mov_b64 v[164:165], 0
QK 96,92,12,96
v_mov_b64 v[166:167], 0
v_mfma_f32_16x16x32_bf16 v[100:103], a[96:99], a[0:3], 0
v_mov_b64 v[168:169], 0
QK 100,100,4,100
v_mov_b64 v[170:171], 0
QK 100,104,8,100
v_mov_b64 v[172:173], 0
QK 100,108,12,100
v_mov_b64 v[174:175], 0
v_mfma_f32_16x16x32_bf16 v[104:107], a[80:83], a[16:19], 0
v_mov_b64 v[176:177], 0
QK 104,84,20,104
v_mov_b64 v[178:179], 0
QK 104,88,24,104
v_mov_b64 v[180:181], 0
QK 104,92,28,104
v_mov_b64 v[182:183], 0
v_mfma_f32_16x16x32_bf16 v[108:111], a[96:99], a[16:19], 0
v_mov_b64 v[184:185], 0
QK 108,100,20,108
v_mov_b64 v[186:187], 0
QK 108,104,24,108
v_mov_b64 v[188:189], 0
QK 108,108,28,108
v_mov_b64 v[190:191], 0
v_mfma_f32_16x16x32_bf16 v[112:115], a[80:83], a[32:35], 0
QK 112,84,36,112
QK 112,88,40,112
QK 112,92,44,112
v_mfma_f32_16x16x32_bf16 v[116:119], a[96:99], a[32:35], 0
QK 116,100,36,116
QK 116,104,40,116
QK 116,108,44,116
s_nop 8
v_max3_f32 v32, v96, v97, v98
v_max3_f32 v33, v104, v105, v106
v_max3_f32 v34, v112, v113, v114
v_max3_f32 v32, v32, v99, v100
v_max3_f32 v33, v33, v107, v108
v_max3_f32 v34, v34, v115, v116
v_max3_f32 v32, v32, v101, v102
v_max3_f32 v33, v33, v109, v110
v_max3_f32 v34, v34, v117, v118
v_max_f32 v32, v32, v103
v_max_f32 v33, v33, v111
v_max_f32 v34, v34, v119
v_mov_b32 v40, v32
v_mov_b32 v41, v33
v_mov_b32 v42, v34
s_nop 1
v_permlane16_swap_b32 v32, v40
v_permlane16_swap_b32 v33, v41
v_permlane16_swap_b32 v34, v42
s_nop 1
v_max_f32 v32, v32, v40
v_max_f32 v33, v33, v41
v_max_f32 v34, v34, v42
v_mov_b32 v40, v32
v_mov_b32 v41, v33
v_mov_b32 v42, v34
s_nop 1
v_permlane32_swap_b32 v32, v40
v_permlane32_swap_b32 v33, v41
v_permlane32_swap_b32 v34, v42
s_nop 1
v_max_f32 v32, v32, v40
v_max_f32 v33, v33, v41
v_max_f32 v34, v34, v42
v_sub_f32 v56, 0, v32
v_sub_f32 v57, 0, v32
v_sub_f32 v58, 0, v32
v_sub_f32 v59, 0, v32
v_sub_f32 v60, 0, v33
v_sub_f32 v61, 0, v33
v_sub_f32 v62, 0, v33
v_sub_f32 v63, 0, v33
v_sub_f32 v64, 0, v34
v_sub_f32 v65, 0, v34
v_sub_f32 v66, 0, v34
v_sub_f32 v67, 0, v34
s_branch PRO_V300_go
PRO_V300_skipmax:
v_mov_b64 v[160:161], 0
v_mov_b64 v[162:163], 0
v_mov_b64 v[164:165], 0
v_mov_b64 v[166:167], 0
v_mov_b64 v[168:169], 0
v_mov_b64 v[170:171], 0
v_mov_b64 v[172:173], 0
v_mov_b64 v[174:175], 0
v_mov_b64 v[176:177], 0
v_mov_b64 v[178:179], 0
v_mov_b64 v[180:181], 0
v_mov_b64 v[182:183], 0
v_mov_b64 v[184:185], 0
v_mov_b64 v[186:187], 0
v_mov_b64 v[188:189], 0
v_mov_b64 v[190:191], 0
s_waitcnt lgkmcnt(0)
PRO_V300_go:
v_mov_b64 v[96:97], 0
v_mov_b64 v[98:99], 0
v_mov_b64 v[100:101], 0
v_mov_b64 v[102:103], 0
v_mov_b64 v[104:105], 0
v_mov_b64 v[106:107], 0
v_mov_b64 v[108:109], 0
v_mov_b64 v[110:111], 0
v_mov_b64 v[112:113], 0
v_mov_b64 v[114:115], 0
v_mov_b64 v[116:117], 0
v_mov_b64 v[118:119], 0
v_mov_b64 v[120:121], 0
v_mov_b64 v[122:123], 0
v_mov_b64 v[124:125], 0
v_mov_b64 v[126:127], 0
v_mov_b64 v[128:129], 0
v_mov_b64 v[130:131], 0
v_mov_b64 v[132:133], 0
v_mov_b64 v[134:135], 0
v_mov_b64 v[136:137], 0
v_mov_b64 v[138:139], 0
v_mov_b64 v[140:141], 0
v_mov_b64 v[142:143], 0
v_mov_b64 v[144:145], 0
v_mov_b64 v[146:147], 0
v_mov_b64 v[148:149], 0
v_mov_b64 v[150:151], 0
v_mov_b64 v[152:153], 0
v_mov_b64 v[154:155], 0
v_mov_b64 v[156:157], 0
v_mov_b64 v[158:159], 0
v_mov_b32 v32, v31
v_mov_b32 v33, v31
v_mov_b32 v34, v31
v_mov_b32 v35, v31
v_mov_b32 v36, v31
v_mov_b32 v37, v31
v_mov_b32 v38, v31
v_mov_b32 v39, v31
v_mov_b32 v40, v31
v_mov_b32 v41, v31
v_mov_b32 v42, v31
v_mov_b32 v43, v31
v_mov_b32 v44, v31
v_mov_b32 v45, v31
v_mov_b32 v46, v31
v_mov_b32 v47, v31
v_mov_b64 v[48:49], 0
v_mov_b64 v[50:51], 0
v_mov_b64 v[52:53], 0
v_mov_b64 v[54:55], 0
s_sub_u32 s71, 3, s45
s_mov_b32 s77, 0
s_sub_u32 s37, s2, s2
s_cmp_eq_u32 s57, 0
s_cselect_b32 s36, 1, -3
s_cmp_eq_u32 s72, 1
s_cbranch_scc1 BODY_V300_1
s_cmp_eq_u32 s72, 2
s_cbranch_scc1 BODY_V300_2
s_cmp_eq_u32 s72, 3
s_cbranch_scc1 BODY_V300_3
BODY_V300_0:
s_waitcnt lgkmcnt(0)
QK 32,80,0,56
EX 40
QK 32,84,4,32
VR 144,12,0
VR 146,12,4096
QK 32,88,8,32
EX 41
QK 32,92,12,32
VR 148,13,0
CV 52,40,41
QK 36,96,0,56
EX 42
QK 36,100,4,36
VR 150,13,4096
VR 152,14,0
QK 36,104,8,36
EX 43
QK 36,108,12,36
VR 154,14,4096
CV 53,42,43
PV 128,176,48
EX 44
PV 132,180,48
VR 156,15,0
VR 158,15,4096
PV 136,184,48
EX 45
PV 140,188,48
VR 160,16,0
CV 54,44,45
PV 144,192,48
EX 46
PV 148,196,48
VR 162,16,4096
KR 112,8,8192
PV 152,200,48
EX 47
PV 156,204,48
KR 116,9,8192
CV 55,46,47
LM 212,48
VR 164,17,0
VR 166,17,4096
QK 40,80,16,60
EX 32
QK 40,84,20,40
KR 120,10,8192
KR 124,11,8192
QK 40,88,24,40
EX 33
QK 40,92,28,40
VR 168,18,0
CV 48,32,33
QK 44,96,16,60
EX 34
QK 44,100,20,44
VR 170,18,4096
s_add_u32 m0, s26, 49152
QK 44,104,24,44
EX 35
QK 44,108,28,44
KR 128,8,12288
CV 49,34,35
PV 160,176,52
EX 36
PV 164,180,52
KR 132,9,12288
VR 172,19,0
PV 168,184,52
EX 37
PV 172,188,52
VR 174,19,4096
CV 50,36,37
PV 176,192,52
EX 38
PV 180,196,52
KR 136,10,12288
KR 140,11,12288
PV 184,200,52
EX 39
PV 188,204,52
CV 51,38,39
LM 216,52
buffer_load_dwordx4 v20, s[12:15], s28 offen offset:0 nt lds
QK 32,80,32,64
EX 40
QK 32,84,36,32
buffer_load_dwordx4 v21, s[12:15], s28 offen offset:1024 nt lds
QK 32,88,40,32
EX 41
QK 32,92,44,32
buffer_load_dwordx4 v22, s[12:15], s28 offen offset:2048 nt lds
QK 36,96,32,64
EX 42
QK 36,100,36,36
buffer_load_dwordx4 v23, s[12:15], s28 offen offset:3072 nt lds
QK 36,104,40,36
EX 43
QK 36,108,44,36
CV 52,40,41
CV 53,42,43
s_waitcnt lgkmcnt(2)
PV 96,144,48
EX 44
PV 100,148,48
s_add_u32 s28, s28, 0x40000
VR 176,12,8192
PV 104,152,48
EX 45
PV 108,156,48
VR 178,12,12288
CV 54,44,45
PV 112,160,48
EX 46
PV 116,164,48
VR 180,13,8192
VR 182,13,12288
PV 120,168,48
EX 47
PV 124,172,48
VR 184,14,8192
CV 55,46,47
LM 208,48
VR 186,14,12288
VR 188,15,8192
s_waitcnt vmcnt(12) lgkmcnt(7)
s_barrier
QK 40,112,0,56
EX 32
QK 40,116,4,40
VR 190,15,12288
VR 192,16,8192
QK 40,120,8,40
EX 33
QK 40,124,12,40
VR 194,16,12288
CV 48,32,33
QK 44,128,0,56
EX 34
QK 44,132,4,44
KR 80,8,16384
KR 84,9,16384
QK 44,136,8,44
EX 35
QK 44,140,12,44
VR 196,17,8192
CV 49,34,35
PV 128,144,52
EX 36
PV 132,148,52
VR 198,17,12288
KR 88,10,16384
PV 136,152,52
EX 37
PV 140,156,52
KR 92,11,16384
CV 50,36,37
PV 144,160,52
EX 38
PV 148,164,52
VR 200,18,8192
VR 202,18,12288
PV 152,168,52
EX 39
PV 156,172,52
s_add_u32 m0, s27, 49152
CV 51,38,39
LM 212,52
KR 96,8,20480
KR 100,9,20480
QK 32,112,16,60
EX 40
QK 32,116,20,32
VR 204,19,8192
VR 206,19,12288
QK 32,120,24,32
EX 41
QK 32,124,28,32
KR 104,10,20480
CV 52,40,41
QK 36,128,16,60
EX 42
QK 36,132,20,36
KR 108,11,20480
QK 36,136,24,36
EX 43
QK 36,140,28,36
CV 53,42,43
PV 160,144,48
EX 44
PV 164,148,48
buffer_load_dwordx4 v24, s[16:19], s29 offen offset:0 nt lds
PV 168,152,48
EX 45
PV 172,156,48
CV 54,44,45
PV 176,160,48
EX 46
PV 180,164,48
buffer_load_dwordx4 v25, s[16:19], s29 offen offset:1024 nt lds
PV 184,168,48
EX 47
PV 188,172,48
CV 55,46,47
LM 216,48
buffer_load_dwordx4 v26, s[16:19], s29 offen offset:2048 nt lds
QK 40,112,32,64
EX 32
QK 40,116,36,40
buffer_load_dwordx4 v27, s[16:19], s29 offen offset:3072 nt lds
QK 40,120,40,40
EX 33
QK 40,124,44,40
s_add_u32 s29, s29, 0x40000
CV 48,32,33
QK 44,128,32,64
EX 34
QK 44,132,36,44
QK 44,136,40,44
EX 35
QK 44,140,44,44
CV 49,34,35
s_waitcnt lgkmcnt(2)
PV 96,176,52
EX 36
PV 100,180,52
PV 104,184,52
EX 37
PV 108,188,52
CV 50,36,37
PV 112,192,52
EX 38
PV 116,196,52
PV 120,200,52
EX 39
PV 124,204,52
CV 51,38,39
LM 208,52
s_add_u32 s71, s71, 1
s_cbranch_scc1 SPEC_V300_0
BODY_V300_1:
s_waitcnt lgkmcnt(0)
QK 32,80,0,56
EX 40
QK 32,84,4,32
VR 144,12,16384
VR 146,12,20480
QK 32,88,8,32
EX 41
QK 32,92,12,32
VR 148,13,16384
CV 52,40,41
QK 36,96,0,56
EX 42
QK 36,100,4,36
VR 150,13,20480
VR 152,14,16384
QK 36,104,8,36
EX 43
QK 36,108,12,36
VR 154,14,20480
CV 53,42,43
PV 128,176,48
EX 44
PV 132,180,48
VR 156,15,16384
VR 158,15,20480
PV 136,184,48
EX 45
PV 140,188,48
VR 160,16,16384
CV 54,44,45
PV 144,192,48
EX 46
PV 148,196,48
VR 162,16,20480
KR 112,8,24576
PV 152,200,48
EX 47
PV 156,204,48
KR 116,9,24576
CV 55,46,47
LM 212,48
VR 164,17,16384
VR 166,17,20480
QK 40,80,16,60
EX 32
QK 40,84,20,40
KR 120,10,24576
KR 124,11,24576
QK 40,88,24,40
EX 33
QK 40,92,28,40
VR 168,18,16384
CV 48,32,33
QK 44,96,16,60
EX 34
QK 44,100,20,44
VR 170,18,20480
s_add_u32 m0, s26, 0
QK 44,104,24,44
EX 35
QK 44,108,28,44
KR 128,8,28672
CV 49,34,35
PV 160,176,52
EX 36
PV 164,180,52
KR 132,9,28672
VR 172,19,16384
PV 168,184,52
EX 37
PV 172,188,52
VR 174,19,20480
CV 50,36,37
PV 176,192,52
EX 38
PV 180,196,52
KR 136,10,28672
KR 140,11,28672
PV 184,200,52
EX 39
PV 188,204,52
CV 51,38,39
LM 216,52
buffer_load_dwordx4 v20, s[12:15], s28 offen offset:0 nt lds
QK 32,80,32,64
EX 40
QK 32,84,36,32
buffer_load_dwordx4 v21, s[12:15], s28 offen offset:1024 nt lds
QK 32,88,40,32
EX 41
QK 32,92,44,32
buffer_load_dwordx4 v22, s[12:15], s28 offen offset:2048 nt lds
QK 36,96,32,64
EX 42
QK 36,100,36,36
buffer_load_dwordx4 v23, s[12:15], s28 offen offset:3072 nt lds
QK 36,104,40,36
EX 43
QK 36,108,44,36
CV 52,40,41
CV 53,42,43
s_waitcnt lgkmcnt(2)
PV 96,144,48
EX 44
PV 100,148,48
s_add_u32 s28, s28, 0x40000
VR 176,12,24576
PV 104,152,48
EX 45
PV 108,156,48
VR 178,12,28672
CV 54,44,45
PV 112,160,48
EX 46
PV 116,164,48
VR 180,13,24576
VR 182,13,28672
PV 120,168,48
EX 47
PV 124,172,48
VR 184,14,24576
CV 55,46,47
LM 208,48
VR 186,14,28672
VR 188,15,24576
s_waitcnt vmcnt(12) lgkmcnt(7)
s_barrier
QK 40,112,0,56
EX 32
QK 40,116,4,40
VR 190,15,28672
VR 192,16,24576
QK 40,120,8,40
EX 33
QK 40,124,12,40
VR 194,16,28672
CV 48,32,33
QK 44,128,0,56
EX 34
QK 44,132,4,44
KR 80,8,32768
KR 84,9,32768
QK 44,136,8,44
EX 35
QK 44,140,12,44
VR 196,17,24576
CV 49,34,35
PV 128,144,52
EX 36
PV 132,148,52
VR 198,17,28672
KR 88,10,32768
PV 136,152,52
EX 37
PV 140,156,52
KR 92,11,32768
CV 50,36,37
PV 144,160,52
EX 38
PV 148,164,52
VR 200,18,24576
VR 202,18,28672
PV 152,168,52
EX 39
PV 156,172,52
s_add_u32 m0, s27, 0
CV 51,38,39
LM 212,52
KR 96,8,36864
KR 100,9,36864
QK 32,112,16,60
EX 40
QK 32,116,20,32
VR 204,19,24576
VR 206,19,28672
QK 32,120,24,32
EX 41
QK 32,124,28,32
KR 104,10,36864
CV 52,40,41
QK 36,128,16,60
EX 42
QK 36,132,20,36
KR 108,11,36864
QK 36,136,24,36
EX 43
QK 36,140,28,36
CV 53,42,43
PV 160,144,48
EX 44
PV 164,148,48
buffer_load_dwordx4 v24, s[16:19], s29 offen offset:0 nt lds
PV 168,152,48
EX 45
PV 172,156,48
CV 54,44,45
PV 176,160,48
EX 46
PV 180,164,48
buffer_load_dwordx4 v25, s[16:19], s29 offen offset:1024 nt lds
PV 184,168,48
EX 47
PV 188,172,48
CV 55,46,47
LM 216,48
buffer_load_dwordx4 v26, s[16:19], s29 offen offset:2048 nt lds
QK 40,112,32,64
EX 32
QK 40,116,36,40
buffer_load_dwordx4 v27, s[16:19], s29 offen offset:3072 nt lds
QK 40,120,40,40
EX 33
QK 40,124,44,40
s_add_u32 s29, s29, 0x40000
CV 48,32,33
QK 44,128,32,64
EX 34
QK 44,132,36,44
QK 44,136,40,44
EX 35
QK 44,140,44,44
CV 49,34,35
s_waitcnt lgkmcnt(2)
PV 96,176,52
EX 36
PV 100,180,52
PV 104,184,52
EX 37
PV 108,188,52
CV 50,36,37
PV 112,192,52
EX 38
PV 116,196,52
PV 120,200,52
EX 39
PV 124,204,52
CV 51,38,39
LM 208,52
s_add_u32 s71, s71, 1
s_cbranch_scc1 SPEC_V300_1
BODY_V300_2:
s_waitcnt lgkmcnt(0)
QK 32,80,0,56
EX 40
QK 32,84,4,32
VR 144,12,32768
VR 146,12,36864
QK 32,88,8,32
EX 41
QK 32,92,12,32
VR 148,13,32768
CV 52,40,41
QK 36,96,0,56
EX 42
QK 36,100,4,36
VR 150,13,36864
VR 152,14,32768
QK 36,104,8,36
EX 43
QK 36,108,12,36
VR 154,14,36864
CV 53,42,43
PV 128,176,48
EX 44
PV 132,180,48
VR 156,15,32768
VR 158,15,36864
PV 136,184,48
EX 45
PV 140,188,48
VR 160,16,32768
CV 54,44,45
PV 144,192,48
EX 46
PV 148,196,48
VR 162,16,36864
KR 112,8,40960
PV 152,200,48
EX 47
PV 156,204,48
KR 116,9,40960
CV 55,46,47
LM 212,48
VR 164,17,32768
VR 166,17,36864
QK 40,80,16,60
EX 32
QK 40,84,20,40
KR 120,10,40960
KR 124,11,40960
QK 40,88,24,40
EX 33
QK 40,92,28,40
VR 168,18,32768
CV 48,32,33
QK 44,96,16,60
EX 34
QK 44,100,20,44
VR 170,18,36864
s_add_u32 m0, s26, 16384
QK 44,104,24,44
EX 35
QK 44,108,28,44
KR 128,8,45056
CV 49,34,35
PV 160,176,52
EX 36
PV 164,180,52
KR 132,9,45056
VR 172,19,32768
PV 168,184,52
EX 37
PV 172,188,52
VR 174,19,36864
CV 50,36,37
PV 176,192,52
EX 38
PV 180,196,52
KR 136,10,45056
KR 140,11,45056
PV 184,200,52
EX 39
PV 188,204,52
CV 51,38,39
LM 216,52
buffer_load_dwordx4 v20, s[12:15], s28 offen offset:0 nt lds
QK 32,80,32,64
EX 40
QK 32,84,36,32
buffer_load_dwordx4 v21, s[12:15], s28 offen offset:1024 nt lds
QK 32,88,40,32
EX 41
QK 32,92,44,32
buffer_load_dwordx4 v22, s[12:15], s28 offen offset:2048 nt lds
QK 36,96,32,64
EX 42
QK 36,100,36,36
buffer_load_dwordx4 v23, s[12:15], s28 offen offset:3072 nt lds
QK 36,104,40,36
EX 43
QK 36,108,44,36
CV 52,40,41
CV 53,42,43
s_waitcnt lgkmcnt(2)
PV 96,144,48
EX 44
PV 100,148,48
s_add_u32 s28, s28, 0x40000
VR 176,12,40960
PV 104,152,48
EX 45
PV 108,156,48
VR 178,12,45056
CV 54,44,45
PV 112,160,48
EX 46
PV 116,164,48
VR 180,13,40960
VR 182,13,45056
PV 120,168,48
EX 47
PV 124,172,48
VR 184,14,40960
CV 55,46,47
LM 208,48
VR 186,14,45056
VR 188,15,40960
s_waitcnt vmcnt(12) lgkmcnt(7)
s_barrier
QK 40,112,0,56
EX 32
QK 40,116,4,40
VR 190,15,45056
VR 192,16,40960
QK 40,120,8,40
EX 33
QK 40,124,12,40
VR 194,16,45056
CV 48,32,33
QK 44,128,0,56
EX 34
QK 44,132,4,44
KR 80,8,49152
KR 84,9,49152
QK 44,136,8,44
EX 35
QK 44,140,12,44
VR 196,17,40960
CV 49,34,35
PV 128,144,52
EX 36
PV 132,148,52
VR 198,17,45056
KR 88,10,49152
PV 136,152,52
EX 37
PV 140,156,52
KR 92,11,49152
CV 50,36,37
PV 144,160,52
EX 38
PV 148,164,52
VR 200,18,40960
VR 202,18,45056
PV 152,168,52
EX 39
PV 156,172,52
s_add_u32 m0, s27, 16384
CV 51,38,39
LM 212,52
KR 96,8,53248
KR 100,9,53248
QK 32,112,16,60
EX 40
QK 32,116,20,32
VR 204,19,40960
VR 206,19,45056
QK 32,120,24,32
EX 41
QK 32,124,28,32
KR 104,10,53248
CV 52,40,41
QK 36,128,16,60
EX 42
QK 36,132,20,36
KR 108,11,53248
QK 36,136,24,36
EX 43
QK 36,140,28,36
CV 53,42,43
PV 160,144,48
EX 44
PV 164,148,48
buffer_load_dwordx4 v24, s[16:19], s29 offen offset:0 nt lds
PV 168,152,48
EX 45
PV 172,156,48
CV 54,44,45
PV 176,160,48
EX 46
PV 180,164,48
buffer_load_dwordx4 v25, s[16:19], s29 offen offset:1024 nt lds
PV 184,168,48
EX 47
PV 188,172,48
CV 55,46,47
LM 216,48
buffer_load_dwordx4 v26, s[16:19], s29 offen offset:2048 nt lds
QK 40,112,32,64
EX 32
QK 40,116,36,40
buffer_load_dwordx4 v27, s[16:19], s29 offen offset:3072 nt lds
QK 40,120,40,40
EX 33
QK 40,124,44,40
s_add_u32 s29, s29, 0x40000
CV 48,32,33
QK 44,128,32,64
EX 34
QK 44,132,36,44
QK 44,136,40,44
EX 35
QK 44,140,44,44
CV 49,34,35
s_waitcnt lgkmcnt(2)
PV 96,176,52
EX 36
PV 100,180,52
PV 104,184,52
EX 37
PV 108,188,52
CV 50,36,37
PV 112,192,52
EX 38
PV 116,196,52
PV 120,200,52
EX 39
PV 124,204,52
CV 51,38,39
LM 208,52
s_add_u32 s71, s71, 1
s_cbranch_scc1 SPEC_V300_2
BODY_V300_3:
s_waitcnt lgkmcnt(0)
QK 32,80,0,56
EX 40
QK 32,84,4,32
VR 144,12,49152
VR 146,12,53248
QK 32,88,8,32
EX 41
QK 32,92,12,32
VR 148,13,49152
CV 52,40,41
QK 36,96,0,56
EX 42
QK 36,100,4,36
VR 150,13,53248
VR 152,14,49152
QK 36,104,8,36
EX 43
QK 36,108,12,36
VR 154,14,53248
CV 53,42,43
PV 128,176,48
EX 44
PV 132,180,48
VR 156,15,49152
VR 158,15,53248
PV 136,184,48
EX 45
PV 140,188,48
VR 160,16,49152
CV 54,44,45
PV 144,192,48
EX 46
PV 148,196,48
VR 162,16,53248
KR 112,8,57344
PV 152,200,48
EX 47
PV 156,204,48
KR 116,9,57344
CV 55,46,47
LM 212,48
VR 164,17,49152
VR 166,17,53248
QK 40,80,16,60
EX 32
QK 40,84,20,40
KR 120,10,57344
KR 124,11,57344
QK 40,88,24,40
EX 33
QK 40,92,28,40
VR 168,18,49152
CV 48,32,33
QK 44,96,16,60
EX 34
QK 44,100,20,44
VR 170,18,53248
s_add_u32 m0, s26, 32768
QK 44,104,24,44
EX 35
QK 44,108,28,44
KR 128,8,61440
CV 49,34,35
PV 160,176,52
EX 36
PV 164,180,52
KR 132,9,61440
VR 172,19,49152
PV 168,184,52
EX 37
PV 172,188,52
VR 174,19,53248
CV 50,36,37
PV 176,192,52
EX 38
PV 180,196,52
KR 136,10,61440
KR 140,11,61440
PV 184,200,52
EX 39
PV 188,204,52
CV 51,38,39
LM 216,52
buffer_load_dwordx4 v20, s[12:15], s28 offen offset:0 nt lds
QK 32,80,32,64
EX 40
QK 32,84,36,32
buffer_load_dwordx4 v21, s[12:15], s28 offen offset:1024 nt lds
QK 32,88,40,32
EX 41
QK 32,92,44,32
buffer_load_dwordx4 v22, s[12:15], s28 offen offset:2048 nt lds
QK 36,96,32,64
EX 42
QK 36,100,36,36
buffer_load_dwordx4 v23, s[12:15], s28 offen offset:3072 nt lds
QK 36,104,40,36
EX 43
QK 36,108,44,36
CV 52,40,41
CV 53,42,43
s_waitcnt lgkmcnt(2)
PV 96,144,48
EX 44
PV 100,148,48
s_add_u32 s28, s28, 0x40000
VR 176,12,57344
PV 104,152,48
EX 45
PV 108,156,48
VR 178,12,61440
CV 54,44,45
PV 112,160,48
EX 46
PV 116,164,48
VR 180,13,57344
VR 182,13,61440
PV 120,168,48
EX 47
PV 124,172,48
VR 184,14,57344
CV 55,46,47
LM 208,48
VR 186,14,61440
VR 188,15,57344
s_waitcnt vmcnt(12) lgkmcnt(7)
s_barrier
QK 40,112,0,56
EX 32
QK 40,116,4,40
VR 190,15,61440
VR 192,16,57344
QK 40,120,8,40
EX 33
QK 40,124,12,40
VR 194,16,61440
CV 48,32,33
QK 44,128,0,56
EX 34
QK 44,132,4,44
KR 80,8,0
KR 84,9,0
QK 44,136,8,44
EX 35
QK 44,140,12,44
VR 196,17,57344
CV 49,34,35
PV 128,144,52
EX 36
PV 132,148,52
VR 198,17,61440
KR 88,10,0
PV 136,152,52
EX 37
PV 140,156,52
KR 92,11,0
CV 50,36,37
PV 144,160,52
EX 38
PV 148,164,52
VR 200,18,57344
VR 202,18,61440
PV 152,168,52
EX 39
PV 156,172,52
s_add_u32 m0, s27, 32768
CV 51,38,39
LM 212,52
KR 96,8,4096
KR 100,9,4096
QK 32,112,16,60
EX 40
QK 32,116,20,32
VR 204,19,57344
VR 206,19,61440
QK 32,120,24,32
EX 41
QK 32,124,28,32
KR 104,10,4096
CV 52,40,41
QK 36,128,16,60
EX 42
QK 36,132,20,36
KR 108,11,4096
QK 36,136,24,36
EX 43
QK 36,140,28,36
CV 53,42,43
PV 160,144,48
EX 44
PV 164,148,48
buffer_load_dwordx4 v24, s[16:19], s29 offen offset:0 nt lds
PV 168,152,48
EX 45
PV 172,156,48
CV 54,44,45
PV 176,160,48
EX 46
PV 180,164,48
buffer_load_dwordx4 v25, s[16:19], s29 offen offset:1024 nt lds
PV 184,168,48
EX 47
PV 188,172,48
CV 55,46,47
LM 216,48
buffer_load_dwordx4 v26, s[16:19], s29 offen offset:2048 nt lds
QK 40,112,32,64
EX 32
QK 40,116,36,40
buffer_load_dwordx4 v27, s[16:19], s29 offen offset:3072 nt lds
QK 40,120,40,40
EX 33
QK 40,124,44,40
s_add_u32 s29, s29, 0x40000
CV 48,32,33
QK 44,128,32,64
EX 34
QK 44,132,36,44
QK 44,136,40,44
EX 35
QK 44,140,44,44
CV 49,34,35
s_waitcnt lgkmcnt(2)
PV 96,176,52
EX 36
PV 100,180,52
PV 104,184,52
EX 37
PV 108,188,52
CV 50,36,37
PV 112,192,52
EX 38
PV 116,196,52
PV 120,200,52
EX 39
PV 124,204,52
CV 51,38,39
LM 208,52
s_add_u32 s71, s71, 1
s_cbranch_scc1 SPEC_V300_3
s_branch BODY_V300_0
SPEC_V300_0:
s_mov_b32 s71, -1
s_add_u32 s77, s77, 1
s_cmp_eq_u32 s77, 3
s_cbranch_scc1 TAIL_V300_1
s_cmp_eq_u32 s77, 2
s_cbranch_scc1 BODY_V300_1
s_mov_b32 s28, s54
s_mov_b32 s29, s54
s_mov_b32 s14, s56
s_mov_b32 s18, s56
s_branch BODY_V300_1
SPEC_V300_1:
s_mov_b32 s71, -1
s_add_u32 s77, s77, 1
s_cmp_eq_u32 s77, 3
s_cbranch_scc1 TAIL_V300_2
s_cmp_eq_u32 s77, 2
s_cbranch_scc1 BODY_V300_2
s_mov_b32 s28, s54
s_mov_b32 s29, s54
s_mov_b32 s14, s56
s_mov_b32 s18, s56
s_branch BODY_V300_2
SPEC_V300_2:
s_mov_b32 s71, -1
s_add_u32 s77, s77, 1
s_cmp_eq_u32 s77, 3
s_cbranch_scc1 TAIL_V300_3
s_cmp_eq_u32 s77, 2
s_cbranch_scc1 BODY_V300_3
s_mov_b32 s28, s54
s_mov_b32 s29, s54
s_mov_b32 s14, s56
s_mov_b32 s18, s56
s_branch BODY_V300_3
SPEC_V300_3:
s_mov_b32 s71, -1
s_add_u32 s77, s77, 1
s_cmp_eq_u32 s77, 3
s_cbranch_scc1 TAIL_V300_0
s_cmp_eq_u32 s77, 2
s_cbranch_scc1 BODY_V300_0
s_mov_b32 s28, s54
s_mov_b32 s29, s54
s_mov_b32 s14, s56
s_mov_b32 s18, s56
s_branch BODY_V300_0
TAIL_V300_0:
s_waitcnt lgkmcnt(0)
QK 32,80,0,56
EX 40
QK 32,84,4,32
VR 144,12,0
VR 146,12,4096
QK 32,88,8,32
EX 41
QK 32,92,12,32
VR 148,13,0
CV 52,40,41
QK 36,96,0,56
EX 42
QK 36,100,4,36
VR 150,13,4096
VR 152,14,0
QK 36,104,8,36
EX 43
QK 36,108,12,36
VR 154,14,4096
CV 53,42,43
PV 128,176,48
EX 44
PV 132,180,48
VR 156,15,0
VR 158,15,4096
PV 136,184,48
EX 45
PV 140,188,48
VR 160,16,0
CV 54,44,45
PV 144,192,48
EX 46
PV 148,196,48
VR 162,16,4096
KR 112,8,8192
PV 152,200,48
EX 47
PV 156,204,48
KR 116,9,8192
CV 55,46,47
LM 212,48
VR 164,17,0
VR 166,17,4096
QK 40,80,16,60
EX 32
QK 40,84,20,40
KR 120,10,8192
KR 124,11,8192
QK 40,88,24,40
EX 33
QK 40,92,28,40
VR 168,18,0
CV 48,32,33
QK 44,96,16,60
EX 34
QK 44,100,20,44
VR 170,18,4096
s_add_u32 m0, s26, 49152
QK 44,104,24,44
EX 35
QK 44,108,28,44
KR 128,8,12288
CV 49,34,35
PV 160,176,52
EX 36
PV 164,180,52
KR 132,9,12288
VR 172,19,0
PV 168,184,52
EX 37
PV 172,188,52
VR 174,19,4096
CV 50,36,37
PV 176,192,52
EX 38
PV 180,196,52
KR 136,10,12288
KR 140,11,12288
PV 184,200,52
EX 39
PV 188,204,52
CV 51,38,39
LM 216,52
buffer_load_dwordx4 v20, s[12:15], s28 offen offset:0 nt lds
QK 32,80,32,64
EX 40
QK 32,84,36,32
buffer_load_dwordx4 v21, s[12:15], s28 offen offset:1024 nt lds
QK 32,88,40,32
EX 41
QK 32,92,44,32
buffer_load_dwordx4 v22, s[12:15], s28 offen offset:2048 nt lds
QK 36,96,32,64
EX 42
QK 36,100,36,36
buffer_load_dwordx4 v23, s[12:15], s28 offen offset:3072 nt lds
QK 36,104,40,36
EX 43
QK 36,108,44,36
CV 52,40,41
CV 53,42,43
s_waitcnt lgkmcnt(2)
PV 96,144,48
EX 44
PV 100,148,48
s_add_u32 s28, s28, 0x40000
VR 176,12,8192
PV 104,152,48
EX 45
PV 108,156,48
VR 178,12,12288
CV 54,44,45
PV 112,160,48
EX 46
PV 116,164,48
VR 180,13,8192
VR 182,13,12288
PV 120,168,48
EX 47
PV 124,172,48
VR 184,14,8192
CV 55,46,47
LM 208,48
VR 186,14,12288
VR 188,15,8192
s_waitcnt vmcnt(12) lgkmcnt(7)
s_barrier
v_add_f32 v40, v56, v76
v_add_f32 v41, v56, v77
v_add_f32 v42, v56, v78
v_add_f32 v43, v56, v79
v_add_f32 v44, v56, v80
v_add_f32 v45, v56, v81
v_add_f32 v46, v56, v82
v_add_f32 v47, v56, v83
s_nop 1
QK 40,112,0,40
EX 32
QK 40,116,4,40
VR 190,15,12288
VR 192,16,8192
QK 40,120,8,40
EX 33
QK 40,124,12,40
VR 194,16,12288
CV 48,32,33
QK 44,128,0,44
EX 34
QK 44,132,4,44
KR 80,8,16384
KR 84,9,16384
QK 44,136,8,44
EX 35
QK 44,140,12,44
VR 196,17,8192
CV 49,34,35
PV 128,144,52
EX 36
PV 132,148,52
VR 198,17,12288
KR 88,10,16384
PV 136,152,52
EX 37
PV 140,156,52
KR 92,11,16384
CV 50,36,37
PV 144,160,52
EX 38
PV 148,164,52
VR 200,18,8192
VR 202,18,12288
PV 152,168,52
EX 39
PV 156,172,52
s_add_u32 m0, s27, 49152
CV 51,38,39
LM 212,52
KR 96,8,20480
KR 100,9,20480
v_add_f32 v32, v60, v76
v_add_f32 v33, v60, v77
v_add_f32 v34, v60, v78
v_add_f32 v35, v60, v79
v_add_f32 v36, v60, v80
v_add_f32 v37, v60, v81
v_add_f32 v38, v60, v82
v_add_f32 v39, v60, v83
s_nop 1
QK 32,112,16,32
EX 40
QK 32,116,20,32
VR 204,19,8192
VR 206,19,12288
QK 32,120,24,32
EX 41
QK 32,124,28,32
KR 104,10,20480
CV 52,40,41
QK 36,128,16,36
EX 42
QK 36,132,20,36
KR 108,11,20480
QK 36,136,24,36
EX 43
QK 36,140,28,36
CV 53,42,43
PV 160,144,48
EX 44
PV 164,148,48
buffer_load_dwordx4 v24, s[16:19], s29 offen offset:0 nt lds
PV 168,152,48
EX 45
PV 172,156,48
CV 54,44,45
PV 176,160,48
EX 46
PV 180,164,48
buffer_load_dwordx4 v25, s[16:19], s29 offen offset:1024 nt lds
PV 184,168,48
EX 47
PV 188,172,48
CV 55,46,47
LM 216,48
buffer_load_dwordx4 v26, s[16:19], s29 offen offset:2048 nt lds
v_add_f32 v40, v64, v76
v_add_f32 v41, v64, v77
v_add_f32 v42, v64, v78
v_add_f32 v43, v64, v79
v_add_f32 v44, v64, v80
v_add_f32 v45, v64, v81
v_add_f32 v46, v64, v82
v_add_f32 v47, v64, v83
s_nop 1
QK 40,112,32,40
EX 32
QK 40,116,36,40
buffer_load_dwordx4 v27, s[16:19], s29 offen offset:3072 nt lds
QK 40,120,40,40
EX 33
QK 40,124,44,40
s_add_u32 s29, s29, 0x40000
CV 48,32,33
QK 44,128,32,44
EX 34
QK 44,132,36,44
QK 44,136,40,44
EX 35
QK 44,140,44,44
CV 49,34,35
s_waitcnt lgkmcnt(2)
PV 96,176,52
EX 36
PV 100,180,52
PV 104,184,52
EX 37
PV 108,188,52
CV 50,36,37
PV 112,192,52
EX 38
PV 116,196,52
PV 120,200,52
EX 39
PV 124,204,52
CV 51,38,39
LM 208,52
s_waitcnt lgkmcnt(0)
PV 128,176,48
EX 40
PV 132,180,48
EX 41
PV 136,184,48
EX 42
PV 140,188,48
EX 43
PV 144,192,48
EX 44
PV 148,196,48
EX 45
PV 152,200,48
EX 46
PV 156,204,48
EX 47
LM 212,48
CV 52,40,41
CV 53,42,43
CV 54,44,45
CV 55,46,47
s_nop 1
LM 216,52
PV 160,176,52
PV 164,180,52
PV 168,184,52
PV 172,188,52
PV 176,192,52
PV 180,196,52
PV 184,200,52
PV 188,204,52
s_mov_b32 s72, 1
s_branch EPI_V300
TAIL_V300_1:
s_waitcnt lgkmcnt(0)
QK 32,80,0,56
EX 40
QK 32,84,4,32
VR 144,12,16384
VR 146,12,20480
QK 32,88,8,32
EX 41
QK 32,92,12,32
VR 148,13,16384
CV 52,40,41
QK 36,96,0,56
EX 42
QK 36,100,4,36
VR 150,13,20480
VR 152,14,16384
QK 36,104,8,36
EX 43
QK 36,108,12,36
VR 154,14,20480
CV 53,42,43
PV 128,176,48
EX 44
PV 132,180,48
VR 156,15,16384
VR 158,15,20480
PV 136,184,48
EX 45
PV 140,188,48
VR 160,16,16384
CV 54,44,45
PV 144,192,48
EX 46
PV 148,196,48
VR 162,16,20480
KR 112,8,24576
PV 152,200,48
EX 47
PV 156,204,48
KR 116,9,24576
CV 55,46,47
LM 212,48
VR 164,17,16384
VR 166,17,20480
QK 40,80,16,60
EX 32
QK 40,84,20,40
KR 120,10,24576
KR 124,11,24576
QK 40,88,24,40
EX 33
QK 40,92,28,40
VR 168,18,16384
CV 48,32,33
QK 44,96,16,60
EX 34
QK 44,100,20,44
VR 170,18,20480
s_add_u32 m0, s26, 0
QK 44,104,24,44
EX 35
QK 44,108,28,44
KR 128,8,28672
CV 49,34,35
PV 160,176,52
EX 36
PV 164,180,52
KR 132,9,28672
VR 172,19,16384
PV 168,184,52
EX 37
PV 172,188,52
VR 174,19,20480
CV 50,36,37
PV 176,192,52
EX 38
PV 180,196,52
KR 136,10,28672
KR 140,11,28672
PV 184,200,52
EX 39
PV 188,204,52
CV 51,38,39
LM 216,52
buffer_load_dwordx4 v20, s[12:15], s28 offen offset:0 nt lds
QK 32,80,32,64
EX 40
QK 32,84,36,32
buffer_load_dwordx4 v21, s[12:15], s28 offen offset:1024 nt lds
QK 32,88,40,32
EX 41
QK 32,92,44,32
buffer_load_dwordx4 v22, s[12:15], s28 offen offset:2048 nt lds
QK 36,96,32,64
EX 42
QK 36,100,36,36
buffer_load_dwordx4 v23, s[12:15], s28 offen offset:3072 nt lds
QK 36,104,40,36
EX 43
QK 36,108,44,36
CV 52,40,41
CV 53,42,43
s_waitcnt lgkmcnt(2)
PV 96,144,48
EX 44
PV 100,148,48
s_add_u32 s28, s28, 0x40000
VR 176,12,24576
PV 104,152,48
EX 45
PV 108,156,48
VR 178,12,28672
CV 54,44,45
PV 112,160,48
EX 46
PV 116,164,48
VR 180,13,24576
VR 182,13,28672
PV 120,168,48
EX 47
PV 124,172,48
VR 184,14,24576
CV 55,46,47
LM 208,48
VR 186,14,28672
VR 188,15,24576
s_waitcnt vmcnt(12) lgkmcnt(7)
s_barrier
v_add_f32 v40, v56, v76
v_add_f32 v41, v56, v77
v_add_f32 v42, v56, v78
v_add_f32 v43, v56, v79
v_add_f32 v44, v56, v80
v_add_f32 v45, v56, v81
v_add_f32 v46, v56, v82
v_add_f32 v47, v56, v83
s_nop 1
QK 40,112,0,40
EX 32
QK 40,116,4,40
VR 190,15,28672
VR 192,16,24576
QK 40,120,8,40
EX 33
QK 40,124,12,40
VR 194,16,28672
CV 48,32,33
QK 44,128,0,44
EX 34
QK 44,132,4,44
KR 80,8,32768
KR 84,9,32768
QK 44,136,8,44
EX 35
QK 44,140,12,44
VR 196,17,24576
CV 49,34,35
PV 128,144,52
EX 36
PV 132,148,52
VR 198,17,28672
KR 88,10,32768
PV 136,152,52
EX 37
PV 140,156,52
KR 92,11,32768
CV 50,36,37
PV 144,160,52
EX 38
PV 148,164,52
VR 200,18,24576
VR 202,18,28672
PV 152,168,52
EX 39
PV 156,172,52
s_add_u32 m0, s27, 0
CV 51,38,39
LM 212,52
KR 96,8,36864
KR 100,9,36864
v_add_f32 v32, v60, v76
v_add_f32 v33, v60, v77
v_add_f32 v34, v60, v78
v_add_f32 v35, v60, v79
v_add_f32 v36, v60, v80
v_add_f32 v37, v60, v81
v_add_f32 v38, v60, v82
v_add_f32 v39, v60, v83
s_nop 1
QK 32,112,16,32
EX 40
QK 32,116,20,32
VR 204,19,24576
VR 206,19,28672
QK 32,120,24,32
EX 41
QK 32,124,28,32
KR 104,10,36864
CV 52,40,41
QK 36,128,16,36
EX 42
QK 36,132,20,36
KR 108,11,36864
QK 36,136,24,36
EX 43
QK 36,140,28,36
CV 53,42,43
PV 160,144,48
EX 44
PV 164,148,48
buffer_load_dwordx4 v24, s[16:19], s29 offen offset:0 nt lds
PV 168,152,48
EX 45
PV 172,156,48
CV 54,44,45
PV 176,160,48
EX 46
PV 180,164,48
buffer_load_dwordx4 v25, s[16:19], s29 offen offset:1024 nt lds
PV 184,168,48
EX 47
PV 188,172,48
CV 55,46,47
LM 216,48
buffer_load_dwordx4 v26, s[16:19], s29 offen offset:2048 nt lds
v_add_f32 v40, v64, v76
v_add_f32 v41, v64, v77
v_add_f32 v42, v64, v78
v_add_f32 v43, v64, v79
v_add_f32 v44, v64, v80
v_add_f32 v45, v64, v81
v_add_f32 v46, v64, v82
v_add_f32 v47, v64, v83
s_nop 1
QK 40,112,32,40
EX 32
QK 40,116,36,40
buffer_load_dwordx4 v27, s[16:19], s29 offen offset:3072 nt lds
QK 40,120,40,40
EX 33
QK 40,124,44,40
s_add_u32 s29, s29, 0x40000
CV 48,32,33
QK 44,128,32,44
EX 34
QK 44,132,36,44
QK 44,136,40,44
EX 35
QK 44,140,44,44
CV 49,34,35
s_waitcnt lgkmcnt(2)
PV 96,176,52
EX 36
PV 100,180,52
PV 104,184,52
EX 37
PV 108,188,52
CV 50,36,37
PV 112,192,52
EX 38
PV 116,196,52
PV 120,200,52
EX 39
PV 124,204,52
CV 51,38,39
LM 208,52
s_waitcnt lgkmcnt(0)
PV 128,176,48
EX 40
PV 132,180,48
EX 41
PV 136,184,48
EX 42
PV 140,188,48
EX 43
PV 144,192,48
EX 44
PV 148,196,48
EX 45
PV 152,200,48
EX 46
PV 156,204,48
EX 47
LM 212,48
CV 52,40,41
CV 53,42,43
CV 54,44,45
CV 55,46,47
s_nop 1
LM 216,52
PV 160,176,52
PV 164,180,52
PV 168,184,52
PV 172,188,52
PV 176,192,52
PV 180,196,52
PV 184,200,52
PV 188,204,52
s_mov_b32 s72, 2
s_branch EPI_V300
TAIL_V300_2:
s_waitcnt lgkmcnt(0)
QK 32,80,0,56
EX 40
QK 32,84,4,32
VR 144,12,32768
VR 146,12,36864
QK 32,88,8,32
EX 41
QK 32,92,12,32
VR 148,13,32768
CV 52,40,41
QK 36,96,0,56
EX 42
QK 36,100,4,36
VR 150,13,36864
VR 152,14,32768
QK 36,104,8,36
EX 43
QK 36,108,12,36
VR 154,14,36864
CV 53,42,43
PV 128,176,48
EX 44
PV 132,180,48
VR 156,15,32768
VR 158,15,36864
PV 136,184,48
EX 45
PV 140,188,48
VR 160,16,32768
CV 54,44,45
PV 144,192,48
EX 46
PV 148,196,48
VR 162,16,36864
KR 112,8,40960
PV 152,200,48
EX 47
PV 156,204,48
KR 116,9,40960
CV 55,46,47
LM 212,48
VR 164,17,32768
VR 166,17,36864
QK 40,80,16,60
EX 32
QK 40,84,20,40
KR 120,10,40960
KR 124,11,40960
QK 40,88,24,40
EX 33
QK 40,92,28,40
VR 168,18,32768
CV 48,32,33
QK 44,96,16,60
EX 34
QK 44,100,20,44
VR 170,18,36864
s_add_u32 m0, s26, 16384
QK 44,104,24,44
EX 35
QK 44,108,28,44
KR 128,8,45056
CV 49,34,35
PV 160,176,52
EX 36
PV 164,180,52
KR 132,9,45056
VR 172,19,32768
PV 168,184,52
EX 37
PV 172,188,52
VR 174,19,36864
CV 50,36,37
PV 176,192,52
EX 38
PV 180,196,52
KR 136,10,45056
KR 140,11,45056
PV 184,200,52
EX 39
PV 188,204,52
CV 51,38,39
LM 216,52
buffer_load_dwordx4 v20, s[12:15], s28 offen offset:0 nt lds
QK 32,80,32,64
EX 40
QK 32,84,36,32
buffer_load_dwordx4 v21, s[12:15], s28 offen offset:1024 nt lds
QK 32,88,40,32
EX 41
QK 32,92,44,32
buffer_load_dwordx4 v22, s[12:15], s28 offen offset:2048 nt lds
QK 36,96,32,64
EX 42
QK 36,100,36,36
buffer_load_dwordx4 v23, s[12:15], s28 offen offset:3072 nt lds
QK 36,104,40,36
EX 43
QK 36,108,44,36
CV 52,40,41
CV 53,42,43
s_waitcnt lgkmcnt(2)
PV 96,144,48
EX 44
PV 100,148,48
s_add_u32 s28, s28, 0x40000
VR 176,12,40960
PV 104,152,48
EX 45
PV 108,156,48
VR 178,12,45056
CV 54,44,45
PV 112,160,48
EX 46
PV 116,164,48
VR 180,13,40960
VR 182,13,45056
PV 120,168,48
EX 47
PV 124,172,48
VR 184,14,40960
CV 55,46,47
LM 208,48
VR 186,14,45056
VR 188,15,40960
s_waitcnt vmcnt(12) lgkmcnt(7)
s_barrier
v_add_f32 v40, v56, v76
v_add_f32 v41, v56, v77
v_add_f32 v42, v56, v78
v_add_f32 v43, v56, v79
v_add_f32 v44, v56, v80
v_add_f32 v45, v56, v81
v_add_f32 v46, v56, v82
v_add_f32 v47, v56, v83
s_nop 1
QK 40,112,0,40
EX 32
QK 40,116,4,40
VR 190,15,45056
VR 192,16,40960
QK 40,120,8,40
EX 33
QK 40,124,12,40
VR 194,16,45056
CV 48,32,33
QK 44,128,0,44
EX 34
QK 44,132,4,44
KR 80,8,49152
KR 84,9,49152
QK 44,136,8,44
EX 35
QK 44,140,12,44
VR 196,17,40960
CV 49,34,35
PV 128,144,52
EX 36
PV 132,148,52
VR 198,17,45056
KR 88,10,49152
PV 136,152,52
EX 37
PV 140,156,52
KR 92,11,49152
CV 50,36,37
PV 144,160,52
EX 38
PV 148,164,52
VR 200,18,40960
VR 202,18,45056
PV 152,168,52
EX 39
PV 156,172,52
s_add_u32 m0, s27, 16384
CV 51,38,39
LM 212,52
KR 96,8,53248
KR 100,9,53248
v_add_f32 v32, v60, v76
v_add_f32 v33, v60, v77
v_add_f32 v34, v60, v78
v_add_f32 v35, v60, v79
v_add_f32 v36, v60, v80
v_add_f32 v37, v60, v81
v_add_f32 v38, v60, v82
v_add_f32 v39, v60, v83
s_nop 1
QK 32,112,16,32
EX 40
QK 32,116,20,32
VR 204,19,40960
VR 206,19,45056
QK 32,120,24,32
EX 41
QK 32,124,28,32
KR 104,10,53248
CV 52,40,41
QK 36,128,16,36
EX 42
QK 36,132,20,36
KR 108,11,53248
QK 36,136,24,36
EX 43
QK 36,140,28,36
CV 53,42,43
PV 160,144,48
EX 44
PV 164,148,48
buffer_load_dwordx4 v24, s[16:19], s29 offen offset:0 nt lds
PV 168,152,48
EX 45
PV 172,156,48
CV 54,44,45
PV 176,160,48
EX 46
PV 180,164,48
buffer_load_dwordx4 v25, s[16:19], s29 offen offset:1024 nt lds
PV 184,168,48
EX 47
PV 188,172,48
CV 55,46,47
LM 216,48
buffer_load_dwordx4 v26, s[16:19], s29 offen offset:2048 nt lds
v_add_f32 v40, v64, v76
v_add_f32 v41, v64, v77
v_add_f32 v42, v64, v78
v_add_f32 v43, v64, v79
v_add_f32 v44, v64, v80
v_add_f32 v45, v64, v81
v_add_f32 v46, v64, v82
v_add_f32 v47, v64, v83
s_nop 1
QK 40,112,32,40
EX 32
QK 40,116,36,40
buffer_load_dwordx4 v27, s[16:19], s29 offen offset:3072 nt lds
QK 40,120,40,40
EX 33
QK 40,124,44,40
s_add_u32 s29, s29, 0x40000
CV 48,32,33
QK 44,128,32,44
EX 34
QK 44,132,36,44
QK 44,136,40,44
EX 35
QK 44,140,44,44
CV 49,34,35
s_waitcnt lgkmcnt(2)
PV 96,176,52
EX 36
PV 100,180,52
PV 104,184,52
EX 37
PV 108,188,52
CV 50,36,37
PV 112,192,52
EX 38
PV 116,196,52
PV 120,200,52
EX 39
PV 124,204,52
CV 51,38,39
LM 208,52
s_waitcnt lgkmcnt(0)
PV 128,176,48
EX 40
PV 132,180,48
EX 41
PV 136,184,48
EX 42
PV 140,188,48
EX 43
PV 144,192,48
EX 44
PV 148,196,48
EX 45
PV 152,200,48
EX 46
PV 156,204,48
EX 47
LM 212,48
CV 52,40,41
CV 53,42,43
CV 54,44,45
CV 55,46,47
s_nop 1
LM 216,52
PV 160,176,52
PV 164,180,52
PV 168,184,52
PV 172,188,52
PV 176,192,52
PV 180,196,52
PV 184,200,52
PV 188,204,52
s_mov_b32 s72, 3
s_branch EPI_V300
TAIL_V300_3:
s_waitcnt lgkmcnt(0)
QK 32,80,0,56
EX 40
QK 32,84,4,32
VR 144,12,49152
VR 146,12,53248
QK 32,88,8,32
EX 41
QK 32,92,12,32
VR 148,13,49152
CV 52,40,41
QK 36,96,0,56
EX 42
QK 36,100,4,36
VR 150,13,53248
VR 152,14,49152
QK 36,104,8,36
EX 43
QK 36,108,12,36
VR 154,14,53248
CV 53,42,43
PV 128,176,48
EX 44
PV 132,180,48
VR 156,15,49152
VR 158,15,53248
PV 136,184,48
EX 45
PV 140,188,48
VR 160,16,49152
CV 54,44,45
PV 144,192,48
EX 46
PV 148,196,48
VR 162,16,53248
KR 112,8,57344
PV 152,200,48
EX 47
PV 156,204,48
KR 116,9,57344
CV 55,46,47
LM 212,48
VR 164,17,49152
VR 166,17,53248
QK 40,80,16,60
EX 32
QK 40,84,20,40
KR 120,10,57344
KR 124,11,57344
QK 40,88,24,40
EX 33
QK 40,92,28,40
VR 168,18,49152
CV 48,32,33
QK 44,96,16,60
EX 34
QK 44,100,20,44
VR 170,18,53248
s_add_u32 m0, s26, 32768
QK 44,104,24,44
EX 35
QK 44,108,28,44
KR 128,8,61440
CV 49,34,35
PV 160,176,52
EX 36
PV 164,180,52
KR 132,9,61440
VR 172,19,49152
PV 168,184,52
EX 37
PV 172,188,52
VR 174,19,53248
CV 50,36,37
PV 176,192,52
EX 38
PV 180,196,52
KR 136,10,61440
KR 140,11,61440
PV 184,200,52
EX 39
PV 188,204,52
CV 51,38,39
LM 216,52
buffer_load_dwordx4 v20, s[12:15], s28 offen offset:0 nt lds
QK 32,80,32,64
EX 40
QK 32,84,36,32
buffer_load_dwordx4 v21, s[12:15], s28 offen offset:1024 nt lds
QK 32,88,40,32
EX 41
QK 32,92,44,32
buffer_load_dwordx4 v22, s[12:15], s28 offen offset:2048 nt lds
QK 36,96,32,64
EX 42
QK 36,100,36,36
buffer_load_dwordx4 v23, s[12:15], s28 offen offset:3072 nt lds
QK 36,104,40,36
EX 43
QK 36,108,44,36
CV 52,40,41
CV 53,42,43
s_waitcnt lgkmcnt(2)
PV 96,144,48
EX 44
PV 100,148,48
s_add_u32 s28, s28, 0x40000
VR 176,12,57344
PV 104,152,48
EX 45
PV 108,156,48
VR 178,12,61440
CV 54,44,45
PV 112,160,48
EX 46
PV 116,164,48
VR 180,13,57344
VR 182,13,61440
PV 120,168,48
EX 47
PV 124,172,48
VR 184,14,57344
CV 55,46,47
LM 208,48
VR 186,14,61440
VR 188,15,57344
s_waitcnt vmcnt(12) lgkmcnt(7)
s_barrier
v_add_f32 v40, v56, v76
v_add_f32 v41, v56, v77
v_add_f32 v42, v56, v78
v_add_f32 v43, v56, v79
v_add_f32 v44, v56, v80
v_add_f32 v45, v56, v81
v_add_f32 v46, v56, v82
v_add_f32 v47, v56, v83
s_nop 1
QK 40,112,0,40
EX 32
QK 40,116,4,40
VR 190,15,61440
VR 192,16,57344
QK 40,120,8,40
EX 33
QK 40,124,12,40
VR 194,16,61440
CV 48,32,33
QK 44,128,0,44
EX 34
QK 44,132,4,44
KR 80,8,0
KR 84,9,0
QK 44,136,8,44
EX 35
QK 44,140,12,44
VR 196,17,57344
CV 49,34,35
PV 128,144,52
EX 36
PV 132,148,52
VR 198,17,61440
KR 88,10,0
PV 136,152,52
EX 37
PV 140,156,52
KR 92,11,0
CV 50,36,37
PV 144,160,52
EX 38
PV 148,164,52
VR 200,18,57344
VR 202,18,61440
PV 152,168,52
EX 39
PV 156,172,52
s_add_u32 m0, s27, 32768
CV 51,38,39
LM 212,52
KR 96,8,4096
KR 100,9,4096
v_add_f32 v32, v60, v76
v_add_f32 v33, v60, v77
v_add_f32 v34, v60, v78
v_add_f32 v35, v60, v79
v_add_f32 v36, v60, v80
v_add_f32 v37, v60, v81
v_add_f32 v38, v60, v82
v_add_f32 v39, v60, v83
s_nop 1
QK 32,112,16,32
EX 40
QK 32,116,20,32
VR 204,19,57344
VR 206,19,61440
QK 32,120,24,32
EX 41
QK 32,124,28,32
KR 104,10,4096
CV 52,40,41
QK 36,128,16,36
EX 42
QK 36,132,20,36
KR 108,11,4096
QK 36,136,24,36
EX 43
QK 36,140,28,36
CV 53,42,43
PV 160,144,48
EX 44
PV 164,148,48
buffer_load_dwordx4 v24, s[16:19], s29 offen offset:0 nt lds
PV 168,152,48
EX 45
PV 172,156,48
CV 54,44,45
PV 176,160,48
EX 46
PV 180,164,48
buffer_load_dwordx4 v25, s[16:19], s29 offen offset:1024 nt lds
PV 184,168,48
EX 47
PV 188,172,48
CV 55,46,47
LM 216,48
buffer_load_dwordx4 v26, s[16:19], s29 offen offset:2048 nt lds
v_add_f32 v40, v64, v76
v_add_f32 v41, v64, v77
v_add_f32 v42, v64, v78
v_add_f32 v43, v64, v79
v_add_f32 v44, v64, v80
v_add_f32 v45, v64, v81
v_add_f32 v46, v64, v82
v_add_f32 v47, v64, v83
s_nop 1
QK 40,112,32,40
EX 32
QK 40,116,36,40
buffer_load_dwordx4 v27, s[16:19], s29 offen offset:3072 nt lds
QK 40,120,40,40
EX 33
QK 40,124,44,40
s_add_u32 s29, s29, 0x40000
CV 48,32,33
QK 44,128,32,44
EX 34
QK 44,132,36,44
QK 44,136,40,44
EX 35
QK 44,140,44,44
CV 49,34,35
s_waitcnt lgkmcnt(2)
PV 96,176,52
EX 36
PV 100,180,52
PV 104,184,52
EX 37
PV 108,188,52
CV 50,36,37
PV 112,192,52
EX 38
PV 116,196,52
PV 120,200,52
EX 39
PV 124,204,52
CV 51,38,39
LM 208,52
s_waitcnt lgkmcnt(0)
PV 128,176,48
EX 40
PV 132,180,48
EX 41
PV 136,184,48
EX 42
PV 140,188,48
EX 43
PV 144,192,48
EX 44
PV 148,196,48
EX 45
PV 152,200,48
EX 46
PV 156,204,48
EX 47
LM 212,48
CV 52,40,41
CV 53,42,43
CV 54,44,45
CV 55,46,47
s_nop 1
LM 216,52
PV 160,176,52
PV 164,180,52
PV 168,184,52
PV 172,188,52
PV 176,192,52
PV 180,196,52
PV 184,200,52
PV 188,204,52
s_mov_b32 s72, 0
EPI_V300:
s_add_u32 s88, s40, 135424
v_mov_b32 v42, s88
v_add_u32 v44, s40, v4
v_add_u32 v45, s40, v3
v_add_u32 v46, s40, v1
v_accvgpr_read_b32 v50, a208
v_accvgpr_read_b32 v51, a212
v_accvgpr_read_b32 v52, a216
v_cmp_nge_f32 s[78:79], s76, v50
v_cmp_nge_f32 s[80:81], s76, v51
v_cmp_nge_f32 s[82:83], s76, v52
v_rcp_f32 v32, v50
v_rcp_f32 v34, v51
v_rcp_f32 v36, v52
s_or_b64 s[78:79], s[78:79], s[80:81]
s_or_b64 s[78:79], s[78:79], s[82:83]
s_cmp_lg_u64 s[78:79], 0
s_cselect_b32 s90, 1, 0
v_mov_b32 v43, s90
ds_write_b32 v42, v43
s_nop 3
v_pk_mul_f32 v[96:97], v[96:97], v[32:33] op_sel_hi:[1,0]
v_pk_mul_f32 v[98:99], v[98:99], v[32:33] op_sel_hi:[1,0]
CV 96,96,97
CV 97,98,99
v_pk_mul_f32 v[100:101], v[100:101], v[32:33] op_sel_hi:[1,0]
v_pk_mul_f32 v[102:103], v[102:103], v[32:33] op_sel_hi:[1,0]
CV 100,100,101
CV 101,102,103
v_pk_mul_f32 v[104:105], v[104:105], v[32:33] op_sel_hi:[1,0]
v_pk_mul_f32 v[106:107], v[106:107], v[32:33] op_sel_hi:[1,0]
CV 104,104,105
CV 105,106,107
v_pk_mul_f32 v[108:109], v[108:109], v[32:33] op_sel_hi:[1,0]
v_pk_mul_f32 v[110:111], v[110:111], v[32:33] op_sel_hi:[1,0]
CV 108,108,109
CV 109,110,111
v_pk_mul_f32 v[112:113], v[112:113], v[32:33] op_sel_hi:[1,0]
v_pk_mul_f32 v[114:115], v[114:115], v[32:33] op_sel_hi:[1,0]
CV 112,112,113
CV 113,114,115
v_pk_mul_f32 v[116:117], v[116:117], v[32:33] op_sel_hi:[1,0]
v_pk_mul_f32 v[118:119], v[118:119], v[32:33] op_sel_hi:[1,0]
CV 116,116,117
CV 117,118,119
v_pk_mul_f32 v[120:121], v[120:121], v[32:33] op_sel_hi:[1,0]
v_pk_mul_f32 v[122:123], v[122:123], v[32:33] op_sel_hi:[1,0]
CV 120,120,121
CV 121,122,123
v_pk_mul_f32 v[124:125], v[124:125], v[32:33] op_sel_hi:[1,0]
v_pk_mul_f32 v[126:127], v[126:127], v[32:33] op_sel_hi:[1,0]
CV 124,124,125
CV 125,126,127
ds_write_b64 v44, v[96:97] offset:0
ds_write_b64 v44, v[100:101] offset:32
ds_write_b64 v44, v[104:105] offset:64
ds_write_b64 v44, v[108:109] offset:96
ds_write_b64 v44, v[112:113] offset:128
ds_write_b64 v44, v[116:117] offset:160
ds_write_b64 v44, v[120:121] offset:192
ds_write_b64 v44, v[124:125] offset:224
v_pk_mul_f32 v[128:129], v[128:129], v[34:35] op_sel_hi:[1,0]
v_pk_mul_f32 v[130:131], v[130:131], v[34:35] op_sel_hi:[1,0]
CV 128,128,129
CV 129,130,131
v_pk_mul_f32 v[132:133], v[132:133], v[34:35] op_sel_hi:[1,0]
v_pk_mul_f32 v[134:135], v[134:135], v[34:35] op_sel_hi:[1,0]
CV 132,132,133
CV 133,134,135
v_pk_mul_f32 v[136:137], v[136:137], v[34:35] op_sel_hi:[1,0]
v_pk_mul_f32 v[138:139], v[138:139], v[34:35] op_sel_hi:[1,0]
CV 136,136,137
CV 137,138,139
v_pk_mul_f32 v[140:141], v[140:141], v[34:35] op_sel_hi:[1,0]
v_pk_mul_f32 v[142:143], v[142:143], v[34:35] op_sel_hi:[1,0]
CV 140,140,141
CV 141,142,143
v_pk_mul_f32 v[144:145], v[144:145], v[34:35] op_sel_hi:[1,0]
v_pk_mul_f32 v[146:147], v[146:147], v[34:35] op_sel_hi:[1,0]
CV 144,144,145
CV 145,146,147
v_pk_mul_f32 v[148:149], v[148:149], v[34:35] op_sel_hi:[1,0]
v_pk_mul_f32 v[150:151], v[150:151], v[34:35] op_sel_hi:[1,0]
CV 148,148,149
CV 149,150,151
v_pk_mul_f32 v[152:153], v[152:153], v[34:35] op_sel_hi:[1,0]
v_pk_mul_f32 v[154:155], v[154:155], v[34:35] op_sel_hi:[1,0]
CV 152,152,153
CV 153,154,155
v_pk_mul_f32 v[156:157], v[156:157], v[34:35] op_sel_hi:[1,0]
v_pk_mul_f32 v[158:159], v[158:159], v[34:35] op_sel_hi:[1,0]
CV 156,156,157
CV 157,158,159
v_pk_mul_f32 v[160:161], v[160:161], v[36:37] op_sel_hi:[1,0]
v_pk_mul_f32 v[162:163], v[162:163], v[36:37] op_sel_hi:[1,0]
CV 160,160,161
CV 161,162,163
v_pk_mul_f32 v[164:165], v[164:165], v[36:37] op_sel_hi:[1,0]
v_pk_mul_f32 v[166:167], v[166:167], v[36:37] op_sel_hi:[1,0]
CV 164,164,165
CV 165,166,167
v_pk_mul_f32 v[168:169], v[168:169], v[36:37] op_sel_hi:[1,0]
v_pk_mul_f32 v[170:171], v[170:171], v[36:37] op_sel_hi:[1,0]
CV 168,168,169
CV 169,170,171
v_pk_mul_f32 v[172:173], v[172:173], v[36:37] op_sel_hi:[1,0]
v_pk_mul_f32 v[174:175], v[174:175], v[36:37] op_sel_hi:[1,0]
CV 172,172,173
CV 173,174,175
v_pk_mul_f32 v[176:177], v[176:177], v[36:37] op_sel_hi:[1,0]
v_pk_mul_f32 v[178:179], v[178:179], v[36:37] op_sel_hi:[1,0]
CV 176,176,177
CV 177,178,179
v_pk_mul_f32 v[180:181], v[180:181], v[36:37] op_sel_hi:[1,0]
v_pk_mul_f32 v[182:183], v[182:183], v[36:37] op_sel_hi:[1,0]
CV 180,180,181
CV 181,182,183
v_pk_mul_f32 v[184:185], v[184:185], v[36:37] op_sel_hi:[1,0]
v_pk_mul_f32 v[186:187], v[186:187], v[36:37] op_sel_hi:[1,0]
CV 184,184,185
CV 185,186,187
v_pk_mul_f32 v[188:189], v[188:189], v[36:37] op_sel_hi:[1,0]
v_pk_mul_f32 v[190:191], v[190:191], v[36:37] op_sel_hi:[1,0]
CV 188,188,189
CV 189,190,191
s_waitcnt lgkmcnt(0)
ds_read_b128 v[112:115], v45 offset:0
ds_read_b128 v[116:119], v45 offset:1088
ds_read_b128 v[120:123], v45 offset:2176
ds_read_b128 v[124:127], v45 offset:3264
s_waitcnt lgkmcnt(0)
ds_write_b64 v44, v[128:129] offset:0
ds_write_b64 v44, v[132:133] offset:32
ds_write_b64 v44, v[136:137] offset:64
ds_write_b64 v44, v[140:141] offset:96
ds_write_b64 v44, v[144:145] offset:128
ds_write_b64 v44, v[148:149] offset:160
ds_write_b64 v44, v[152:153] offset:192
ds_write_b64 v44, v[156:157] offset:224
s_add_u32 s87, s49, 0
buffer_store_dwordx4 v[112:115], v29, s[20:23], s87 offen sc1
s_add_u32 s87, s49, 16384
buffer_store_dwordx4 v[116:119], v29, s[20:23], s87 offen sc1
s_add_u32 s87, s49, 32768
buffer_store_dwordx4 v[120:123], v29, s[20:23], s87 offen sc1
s_add_u32 s87, s49, 49152
buffer_store_dwordx4 v[124:127], v29, s[20:23], s87 offen sc1
s_waitcnt lgkmcnt(0)
ds_read_b128 v[144:147], v45 offset:0
ds_read_b128 v[148:151], v45 offset:1088
ds_read_b128 v[152:155], v45 offset:2176
ds_read_b128 v[156:159], v45 offset:3264
s_waitcnt lgkmcnt(0)
ds_write_b64 v44, v[160:161] offset:0
ds_write_b64 v44, v[164:165] offset:32
ds_write_b64 v44, v[168:169] offset:64
ds_write_b64 v44, v[172:173] offset:96
ds_write_b64 v44, v[176:177] offset:128
ds_write_b64 v44, v[180:181] offset:160
ds_write_b64 v44, v[184:185] offset:192
ds_write_b64 v44, v[188:189] offset:224
s_add_u32 s87, s50, 0
buffer_store_dwordx4 v[144:147], v29, s[20:23], s87 offen sc1
s_add_u32 s87, s50, 16384
buffer_store_dwordx4 v[148:151], v29, s[20:23], s87 offen sc1
s_add_u32 s87, s50, 32768
buffer_store_dwordx4 v[152:155], v29, s[20:23], s87 offen sc1
s_add_u32 s87, s50, 49152
buffer_store_dwordx4 v[156:159], v29, s[20:23], s87 offen sc1
s_waitcnt lgkmcnt(0)
ds_read_b128 v[176:179], v45 offset:0
ds_read_b128 v[180:183], v45 offset:1088
ds_read_b128 v[184:187], v45 offset:2176
ds_read_b128 v[188:191], v45 offset:3264
s_waitcnt lgkmcnt(0)
s_add_u32 s87, s51, 0
buffer_store_dwordx4 v[176:179], v29, s[20:23], s87 offen sc1
s_add_u32 s87, s51, 16384
buffer_store_dwordx4 v[180:183], v29, s[20:23], s87 offen sc1
s_add_u32 s87, s51, 32768
buffer_store_dwordx4 v[184:187], v29, s[20:23], s87 offen sc1
s_add_u32 s87, s51, 49152
buffer_store_dwordx4 v[188:191], v29, s[20:23], s87 offen sc1
s_barrier
ds_read_b32 v43, v28
s_waitcnt lgkmcnt(0)
v_cmp_ne_u32 s[86:87], 0, v43
s_nop 3
s_cmp_lg_u64 s[86:87], 0
s_cselect_b32 s86, 1, 0
s_andn2_b32 s86, s86, s73
s_cmp_lg_u32 s86, 0
s_cbranch_scc1 MAXPASS
s_endpgm
VE_12:
PRO_V210:
s_cmp_lg_u32 s73, 0
s_cbranch_scc1 PRO_V210_skipmax
s_waitcnt lgkmcnt(0)
v_mfma_f32_16x16x32_bf16 v[96:99], a[80:83], a[0:3], 0
v_mov_b64 v[160:161], 0
QK 96,84,4,96
v_mov_b64 v[162:163], 0
QK 96,88,8,96
v_mov_b64 v[164:165], 0
QK 96,92,12,96
v_mov_b64 v[166:167], 0
v_mfma_f32_16x16x32_bf16 v[100:103], a[96:99], a[0:3], 0
v_mov_b64 v[168:169], 0
QK 100,100,4,100
v_mov_b64 v[170:171], 0
QK 100,104,8,100
v_mov_b64 v[172:173], 0
QK 100,108,12,100
v_mov_b64 v[174:175], 0
v_mfma_f32_16x16x32_bf16 v[104:107], a[80:83], a[16:19], 0
v_mov_b64 v[176:177], 0
QK 104,84,20,104
v_mov_b64 v[178:179], 0
QK 104,88,24,104
v_mov_b64 v[180:181], 0
QK 104,92,28,104
v_mov_b64 v[182:183], 0
v_mfma_f32_16x16x32_bf16 v[108:111], a[96:99], a[16:19], 0
v_mov_b64 v[184:185], 0
QK 108,100,20,108
v_mov_b64 v[186:187], 0
QK 108,104,24,108
v_mov_b64 v[188:189], 0
QK 108,108,28,108
v_mov_b64 v[190:191], 0
v_mfma_f32_16x16x32_bf16 v[112:115], a[80:83], a[32:35], 0
QK 112,84,36,112
QK 112,88,40,112
QK 112,92,44,112
v_mfma_f32_16x16x32_bf16 v[116:119], a[96:99], a[32:35], 0
QK 116,100,36,116
QK 116,104,40,116
QK 116,108,44,116
s_nop 8
v_max3_f32 v32, v96, v97, v98
v_max3_f32 v33, v104, v105, v106
v_max3_f32 v34, v112, v113, v114
v_max3_f32 v32, v32, v99, v100
v_max3_f32 v33, v33, v107, v108
v_max3_f32 v34, v34, v115, v116
v_max3_f32 v32, v32, v101, v102
v_max3_f32 v33, v33, v109, v110
v_max3_f32 v34, v34, v117, v118
v_max_f32 v32, v32, v103
v_max_f32 v33, v33, v111
v_max_f32 v34, v34, v119
v_mov_b32 v40, v32
v_mov_b32 v41, v33
v_mov_b32 v42, v34
s_nop 1
v_permlane16_swap_b32 v32, v40
v_permlane16_swap_b32 v33, v41
v_permlane16_swap_b32 v34, v42
s_nop 1
v_max_f32 v32, v32, v40
v_max_f32 v33, v33, v41
v_max_f32 v34, v34, v42
v_mov_b32 v40, v32
v_mov_b32 v41, v33
v_mov_b32 v42, v34
s_nop 1
v_permlane32_swap_b32 v32, v40
v_permlane32_swap_b32 v33, v41
v_permlane32_swap_b32 v34, v42
s_nop 1
v_max_f32 v32, v32, v40
v_max_f32 v33, v33, v41
v_max_f32 v34, v34, v42
v_sub_f32 v56, 0, v32
v_sub_f32 v57, 0, v32
v_sub_f32 v58, 0, v32
v_sub_f32 v59, 0, v32
v_sub_f32 v60, 0, v33
v_sub_f32 v61, 0, v33
v_sub_f32 v62, 0, v33
v_sub_f32 v63, 0, v33
v_sub_f32 v64, 0, v34
v_sub_f32 v65, 0, v34
v_sub_f32 v66, 0, v34
v_sub_f32 v67, 0, v34
s_branch PRO_V210_go
PRO_V210_skipmax:
v_mov_b64 v[160:161], 0
v_mov_b64 v[162:163], 0
v_mov_b64 v[164:165], 0
v_mov_b64 v[166:167], 0
v_mov_b64 v[168:169], 0
v_mov_b64 v[170:171], 0
v_mov_b64 v[172:173], 0
v_mov_b64 v[174:175], 0
v_mov_b64 v[176:177], 0
v_mov_b64 v[178:179], 0
v_mov_b64 v[180:181], 0
v_mov_b64 v[182:183], 0
v_mov_b64 v[184:185], 0
v_mov_b64 v[186:187], 0
v_mov_b64 v[188:189], 0
v_mov_b64 v[190:191], 0
s_waitcnt lgkmcnt(0)
PRO_V210_go:
v_mov_b64 v[96:97], 0
v_mov_b64 v[98:99], 0
v_mov_b64 v[100:101], 0
v_mov_b64 v[102:103], 0
v_mov_b64 v[104:105], 0
v_mov_b64 v[106:107], 0
v_mov_b64 v[108:109], 0
v_mov_b64 v[110:111], 0
v_mov_b64 v[112:113], 0
v_mov_b64 v[114:115], 0
v_mov_b64 v[116:117], 0
v_mov_b64 v[118:119], 0
v_mov_b64 v[120:121], 0
v_mov_b64 v[122:123], 0
v_mov_b64 v[124:125], 0
v_mov_b64 v[126:127], 0
v_mov_b64 v[128:129], 0
v_mov_b64 v[130:131], 0
v_mov_b64 v[132:133], 0
v_mov_b64 v[134:135], 0
v_mov_b64 v[136:137], 0
v_mov_b64 v[138:139], 0
v_mov_b64 v[140:141], 0
v_mov_b64 v[142:143], 0
v_mov_b64 v[144:145], 0
v_mov_b64 v[146:147], 0
v_mov_b64 v[148:149], 0
v_mov_b64 v[150:151], 0
v_mov_b64 v[152:153], 0
v_mov_b64 v[154:155], 0
v_mov_b64 v[156:157], 0
v_mov_b64 v[158:159], 0
v_mov_b32 v32, v31
v_mov_b32 v33, v31
v_mov_b32 v34, v31
v_mov_b32 v35, v31
v_mov_b32 v36, v31
v_mov_b32 v37, v31
v_mov_b32 v38, v31
v_mov_b32 v39, v31
v_mov_b32 v40, v31
v_mov_b32 v41, v31
v_mov_b32 v42, v31
v_mov_b32 v43, v31
v_mov_b32 v44, v31
v_mov_b32 v45, v31
v_mov_b32 v46, v31
v_mov_b32 v47, v31
v_mov_b64 v[48:49], 0
v_mov_b64 v[50:51], 0
v_mov_b64 v[52:53], 0
v_mov_b64 v[54:55], 0
s_sub_u32 s71, 3, s45
s_mov_b32 s77, 0
s_sub_u32 s37, s2, s2
s_cmp_eq_u32 s57, 0
s_cselect_b32 s36, 1, -3
s_cmp_eq_u32 s72, 1
s_cbranch_scc1 BODY_V210_1
s_cmp_eq_u32 s72, 2
s_cbranch_scc1 BODY_V210_2
s_cmp_eq_u32 s72, 3
s_cbranch_scc1 BODY_V210_3
BODY_V210_0:
s_waitcnt lgkmcnt(9)
QK 32,80,0,56
EX 40
QK 32,84,4,32
VR 144,12,0
VR 146,12,4096
QK 32,88,8,32
EX 41
QK 32,92,12,32
VR 148,13,0
CV 52,40,41
QK 36,96,0,56
EX 42
QK 36,100,4,36
VR 150,13,4096
VR 152,14,0
QK 36,104,8,36
EX 43
QK 36,108,12,36
VR 154,14,4096
CV 53,42,43
s_waitcnt lgkmcnt(6)
PV 96,176,48
EX 44
PV 100,180,48
VR 156,15,0
VR 158,15,4096
PV 104,184,48
EX 45
PV 108,188,48
VR 160,16,0
CV 54,44,45
PV 112,192,48
EX 46
PV 116,196,48
VR 162,16,4096
KR 112,8,8192
PV 120,200,48
EX 47
PV 124,204,48
KR 116,9,8192
CV 55,46,47
LM 208,48
VR 164,17,0
VR 166,17,4096
QK 40,80,16,60
EX 32
QK 40,84,20,40
KR 120,10,8192
KR 124,11,8192
QK 40,88,24,40
EX 33
QK 40,92,28,40
VR 168,18,0
CV 48,32,33
QK 44,96,16,60
EX 34
QK 44,100,20,44
VR 170,18,4096
s_add_u32 m0, s26, 49152
QK 44,104,24,44
EX 35
QK 44,108,28,44
KR 128,8,12288
CV 49,34,35
PV 128,176,52
EX 36
PV 132,180,52
KR 132,9,12288
VR 172,19,0
PV 136,184,52
EX 37
PV 140,188,52
VR 174,19,4096
CV 50,36,37
PV 144,192,52
EX 38
PV 148,196,52
KR 136,10,12288
KR 140,11,12288
PV 152,200,52
EX 39
PV 156,204,52
CV 51,38,39
LM 212,52
buffer_load_dwordx4 v20, s[12:15], s28 offen offset:0 nt lds
QK 32,80,32,64
EX 40
QK 32,84,36,32
buffer_load_dwordx4 v21, s[12:15], s28 offen offset:1024 nt lds
QK 32,88,40,32
EX 41
QK 32,92,44,32
buffer_load_dwordx4 v22, s[12:15], s28 offen offset:2048 nt lds
QK 36,96,32,64
EX 42
QK 36,100,36,36
buffer_load_dwordx4 v23, s[12:15], s28 offen offset:3072 nt lds
QK 36,104,40,36
EX 43
QK 36,108,44,36
CV 52,40,41
CV 53,42,43
s_waitcnt lgkmcnt(2)
PV 96,144,48
EX 44
PV 100,148,48
s_add_u32 s28, s28, 0x40000
VR 176,12,8192
PV 104,152,48
EX 45
PV 108,156,48
VR 178,12,12288
CV 54,44,45
PV 112,160,48
EX 46
PV 116,164,48
VR 180,13,8192
VR 182,13,12288
PV 120,168,48
EX 47
PV 124,172,48
VR 184,14,8192
CV 55,46,47
LM 208,48
VR 186,14,12288
VR 188,15,8192
s_waitcnt vmcnt(12) lgkmcnt(7)
s_barrier
QK 40,112,0,56
EX 32
QK 40,116,4,40
KR 80,8,16384
KR 84,9,16384
QK 40,120,8,40
EX 33
QK 40,124,12,40
KR 88,10,16384
CV 48,32,33
QK 44,128,0,56
EX 34
QK 44,132,4,44
KR 92,11,16384
s_add_u32 m0, s27, 49152
QK 44,136,8,44
EX 35
QK 44,140,12,44
KR 96,8,20480
CV 49,34,35
PV 128,144,52
EX 36
PV 132,148,52
KR 100,9,20480
KR 104,10,20480
PV 136,152,52
EX 37
PV 140,156,52
KR 108,11,20480
CV 50,36,37
PV 144,160,52
EX 38
PV 148,164,52
buffer_load_dwordx4 v24, s[16:19], s29 offen offset:0 nt lds
PV 152,168,52
EX 39
PV 156,172,52
VR 190,15,12288
CV 51,38,39
LM 212,52
buffer_load_dwordx4 v25, s[16:19], s29 offen offset:1024 nt lds
QK 32,112,16,60
EX 40
QK 32,116,20,32
buffer_load_dwordx4 v26, s[16:19], s29 offen offset:2048 nt lds
QK 32,120,24,32
EX 41
QK 32,124,28,32
buffer_load_dwordx4 v27, s[16:19], s29 offen offset:3072 nt lds
QK 36,128,16,60
EX 42
QK 36,132,20,36
VR 192,16,8192
CV 52,40,41
QK 36,136,24,36
EX 43
QK 36,140,28,36
VR 194,16,12288
CV 53,42,43
PV 160,144,48
EX 44
PV 164,148,48
VR 196,17,8192
VR 198,17,12288
PV 168,152,48
EX 45
PV 172,156,48
VR 200,18,8192
CV 54,44,45
PV 176,160,48
EX 46
PV 180,164,48
VR 202,18,12288
VR 204,19,8192
PV 184,168,48
EX 47
PV 188,172,48
VR 206,19,12288
CV 55,46,47
LM 216,48
s_add_u32 s29, s29, 0x40000
s_add_u32 s71, s71, 1
s_cbranch_scc1 SPEC_V210_0
BODY_V210_1:
s_waitcnt lgkmcnt(9)
QK 40,80,0,56
EX 32
QK 40,84,4,40
VR 144,12,16384
VR 146,12,20480
QK 40,88,8,40
EX 33
QK 40,92,12,40
VR 148,13,16384
CV 48,32,33
QK 44,96,0,56
EX 34
QK 44,100,4,44
VR 150,13,20480
VR 152,14,16384
QK 44,104,8,44
EX 35
QK 44,108,12,44
VR 154,14,20480
CV 49,34,35
s_waitcnt lgkmcnt(6)
PV 96,176,52
EX 36
PV 100,180,52
VR 156,15,16384
VR 158,15,20480
PV 104,184,52
EX 37
PV 108,188,52
VR 160,16,16384
CV 50,36,37
PV 112,192,52
EX 38
PV 116,196,52
VR 162,16,20480
KR 112,8,24576
PV 120,200,52
EX 39
PV 124,204,52
KR 116,9,24576
CV 51,38,39
LM 208,52
VR 164,17,16384
VR 166,17,20480
QK 32,80,16,60
EX 40
QK 32,84,20,32
KR 120,10,24576
KR 124,11,24576
QK 32,88,24,32
EX 41
QK 32,92,28,32
VR 168,18,16384
CV 52,40,41
QK 36,96,16,60
EX 42
QK 36,100,20,36
VR 170,18,20480
s_add_u32 m0, s26, 0
QK 36,104,24,36
EX 43
QK 36,108,28,36
KR 128,8,28672
CV 53,42,43
PV 128,176,48
EX 44
PV 132,180,48
KR 132,9,28672
VR 172,19,16384
PV 136,184,48
EX 45
PV 140,188,48
VR 174,19,20480
CV 54,44,45
PV 144,192,48
EX 46
PV 148,196,48
KR 136,10,28672
KR 140,11,28672
PV 152,200,48
EX 47
PV 156,204,48
CV 55,46,47
LM 212,48
buffer_load_dwordx4 v20, s[12:15], s28 offen offset:0 nt lds
QK 40,80,32,64
EX 32
QK 40,84,36,40
buffer_load_dwordx4 v21, s[12:15], s28 offen offset:1024 nt lds
QK 40,88,40,40
EX 33
QK 40,92,44,40
buffer_load_dwordx4 v22, s[12:15], s28 offen offset:2048 nt lds
QK 44,96,32,64
EX 34
QK 44,100,36,44
buffer_load_dwordx4 v23, s[12:15], s28 offen offset:3072 nt lds
QK 44,104,40,44
EX 35
QK 44,108,44,44
CV 48,32,33
CV 49,34,35
s_waitcnt lgkmcnt(2)
PV 96,144,52
EX 36
PV 100,148,52
s_add_u32 s28, s28, 0x40000
VR 176,12,24576
PV 104,152,52
EX 37
PV 108,156,52
VR 178,12,28672
CV 50,36,37
PV 112,160,52
EX 38
PV 116,164,52
VR 180,13,24576
VR 182,13,28672
PV 120,168,52
EX 39
PV 124,172,52
VR 184,14,24576
CV 51,38,39
LM 208,52
VR 186,14,28672
VR 188,15,24576
s_waitcnt vmcnt(12) lgkmcnt(7)
s_barrier
QK 32,112,0,56
EX 40
QK 32,116,4,32
KR 80,8,32768
KR 84,9,32768
QK 32,120,8,32
EX 41
QK 32,124,12,32
KR 88,10,32768
CV 52,40,41
QK 36,128,0,56
EX 42
QK 36,132,4,36
KR 92,11,32768
s_add_u32 m0, s27, 0
QK 36,136,8,36
EX 43
QK 36,140,12,36
KR 96,8,36864
CV 53,42,43
PV 128,144,48
EX 44
PV 132,148,48
KR 100,9,36864
KR 104,10,36864
PV 136,152,48
EX 45
PV 140,156,48
KR 108,11,36864
CV 54,44,45
PV 144,160,48
EX 46
PV 148,164,48
buffer_load_dwordx4 v24, s[16:19], s29 offen offset:0 nt lds
PV 152,168,48
EX 47
PV 156,172,48
VR 190,15,28672
CV 55,46,47
LM 212,48
buffer_load_dwordx4 v25, s[16:19], s29 offen offset:1024 nt lds
QK 40,112,16,60
EX 32
QK 40,116,20,40
buffer_load_dwordx4 v26, s[16:19], s29 offen offset:2048 nt lds
QK 40,120,24,40
EX 33
QK 40,124,28,40
buffer_load_dwordx4 v27, s[16:19], s29 offen offset:3072 nt lds
QK 44,128,16,60
EX 34
QK 44,132,20,44
VR 192,16,24576
CV 48,32,33
QK 44,136,24,44
EX 35
QK 44,140,28,44
VR 194,16,28672
CV 49,34,35
PV 160,144,52
EX 36
PV 164,148,52
VR 196,17,24576
VR 198,17,28672
PV 168,152,52
EX 37
PV 172,156,52
VR 200,18,24576
CV 50,36,37
PV 176,160,52
EX 38
PV 180,164,52
VR 202,18,28672
VR 204,19,24576
PV 184,168,52
EX 39
PV 188,172,52
VR 206,19,28672
CV 51,38,39
LM 216,52
s_add_u32 s29, s29, 0x40000
s_add_u32 s71, s71, 1
s_cbranch_scc1 SPEC_V210_1
BODY_V210_2:
s_waitcnt lgkmcnt(9)
QK 32,80,0,56
EX 40
QK 32,84,4,32
VR 144,12,32768
VR 146,12,36864
QK 32,88,8,32
EX 41
QK 32,92,12,32
VR 148,13,32768
CV 52,40,41
QK 36,96,0,56
EX 42
QK 36,100,4,36
VR 150,13,36864
VR 152,14,32768
QK 36,104,8,36
EX 43
QK 36,108,12,36
VR 154,14,36864
CV 53,42,43
s_waitcnt lgkmcnt(6)
PV 96,176,48
EX 44
PV 100,180,48
VR 156,15,32768
VR 158,15,36864
PV 104,184,48
EX 45
PV 108,188,48
VR 160,16,32768
CV 54,44,45
PV 112,192,48
EX 46
PV 116,196,48
VR 162,16,36864
KR 112,8,40960
PV 120,200,48
EX 47
PV 124,204,48
KR 116,9,40960
CV 55,46,47
LM 208,48
VR 164,17,32768
VR 166,17,36864
QK 40,80,16,60
EX 32
QK 40,84,20,40
KR 120,10,40960
KR 124,11,40960
QK 40,88,24,40
EX 33
QK 40,92,28,40
VR 168,18,32768
CV 48,32,33
QK 44,96,16,60
EX 34
QK 44,100,20,44
VR 170,18,36864
s_add_u32 m0, s26, 16384
QK 44,104,24,44
EX 35
QK 44,108,28,44
KR 128,8,45056
CV 49,34,35
PV 128,176,52
EX 36
PV 132,180,52
KR 132,9,45056
VR 172,19,32768
PV 136,184,52
EX 37
PV 140,188,52
VR 174,19,36864
CV 50,36,37
PV 144,192,52
EX 38
PV 148,196,52
KR 136,10,45056
KR 140,11,45056
PV 152,200,52
EX 39
PV 156,204,52
CV 51,38,39
LM 212,52
buffer_load_dwordx4 v20, s[12:15], s28 offen offset:0 nt lds
QK 32,80,32,64
EX 40
QK 32,84,36,32
buffer_load_dwordx4 v21, s[12:15], s28 offen offset:1024 nt lds
QK 32,88,40,32
EX 41
QK 32,92,44,32
buffer_load_dwordx4 v22, s[12:15], s28 offen offset:2048 nt lds
QK 36,96,32,64
EX 42
QK 36,100,36,36
buffer_load_dwordx4 v23, s[12:15], s28 offen offset:3072 nt lds
QK 36,104,40,36
EX 43
QK 36,108,44,36
CV 52,40,41
CV 53,42,43
s_waitcnt lgkmcnt(2)
PV 96,144,48
EX 44
PV 100,148,48
s_add_u32 s28, s28, 0x40000
VR 176,12,40960
PV 104,152,48
EX 45
PV 108,156,48
VR 178,12,45056
CV 54,44,45
PV 112,160,48
EX 46
PV 116,164,48
VR 180,13,40960
VR 182,13,45056
PV 120,168,48
EX 47
PV 124,172,48
VR 184,14,40960
CV 55,46,47
LM 208,48
VR 186,14,45056
VR 188,15,40960
s_waitcnt vmcnt(12) lgkmcnt(7)
s_barrier
QK 40,112,0,56
EX 32
QK 40,116,4,40
KR 80,8,49152
KR 84,9,49152
QK 40,120,8,40
EX 33
QK 40,124,12,40
KR 88,10,49152
CV 48,32,33
QK 44,128,0,56
EX 34
QK 44,132,4,44
KR 92,11,49152
s_add_u32 m0, s27, 16384
QK 44,136,8,44
EX 35
QK 44,140,12,44
KR 96,8,53248
CV 49,34,35
PV 128,144,52
EX 36
PV 132,148,52
KR 100,9,53248
KR 104,10,53248
PV 136,152,52
EX 37
PV 140,156,52
KR 108,11,53248
CV 50,36,37
PV 144,160,52
EX 38
PV 148,164,52
buffer_load_dwordx4 v24, s[16:19], s29 offen offset:0 nt lds
PV 152,168,52
EX 39
PV 156,172,52
VR 190,15,45056
CV 51,38,39
LM 212,52
buffer_load_dwordx4 v25, s[16:19], s29 offen offset:1024 nt lds
QK 32,112,16,60
EX 40
QK 32,116,20,32
buffer_load_dwordx4 v26, s[16:19], s29 offen offset:2048 nt lds
QK 32,120,24,32
EX 41
QK 32,124,28,32
buffer_load_dwordx4 v27, s[16:19], s29 offen offset:3072 nt lds
QK 36,128,16,60
EX 42
QK 36,132,20,36
VR 192,16,40960
CV 52,40,41
QK 36,136,24,36
EX 43
QK 36,140,28,36
VR 194,16,45056
CV 53,42,43
PV 160,144,48
EX 44
PV 164,148,48
VR 196,17,40960
VR 198,17,45056
PV 168,152,48
EX 45
PV 172,156,48
VR 200,18,40960
CV 54,44,45
PV 176,160,48
EX 46
PV 180,164,48
VR 202,18,45056
VR 204,19,40960
PV 184,168,48
EX 47
PV 188,172,48
VR 206,19,45056
CV 55,46,47
LM 216,48
s_add_u32 s29, s29, 0x40000
s_add_u32 s71, s71, 1
s_cbranch_scc1 SPEC_V210_2
BODY_V210_3:
s_waitcnt lgkmcnt(9)
QK 40,80,0,56
EX 32
QK 40,84,4,40
VR 144,12,49152
VR 146,12,53248
QK 40,88,8,40
EX 33
QK 40,92,12,40
VR 148,13,49152
CV 48,32,33
QK 44,96,0,56
EX 34
QK 44,100,4,44
VR 150,13,53248
VR 152,14,49152
QK 44,104,8,44
EX 35
QK 44,108,12,44
VR 154,14,53248
CV 49,34,35
s_waitcnt lgkmcnt(6)
PV 96,176,52
EX 36
PV 100,180,52
VR 156,15,49152
VR 158,15,53248
PV 104,184,52
EX 37
PV 108,188,52
VR 160,16,49152
CV 50,36,37
PV 112,192,52
EX 38
PV 116,196,52
VR 162,16,53248
KR 112,8,57344
PV 120,200,52
EX 39
PV 124,204,52
KR 116,9,57344
CV 51,38,39
LM 208,52
VR 164,17,49152
VR 166,17,53248
QK 32,80,16,60
EX 40
QK 32,84,20,32
KR 120,10,57344
KR 124,11,57344
QK 32,88,24,32
EX 41
QK 32,92,28,32
VR 168,18,49152
CV 52,40,41
QK 36,96,16,60
EX 42
QK 36,100,20,36
VR 170,18,53248
s_add_u32 m0, s26, 32768
QK 36,104,24,36
EX 43
QK 36,108,28,36
KR 128,8,61440
CV 53,42,43
PV 128,176,48
EX 44
PV 132,180,48
KR 132,9,61440
VR 172,19,49152
PV 136,184,48
EX 45
PV 140,188,48
VR 174,19,53248
CV 54,44,45
PV 144,192,48
EX 46
PV 148,196,48
KR 136,10,61440
KR 140,11,61440
PV 152,200,48
EX 47
PV 156,204,48
CV 55,46,47
LM 212,48
buffer_load_dwordx4 v20, s[12:15], s28 offen offset:0 nt lds
QK 40,80,32,64
EX 32
QK 40,84,36,40
buffer_load_dwordx4 v21, s[12:15], s28 offen offset:1024 nt lds
QK 40,88,40,40
EX 33
QK 40,92,44,40
buffer_load_dwordx4 v22, s[12:15], s28 offen offset:2048 nt lds
QK 44,96,32,64
EX 34
QK 44,100,36,44
buffer_load_dwordx4 v23, s[12:15], s28 offen offset:3072 nt lds
QK 44,104,40,44
EX 35
QK 44,108,44,44
CV 48,32,33
CV 49,34,35
s_waitcnt lgkmcnt(2)
PV 96,144,52
EX 36
PV 100,148,52
s_add_u32 s28, s28, 0x40000
VR 176,12,57344
PV 104,152,52
EX 37
PV 108,156,52
VR 178,12,61440
CV 50,36,37
PV 112,160,52
EX 38
PV 116,164,52
VR 180,13,57344
VR 182,13,61440
PV 120,168,52
EX 39
PV 124,172,52
VR 184,14,57344
CV 51,38,39
LM 208,52
VR 186,14,61440
VR 188,15,57344
s_waitcnt vmcnt(12) lgkmcnt(7)
s_barrier
QK 32,112,0,56
EX 40
QK 32,116,4,32
KR 80,8,0
KR 84,9,0
QK 32,120,8,32
EX 41
QK 32,124,12,32
KR 88,10,0
CV 52,40,41
QK 36,128,0,56
EX 42
QK 36,132,4,36
KR 92,11,0
s_add_u32 m0, s27, 32768
QK 36,136,8,36
EX 43
QK 36,140,12,36
KR 96,8,4096
CV 53,42,43
PV 128,144,48
EX 44
PV 132,148,48
KR 100,9,4096
KR 104,10,4096
PV 136,152,48
EX 45
PV 140,156,48
KR 108,11,4096
CV 54,44,45
PV 144,160,48
EX 46
PV 148,164,48
buffer_load_dwordx4 v24, s[16:19], s29 offen offset:0 nt lds
PV 152,168,48
EX 47
PV 156,172,48
VR 190,15,61440
CV 55,46,47
LM 212,48
buffer_load_dwordx4 v25, s[16:19], s29 offen offset:1024 nt lds
QK 40,112,16,60
EX 32
QK 40,116,20,40
buffer_load_dwordx4 v26, s[16:19], s29 offen offset:2048 nt lds
QK 40,120,24,40
EX 33
QK 40,124,28,40
buffer_load_dwordx4 v27, s[16:19], s29 offen offset:3072 nt lds
QK 44,128,16,60
EX 34
QK 44,132,20,44
VR 192,16,57344
CV 48,32,33
QK 44,136,24,44
EX 35
QK 44,140,28,44
VR 194,16,61440
CV 49,34,35
PV 160,144,52
EX 36
PV 164,148,52
VR 196,17,57344
VR 198,17,61440
PV 168,152,52
EX 37
PV 172,156,52
VR 200,18,57344
CV 50,36,37
PV 176,160,52
EX 38
PV 180,164,52
VR 202,18,61440
VR 204,19,57344
PV 184,168,52
EX 39
PV 188,172,52
VR 206,19,61440
CV 51,38,39
LM 216,52
s_add_u32 s29, s29, 0x40000
s_add_u32 s71, s71, 1
s_cbranch_scc1 SPEC_V210_3
s_branch BODY_V210_0
SPEC_V210_0:
s_mov_b32 s71, -1
s_add_u32 s77, s77, 1
s_cmp_eq_u32 s77, 3
s_cbranch_scc1 TAIL_V210_1
s_cmp_eq_u32 s77, 2
s_cbranch_scc1 BODY_V210_1
s_mov_b32 s28, s54
s_mov_b32 s29, s54
s_mov_b32 s14, s56
s_mov_b32 s18, s56
s_branch BODY_V210_1
SPEC_V210_1:
s_mov_b32 s71, -1
s_add_u32 s77, s77, 1
s_cmp_eq_u32 s77, 3
s_cbranch_scc1 TAIL_V210_2
s_cmp_eq_u32 s77, 2
s_cbranch_scc1 BODY_V210_2
s_mov_b32 s28, s54
s_mov_b32 s29, s54
s_mov_b32 s14, s56
s_mov_b32 s18, s56
s_branch BODY_V210_2
SPEC_V210_2:
s_mov_b32 s71, -1
s_add_u32 s77, s77, 1
s_cmp_eq_u32 s77, 3
s_cbranch_scc1 TAIL_V210_3
s_cmp_eq_u32 s77, 2
s_cbranch_scc1 BODY_V210_3
s_mov_b32 s28, s54
s_mov_b32 s29, s54
s_mov_b32 s14, s56
s_mov_b32 s18, s56
s_branch BODY_V210_3
SPEC_V210_3:
s_mov_b32 s71, -1
s_add_u32 s77, s77, 1
s_cmp_eq_u32 s77, 3
s_cbranch_scc1 TAIL_V210_0
s_cmp_eq_u32 s77, 2
s_cbranch_scc1 BODY_V210_0
s_mov_b32 s28, s54
s_mov_b32 s29, s54
s_mov_b32 s14, s56
s_mov_b32 s18, s56
s_branch BODY_V210_0
TAIL_V210_0:
s_waitcnt lgkmcnt(9)
QK 32,80,0,56
EX 40
QK 32,84,4,32
VR 144,12,0
VR 146,12,4096
QK 32,88,8,32
EX 41
QK 32,92,12,32
VR 148,13,0
CV 52,40,41
QK 36,96,0,56
EX 42
QK 36,100,4,36
VR 150,13,4096
VR 152,14,0
QK 36,104,8,36
EX 43
QK 36,108,12,36
VR 154,14,4096
CV 53,42,43
s_waitcnt lgkmcnt(6)
PV 96,176,48
EX 44
PV 100,180,48
VR 156,15,0
VR 158,15,4096
PV 104,184,48
EX 45
PV 108,188,48
VR 160,16,0
CV 54,44,45
PV 112,192,48
EX 46
PV 116,196,48
VR 162,16,4096
KR 112,8,8192
PV 120,200,48
EX 47
PV 124,204,48
KR 116,9,8192
CV 55,46,47
LM 208,48
VR 164,17,0
VR 166,17,4096
QK 40,80,16,60
EX 32
QK 40,84,20,40
KR 120,10,8192
KR 124,11,8192
QK 40,88,24,40
EX 33
QK 40,92,28,40
VR 168,18,0
CV 48,32,33
QK 44,96,16,60
EX 34
QK 44,100,20,44
VR 170,18,4096
s_add_u32 m0, s26, 49152
QK 44,104,24,44
EX 35
QK 44,108,28,44
KR 128,8,12288
CV 49,34,35
PV 128,176,52
EX 36
PV 132,180,52
KR 132,9,12288
VR 172,19,0
PV 136,184,52
EX 37
PV 140,188,52
VR 174,19,4096
CV 50,36,37
PV 144,192,52
EX 38
PV 148,196,52
KR 136,10,12288
KR 140,11,12288
PV 152,200,52
EX 39
PV 156,204,52
CV 51,38,39
LM 212,52
buffer_load_dwordx4 v20, s[12:15], s28 offen offset:0 nt lds
QK 32,80,32,64
EX 40
QK 32,84,36,32
buffer_load_dwordx4 v21, s[12:15], s28 offen offset:1024 nt lds
QK 32,88,40,32
EX 41
QK 32,92,44,32
buffer_load_dwordx4 v22, s[12:15], s28 offen offset:2048 nt lds
QK 36,96,32,64
EX 42
QK 36,100,36,36
buffer_load_dwordx4 v23, s[12:15], s28 offen offset:3072 nt lds
QK 36,104,40,36
EX 43
QK 36,108,44,36
CV 52,40,41
CV 53,42,43
s_waitcnt lgkmcnt(2)
PV 96,144,48
EX 44
PV 100,148,48
s_add_u32 s28, s28, 0x40000
VR 176,12,8192
PV 104,152,48
EX 45
PV 108,156,48
VR 178,12,12288
CV 54,44,45
PV 112,160,48
EX 46
PV 116,164,48
VR 180,13,8192
VR 182,13,12288
PV 120,168,48
EX 47
PV 124,172,48
VR 184,14,8192
CV 55,46,47
LM 208,48
VR 186,14,12288
VR 188,15,8192
s_waitcnt vmcnt(12) lgkmcnt(7)
s_barrier
v_add_f32 v40, v56, v76
v_add_f32 v41, v56, v77
v_add_f32 v42, v56, v78
v_add_f32 v43, v56, v79
v_add_f32 v44, v56, v80
v_add_f32 v45, v56, v81
v_add_f32 v46, v56, v82
v_add_f32 v47, v56, v83
s_nop 1
QK 40,112,0,40
EX 32
QK 40,116,4,40
KR 80,8,16384
KR 84,9,16384
QK 40,120,8,40
EX 33
QK 40,124,12,40
KR 88,10,16384
CV 48,32,33
QK 44,128,0,44
EX 34
QK 44,132,4,44
KR 92,11,16384
s_add_u32 m0, s27, 49152
QK 44,136,8,44
EX 35
QK 44,140,12,44
KR 96,8,20480
CV 49,34,35
PV 128,144,52
EX 36
PV 132,148,52
KR 100,9,20480
KR 104,10,20480
PV 136,152,52
EX 37
PV 140,156,52
KR 108,11,20480
CV 50,36,37
PV 144,160,52
EX 38
PV 148,164,52
buffer_load_dwordx4 v24, s[16:19], s29 offen offset:0 nt lds
PV 152,168,52
EX 39
PV 156,172,52
VR 190,15,12288
CV 51,38,39
LM 212,52
buffer_load_dwordx4 v25, s[16:19], s29 offen offset:1024 nt lds
v_add_f32 v32, v60, v76
v_add_f32 v33, v60, v77
v_add_f32 v34, v60, v78
v_add_f32 v35, v60, v79
v_add_f32 v36, v60, v80
v_add_f32 v37, v60, v81
v_add_f32 v38, v60, v82
v_add_f32 v39, v60, v83
s_nop 1
QK 32,112,16,32
EX 40
QK 32,116,20,32
buffer_load_dwordx4 v26, s[16:19], s29 offen offset:2048 nt lds
QK 32,120,24,32
EX 41
QK 32,124,28,32
buffer_load_dwordx4 v27, s[16:19], s29 offen offset:3072 nt lds
QK 36,128,16,36
EX 42
QK 36,132,20,36
VR 192,16,8192
CV 52,40,41
QK 36,136,24,36
EX 43
QK 36,140,28,36
VR 194,16,12288
CV 53,42,43
PV 160,144,48
EX 44
PV 164,148,48
VR 196,17,8192
VR 198,17,12288
PV 168,152,48
EX 45
PV 172,156,48
VR 200,18,8192
CV 54,44,45
PV 176,160,48
EX 46
PV 180,164,48
VR 202,18,12288
VR 204,19,8192
PV 184,168,48
EX 47
PV 188,172,48
VR 206,19,12288
CV 55,46,47
LM 216,48
s_add_u32 s29, s29, 0x40000
s_waitcnt lgkmcnt(0)
PV 96,176,52
EX 32
PV 100,180,52
EX 33
PV 104,184,52
EX 34
PV 108,188,52
EX 35
PV 112,192,52
EX 36
PV 116,196,52
EX 37
PV 120,200,52
EX 38
PV 124,204,52
EX 39
LM 208,52
CV 48,32,33
CV 49,34,35
CV 50,36,37
CV 51,38,39
s_nop 1
LM 212,48
PV 128,176,48
PV 132,180,48
PV 136,184,48
PV 140,188,48
PV 144,192,48
PV 148,196,48
PV 152,200,48
PV 156,204,48
s_mov_b32 s72, 1
s_branch EPI_V210
TAIL_V210_1:
s_waitcnt lgkmcnt(9)
QK 40,80,0,56
EX 32
QK 40,84,4,40
VR 144,12,16384
VR 146,12,20480
QK 40,88,8,40
EX 33
QK 40,92,12,40
VR 148,13,16384
CV 48,32,33
QK 44,96,0,56
EX 34
QK 44,100,4,44
VR 150,13,20480
VR 152,14,16384
QK 44,104,8,44
EX 35
QK 44,108,12,44
VR 154,14,20480
CV 49,34,35
s_waitcnt lgkmcnt(6)
PV 96,176,52
EX 36
PV 100,180,52
VR 156,15,16384
VR 158,15,20480
PV 104,184,52
EX 37
PV 108,188,52
VR 160,16,16384
CV 50,36,37
PV 112,192,52
EX 38
PV 116,196,52
VR 162,16,20480
KR 112,8,24576
PV 120,200,52
EX 39
PV 124,204,52
KR 116,9,24576
CV 51,38,39
LM 208,52
VR 164,17,16384
VR 166,17,20480
QK 32,80,16,60
EX 40
QK 32,84,20,32
KR 120,10,24576
KR 124,11,24576
QK 32,88,24,32
EX 41
QK 32,92,28,32
VR 168,18,16384
CV 52,40,41
QK 36,96,16,60
EX 42
QK 36,100,20,36
VR 170,18,20480
s_add_u32 m0, s26, 0
QK 36,104,24,36
EX 43
QK 36,108,28,36
KR 128,8,28672
CV 53,42,43
PV 128,176,48
EX 44
PV 132,180,48
KR 132,9,28672
VR 172,19,16384
PV 136,184,48
EX 45
PV 140,188,48
VR 174,19,20480
CV 54,44,45
PV 144,192,48
EX 46
PV 148,196,48
KR 136,10,28672
KR 140,11,28672
PV 152,200,48
EX 47
PV 156,204,48
CV 55,46,47
LM 212,48
buffer_load_dwordx4 v20, s[12:15], s28 offen offset:0 nt lds
QK 40,80,32,64
EX 32
QK 40,84,36,40
buffer_load_dwordx4 v21, s[12:15], s28 offen offset:1024 nt lds
QK 40,88,40,40
EX 33
QK 40,92,44,40
buffer_load_dwordx4 v22, s[12:15], s28 offen offset:2048 nt lds
QK 44,96,32,64
EX 34
QK 44,100,36,44
buffer_load_dwordx4 v23, s[12:15], s28 offen offset:3072 nt lds
QK 44,104,40,44
EX 35
QK 44,108,44,44
CV 48,32,33
CV 49,34,35
s_waitcnt lgkmcnt(2)
PV 96,144,52
EX 36
PV 100,148,52
s_add_u32 s28, s28, 0x40000
VR 176,12,24576
PV 104,152,52
EX 37
PV 108,156,52
VR 178,12,28672
CV 50,36,37
PV 112,160,52
EX 38
PV 116,164,52
VR 180,13,24576
VR 182,13,28672
PV 120,168,52
EX 39
PV 124,172,52
VR 184,14,24576
CV 51,38,39
LM 208,52
VR 186,14,28672
VR 188,15,24576
s_waitcnt vmcnt(12) lgkmcnt(7)
s_barrier
v_add_f32 v32, v56, v76
v_add_f32 v33, v56, v77
v_add_f32 v34, v56, v78
v_add_f32 v35, v56, v79
v_add_f32 v36, v56, v80
v_add_f32 v37, v56, v81
v_add_f32 v38, v56, v82
v_add_f32 v39, v56, v83
s_nop 1
QK 32,112,0,32
EX 40
QK 32,116,4,32
KR 80,8,32768
KR 84,9,32768
QK 32,120,8,32
EX 41
QK 32,124,12,32
KR 88,10,32768
CV 52,40,41
QK 36,128,0,36
EX 42
QK 36,132,4,36
KR 92,11,32768
s_add_u32 m0, s27, 0
QK 36,136,8,36
EX 43
QK 36,140,12,36
KR 96,8,36864
CV 53,42,43
PV 128,144,48
EX 44
PV 132,148,48
KR 100,9,36864
KR 104,10,36864
PV 136,152,48
EX 45
PV 140,156,48
KR 108,11,36864
CV 54,44,45
PV 144,160,48
EX 46
PV 148,164,48
buffer_load_dwordx4 v24, s[16:19], s29 offen offset:0 nt lds
PV 152,168,48
EX 47
PV 156,172,48
VR 190,15,28672
CV 55,46,47
LM 212,48
buffer_load_dwordx4 v25, s[16:19], s29 offen offset:1024 nt lds
v_add_f32 v40, v60, v76
v_add_f32 v41, v60, v77
v_add_f32 v42, v60, v78
v_add_f32 v43, v60, v79
v_add_f32 v44, v60, v80
v_add_f32 v45, v60, v81
v_add_f32 v46, v60, v82
v_add_f32 v47, v60, v83
s_nop 1
QK 40,112,16,40
EX 32
QK 40,116,20,40
buffer_load_dwordx4 v26, s[16:19], s29 offen offset:2048 nt lds
QK 40,120,24,40
EX 33
QK 40,124,28,40
buffer_load_dwordx4 v27, s[16:19], s29 offen offset:3072 nt lds
QK 44,128,16,44
EX 34
QK 44,132,20,44
VR 192,16,24576
CV 48,32,33
QK 44,136,24,44
EX 35
QK 44,140,28,44
VR 194,16,28672
CV 49,34,35
PV 160,144,52
EX 36
PV 164,148,52
VR 196,17,24576
VR 198,17,28672
PV 168,152,52
EX 37
PV 172,156,52
VR 200,18,24576
CV 50,36,37
PV 176,160,52
EX 38
PV 180,164,52
VR 202,18,28672
VR 204,19,24576
PV 184,168,52
EX 39
PV 188,172,52
VR 206,19,28672
CV 51,38,39
LM 216,52
s_add_u32 s29, s29, 0x40000
s_waitcnt lgkmcnt(0)
PV 96,176,48
EX 40
PV 100,180,48
EX 41
PV 104,184,48
EX 42
PV 108,188,48
EX 43
PV 112,192,48
EX 44
PV 116,196,48
EX 45
PV 120,200,48
EX 46
PV 124,204,48
EX 47
LM 208,48
CV 52,40,41
CV 53,42,43
CV 54,44,45
CV 55,46,47
s_nop 1
LM 212,52
PV 128,176,52
PV 132,180,52
PV 136,184,52
PV 140,188,52
PV 144,192,52
PV 148,196,52
PV 152,200,52
PV 156,204,52
s_mov_b32 s72, 2
s_branch EPI_V210
TAIL_V210_2:
s_waitcnt lgkmcnt(9)
QK 32,80,0,56
EX 40
QK 32,84,4,32
VR 144,12,32768
VR 146,12,36864
QK 32,88,8,32
EX 41
QK 32,92,12,32
VR 148,13,32768
CV 52,40,41
QK 36,96,0,56
EX 42
QK 36,100,4,36
VR 150,13,36864
VR 152,14,32768
QK 36,104,8,36
EX 43
QK 36,108,12,36
VR 154,14,36864
CV 53,42,43
s_waitcnt lgkmcnt(6)
PV 96,176,48
EX 44
PV 100,180,48
VR 156,15,32768
VR 158,15,36864
PV 104,184,48
EX 45
PV 108,188,48
VR 160,16,32768
CV 54,44,45
PV 112,192,48
EX 46
PV 116,196,48
VR 162,16,36864
KR 112,8,40960
PV 120,200,48
EX 47
PV 124,204,48
KR 116,9,40960
CV 55,46,47
LM 208,48
VR 164,17,32768
VR 166,17,36864
QK 40,80,16,60
EX 32
QK 40,84,20,40
KR 120,10,40960
KR 124,11,40960
QK 40,88,24,40
EX 33
QK 40,92,28,40
VR 168,18,32768
CV 48,32,33
QK 44,96,16,60
EX 34
QK 44,100,20,44
VR 170,18,36864
s_add_u32 m0, s26, 16384
QK 44,104,24,44
EX 35
QK 44,108,28,44
KR 128,8,45056
CV 49,34,35
PV 128,176,52
EX 36
PV 132,180,52
KR 132,9,45056
VR 172,19,32768
PV 136,184,52
EX 37
PV 140,188,52
VR 174,19,36864
CV 50,36,37
PV 144,192,52
EX 38
PV 148,196,52
KR 136,10,45056
KR 140,11,45056
PV 152,200,52
EX 39
PV 156,204,52
CV 51,38,39
LM 212,52
buffer_load_dwordx4 v20, s[12:15], s28 offen offset:0 nt lds
QK 32,80,32,64
EX 40
QK 32,84,36,32
buffer_load_dwordx4 v21, s[12:15], s28 offen offset:1024 nt lds
QK 32,88,40,32
EX 41
QK 32,92,44,32
buffer_load_dwordx4 v22, s[12:15], s28 offen offset:2048 nt lds
QK 36,96,32,64
EX 42
QK 36,100,36,36
buffer_load_dwordx4 v23, s[12:15], s28 offen offset:3072 nt lds
QK 36,104,40,36
EX 43
QK 36,108,44,36
CV 52,40,41
CV 53,42,43
s_waitcnt lgkmcnt(2)
PV 96,144,48
EX 44
PV 100,148,48
s_add_u32 s28, s28, 0x40000
VR 176,12,40960
PV 104,152,48
EX 45
PV 108,156,48
VR 178,12,45056
CV 54,44,45
PV 112,160,48
EX 46
PV 116,164,48
VR 180,13,40960
VR 182,13,45056
PV 120,168,48
EX 47
PV 124,172,48
VR 184,14,40960
CV 55,46,47
LM 208,48
VR 186,14,45056
VR 188,15,40960
s_waitcnt vmcnt(12) lgkmcnt(7)
s_barrier
v_add_f32 v40, v56, v76
v_add_f32 v41, v56, v77
v_add_f32 v42, v56, v78
v_add_f32 v43, v56, v79
v_add_f32 v44, v56, v80
v_add_f32 v45, v56, v81
v_add_f32 v46, v56, v82
v_add_f32 v47, v56, v83
s_nop 1
QK 40,112,0,40
EX 32
QK 40,116,4,40
KR 80,8,49152
KR 84,9,49152
QK 40,120,8,40
EX 33
QK 40,124,12,40
KR 88,10,49152
CV 48,32,33
QK 44,128,0,44
EX 34
QK 44,132,4,44
KR 92,11,49152
s_add_u32 m0, s27, 16384
QK 44,136,8,44
EX 35
QK 44,140,12,44
KR 96,8,53248
CV 49,34,35
PV 128,144,52
EX 36
PV 132,148,52
KR 100,9,53248
KR 104,10,53248
PV 136,152,52
EX 37
PV 140,156,52
KR 108,11,53248
CV 50,36,37
PV 144,160,52
EX 38
PV 148,164,52
buffer_load_dwordx4 v24, s[16:19], s29 offen offset:0 nt lds
PV 152,168,52
EX 39
PV 156,172,52
VR 190,15,45056
CV 51,38,39
LM 212,52
buffer_load_dwordx4 v25, s[16:19], s29 offen offset:1024 nt lds
v_add_f32 v32, v60, v76
v_add_f32 v33, v60, v77
v_add_f32 v34, v60, v78
v_add_f32 v35, v60, v79
v_add_f32 v36, v60, v80
v_add_f32 v37, v60, v81
v_add_f32 v38, v60, v82
v_add_f32 v39, v60, v83
s_nop 1
QK 32,112,16,32
EX 40
QK 32,116,20,32
buffer_load_dwordx4 v26, s[16:19], s29 offen offset:2048 nt lds
QK 32,120,24,32
EX 41
QK 32,124,28,32
buffer_load_dwordx4 v27, s[16:19], s29 offen offset:3072 nt lds
QK 36,128,16,36
EX 42
QK 36,132,20,36
VR 192,16,40960
CV 52,40,41
QK 36,136,24,36
EX 43
QK 36,140,28,36
VR 194,16,45056
CV 53,42,43
PV 160,144,48
EX 44
PV 164,148,48
VR 196,17,40960
VR 198,17,45056
PV 168,152,48
EX 45
PV 172,156,48
VR 200,18,40960
CV 54,44,45
PV 176,160,48
EX 46
PV 180,164,48
VR 202,18,45056
VR 204,19,40960
PV 184,168,48
EX 47
PV 188,172,48
VR 206,19,45056
CV 55,46,47
LM 216,48
s_add_u32 s29, s29, 0x40000
s_waitcnt lgkmcnt(0)
PV 96,176,52
EX 32
PV 100,180,52
EX 33
PV 104,184,52
EX 34
PV 108,188,52
EX 35
PV 112,192,52
EX 36
PV 116,196,52
EX 37
PV 120,200,52
EX 38
PV 124,204,52
EX 39
LM 208,52
CV 48,32,33
CV 49,34,35
CV 50,36,37
CV 51,38,39
s_nop 1
LM 212,48
PV 128,176,48
PV 132,180,48
PV 136,184,48
PV 140,188,48
PV 144,192,48
PV 148,196,48
PV 152,200,48
PV 156,204,48
s_mov_b32 s72, 3
s_branch EPI_V210
TAIL_V210_3:
s_waitcnt lgkmcnt(9)
QK 40,80,0,56
EX 32
QK 40,84,4,40
VR 144,12,49152
VR 146,12,53248
QK 40,88,8,40
EX 33
QK 40,92,12,40
VR 148,13,49152
CV 48,32,33
QK 44,96,0,56
EX 34
QK 44,100,4,44
VR 150,13,53248
VR 152,14,49152
QK 44,104,8,44
EX 35
QK 44,108,12,44
VR 154,14,53248
CV 49,34,35
s_waitcnt lgkmcnt(6)
PV 96,176,52
EX 36
PV 100,180,52
VR 156,15,49152
VR 158,15,53248
PV 104,184,52
EX 37
PV 108,188,52
VR 160,16,49152
CV 50,36,37
PV 112,192,52
EX 38
PV 116,196,52
VR 162,16,53248
KR 112,8,57344
PV 120,200,52
EX 39
PV 124,204,52
KR 116,9,57344
CV 51,38,39
LM 208,52
VR 164,17,49152
VR 166,17,53248
QK 32,80,16,60
EX 40
QK 32,84,20,32
KR 120,10,57344
KR 124,11,57344
QK 32,88,24,32
EX 41
QK 32,92,28,32
VR 168,18,49152
CV 52,40,41
QK 36,96,16,60
EX 42
QK 36,100,20,36
VR 170,18,53248
s_add_u32 m0, s26, 32768
QK 36,104,24,36
EX 43
QK 36,108,28,36
KR 128,8,61440
CV 53,42,43
PV 128,176,48
EX 44
PV 132,180,48
KR 132,9,61440
VR 172,19,49152
PV 136,184,48
EX 45
PV 140,188,48
VR 174,19,53248
CV 54,44,45
PV 144,192,48
EX 46
PV 148,196,48
KR 136,10,61440
KR 140,11,61440
PV 152,200,48
EX 47
PV 156,204,48
CV 55,46,47
LM 212,48
buffer_load_dwordx4 v20, s[12:15], s28 offen offset:0 nt lds
QK 40,80,32,64
EX 32
QK 40,84,36,40
buffer_load_dwordx4 v21, s[12:15], s28 offen offset:1024 nt lds
QK 40,88,40,40
EX 33
QK 40,92,44,40
buffer_load_dwordx4 v22, s[12:15], s28 offen offset:2048 nt lds
QK 44,96,32,64
EX 34
QK 44,100,36,44
buffer_load_dwordx4 v23, s[12:15], s28 offen offset:3072 nt lds
QK 44,104,40,44
EX 35
QK 44,108,44,44
CV 48,32,33
CV 49,34,35
s_waitcnt lgkmcnt(2)
PV 96,144,52
EX 36
PV 100,148,52
s_add_u32 s28, s28, 0x40000
VR 176,12,57344
PV 104,152,52
EX 37
PV 108,156,52
VR 178,12,61440
CV 50,36,37
PV 112,160,52
EX 38
PV 116,164,52
VR 180,13,57344
VR 182,13,61440
PV 120,168,52
EX 39
PV 124,172,52
VR 184,14,57344
CV 51,38,39
LM 208,52
VR 186,14,61440
VR 188,15,57344
s_waitcnt vmcnt(12) lgkmcnt(7)
s_barrier
v_add_f32 v32, v56, v76
v_add_f32 v33, v56, v77
v_add_f32 v34, v56, v78
v_add_f32 v35, v56, v79
v_add_f32 v36, v56, v80
v_add_f32 v37, v56, v81
v_add_f32 v38, v56, v82
v_add_f32 v39, v56, v83
s_nop 1
QK 32,112,0,32
EX 40
QK 32,116,4,32
KR 80,8,0
KR 84,9,0
QK 32,120,8,32
EX 41
QK 32,124,12,32
KR 88,10,0
CV 52,40,41
QK 36,128,0,36
EX 42
QK 36,132,4,36
KR 92,11,0
s_add_u32 m0, s27, 32768
QK 36,136,8,36
EX 43
QK 36,140,12,36
KR 96,8,4096
CV 53,42,43
PV 128,144,48
EX 44
PV 132,148,48
KR 100,9,4096
KR 104,10,4096
PV 136,152,48
EX 45
PV 140,156,48
KR 108,11,4096
CV 54,44,45
PV 144,160,48
EX 46
PV 148,164,48
buffer_load_dwordx4 v24, s[16:19], s29 offen offset:0 nt lds
PV 152,168,48
EX 47
PV 156,172,48
VR 190,15,61440
CV 55,46,47
LM 212,48
buffer_load_dwordx4 v25, s[16:19], s29 offen offset:1024 nt lds
v_add_f32 v40, v60, v76
v_add_f32 v41, v60, v77
v_add_f32 v42, v60, v78
v_add_f32 v43, v60, v79
v_add_f32 v44, v60, v80
v_add_f32 v45, v60, v81
v_add_f32 v46, v60, v82
v_add_f32 v47, v60, v83
s_nop 1
QK 40,112,16,40
EX 32
QK 40,116,20,40
buffer_load_dwordx4 v26, s[16:19], s29 offen offset:2048 nt lds
QK 40,120,24,40
EX 33
QK 40,124,28,40
buffer_load_dwordx4 v27, s[16:19], s29 offen offset:3072 nt lds
QK 44,128,16,44
EX 34
QK 44,132,20,44
VR 192,16,57344
CV 48,32,33
QK 44,136,24,44
EX 35
QK 44,140,28,44
VR 194,16,61440
CV 49,34,35
PV 160,144,52
EX 36
PV 164,148,52
VR 196,17,57344
VR 198,17,61440
PV 168,152,52
EX 37
PV 172,156,52
VR 200,18,57344
CV 50,36,37
PV 176,160,52
EX 38
PV 180,164,52
VR 202,18,61440
VR 204,19,57344
PV 184,168,52
EX 39
PV 188,172,52
VR 206,19,61440
CV 51,38,39
LM 216,52
s_add_u32 s29, s29, 0x40000
s_waitcnt lgkmcnt(0)
PV 96,176,48
EX 40
PV 100,180,48
EX 41
PV 104,184,48
EX 42
PV 108,188,48
EX 43
PV 112,192,48
EX 44
PV 116,196,48
EX 45
PV 120,200,48
EX 46
PV 124,204,48
EX 47
LM 208,48
CV 52,40,41
CV 53,42,43
CV 54,44,45
CV 55,46,47
s_nop 1
LM 212,52
PV 128,176,52
PV 132,180,52
PV 136,184,52
PV 140,188,52
PV 144,192,52
PV 148,196,52
PV 152,200,52
PV 156,204,52
s_mov_b32 s72, 0
EPI_V210:
s_add_u32 s88, s40, 135424
v_mov_b32 v42, s88
v_add_u32 v44, s40, v4
v_add_u32 v45, s40, v3
v_add_u32 v46, s40, v1
v_add_u32 v47, s40, v6
v_add_u32 v48, s40, v5
v_accvgpr_read_b32 v50, a208
v_accvgpr_read_b32 v51, a212
v_accvgpr_read_b32 v52, a216
v_cmp_nge_f32 s[78:79], s76, v50
v_cmp_nge_f32 s[80:81], s76, v51
v_cmp_nge_f32 s[82:83], s76, v52
v_rcp_f32 v32, v50
v_rcp_f32 v34, v51
s_or_b64 s[78:79], s[78:79], s[80:81]
s_or_b64 s[78:79], s[78:79], s[82:83]
s_cmp_lg_u64 s[78:79], 0
s_cselect_b32 s90, 1, 0
v_mov_b32 v43, s90
ds_write_b32 v42, v43
s_nop 3
ds_write_b128 v47, v[176:179] offset:0
ds_write_b128 v47, v[180:183] offset:1024
ds_write_b128 v47, v[184:187] offset:2048
ds_write_b128 v47, v[188:191] offset:3072
ds_write_b32 v48, v52
v_pk_mul_f32 v[96:97], v[96:97], v[32:33] op_sel_hi:[1,0]
v_pk_mul_f32 v[98:99], v[98:99], v[32:33] op_sel_hi:[1,0]
CV 96,96,97
CV 97,98,99
v_pk_mul_f32 v[100:101], v[100:101], v[32:33] op_sel_hi:[1,0]
v_pk_mul_f32 v[102:103], v[102:103], v[32:33] op_sel_hi:[1,0]
CV 100,100,101
CV 101,102,103
v_pk_mul_f32 v[104:105], v[104:105], v[32:33] op_sel_hi:[1,0]
v_pk_mul_f32 v[106:107], v[106:107], v[32:33] op_sel_hi:[1,0]
CV 104,104,105
CV 105,106,107
v_pk_mul_f32 v[108:109], v[108:109], v[32:33] op_sel_hi:[1,0]
v_pk_mul_f32 v[110:111], v[110:111], v[32:33] op_sel_hi:[1,0]
CV 108,108,109
CV 109,110,111
v_pk_mul_f32 v[112:113], v[112:113], v[32:33] op_sel_hi:[1,0]
v_pk_mul_f32 v[114:115], v[114:115], v[32:33] op_sel_hi:[1,0]
CV 112,112,113
CV 113,114,115
v_pk_mul_f32 v[116:117], v[116:117], v[32:33] op_sel_hi:[1,0]
v_pk_mul_f32 v[118:119], v[118:119], v[32:33] op_sel_hi:[1,0]
CV 116,116,117
CV 117,118,119
v_pk_mul_f32 v[120:121], v[120:121], v[32:33] op_sel_hi:[1,0]
v_pk_mul_f32 v[122:123], v[122:123], v[32:33] op_sel_hi:[1,0]
CV 120,120,121
CV 121,122,123
v_pk_mul_f32 v[124:125], v[124:125], v[32:33] op_sel_hi:[1,0]
v_pk_mul_f32 v[126:127], v[126:127], v[32:33] op_sel_hi:[1,0]
CV 124,124,125
CV 125,126,127
s_waitcnt lgkmcnt(0)
s_barrier
ds_read_b32 v43, v28
v_add_u32 v47, 8192, v47
v_add_u32 v48, 8192, v48
ds_read_b128 v[232:235], v47 offset:0
ds_read_b128 v[236:239], v47 offset:1024
ds_read_b128 v[240:243], v47 offset:2048
ds_read_b128 v[244:247], v47 offset:3072
ds_read_b32 v49, v48
v_pk_mul_f32 v[128:129], v[128:129], v[34:35] op_sel_hi:[1,0]
v_pk_mul_f32 v[130:131], v[130:131], v[34:35] op_sel_hi:[1,0]
CV 128,128,129
CV 129,130,131
v_pk_mul_f32 v[132:133], v[132:133], v[34:35] op_sel_hi:[1,0]
v_pk_mul_f32 v[134:135], v[134:135], v[34:35] op_sel_hi:[1,0]
CV 132,132,133
CV 133,134,135
v_pk_mul_f32 v[136:137], v[136:137], v[34:35] op_sel_hi:[1,0]
v_pk_mul_f32 v[138:139], v[138:139], v[34:35] op_sel_hi:[1,0]
CV 136,136,137
CV 137,138,139
v_pk_mul_f32 v[140:141], v[140:141], v[34:35] op_sel_hi:[1,0]
v_pk_mul_f32 v[142:143], v[142:143], v[34:35] op_sel_hi:[1,0]
CV 140,140,141
CV 141,142,143
v_pk_mul_f32 v[144:145], v[144:145], v[34:35] op_sel_hi:[1,0]
v_pk_mul_f32 v[146:147], v[146:147], v[34:35] op_sel_hi:[1,0]
CV 144,144,145
CV 145,146,147
v_pk_mul_f32 v[148:149], v[148:149], v[34:35] op_sel_hi:[1,0]
v_pk_mul_f32 v[150:151], v[150:151], v[34:35] op_sel_hi:[1,0]
CV 148,148,149
CV 149,150,151
v_pk_mul_f32 v[152:153], v[152:153], v[34:35] op_sel_hi:[1,0]
v_pk_mul_f32 v[154:155], v[154:155], v[34:35] op_sel_hi:[1,0]
CV 152,152,153
CV 153,154,155
v_pk_mul_f32 v[156:157], v[156:157], v[34:35] op_sel_hi:[1,0]
v_pk_mul_f32 v[158:159], v[158:159], v[34:35] op_sel_hi:[1,0]
CV 156,156,157
CV 157,158,159
s_waitcnt lgkmcnt(0)
v_cmp_ne_u32 s[86:87], 0, v43
v_add_f32 v49, v49, v52
s_nop 3
s_cmp_lg_u64 s[86:87], 0
s_cselect_b32 s86, 1, 0
s_andn2_b32 s86, s86, s73
s_cmp_lg_u32 s86, 0
s_cbranch_scc1 MAXPASS
s_barrier
ds_write_b64 v44, v[96:97] offset:0
ds_write_b64 v44, v[100:101] offset:32
ds_write_b64 v44, v[104:105] offset:64
ds_write_b64 v44, v[108:109] offset:96
ds_write_b64 v44, v[112:113] offset:128
ds_write_b64 v44, v[116:117] offset:160
ds_write_b64 v44, v[120:121] offset:192
ds_write_b64 v44, v[124:125] offset:224
v_rcp_f32 v36, v49
v_add_f32 v160, v160, v232
v_add_f32 v161, v161, v233
v_add_f32 v162, v162, v234
v_add_f32 v163, v163, v235
v_add_f32 v164, v164, v236
v_add_f32 v165, v165, v237
v_add_f32 v166, v166, v238
v_add_f32 v167, v167, v239
v_add_f32 v168, v168, v240
v_add_f32 v169, v169, v241
v_add_f32 v170, v170, v242
v_add_f32 v171, v171, v243
v_add_f32 v172, v172, v244
v_add_f32 v173, v173, v245
v_add_f32 v174, v174, v246
v_add_f32 v175, v175, v247
EPI_V210_noq:
v_pk_mul_f32 v[160:161], v[160:161], v[36:37] op_sel_hi:[1,0]
v_pk_mul_f32 v[162:163], v[162:163], v[36:37] op_sel_hi:[1,0]
CV 160,160,161
CV 161,162,163
v_pk_mul_f32 v[164:165], v[164:165], v[36:37] op_sel_hi:[1,0]
v_pk_mul_f32 v[166:167], v[166:167], v[36:37] op_sel_hi:[1,0]
CV 164,164,165
CV 165,166,167
v_pk_mul_f32 v[168:169], v[168:169], v[36:37] op_sel_hi:[1,0]
v_pk_mul_f32 v[170:171], v[170:171], v[36:37] op_sel_hi:[1,0]
CV 168,168,169
CV 169,170,171
v_pk_mul_f32 v[172:173], v[172:173], v[36:37] op_sel_hi:[1,0]
v_pk_mul_f32 v[174:175], v[174:175], v[36:37] op_sel_hi:[1,0]
CV 172,172,173
CV 173,174,175
s_waitcnt lgkmcnt(0)
ds_read_b128 v[112:115], v45 offset:0
ds_read_b128 v[116:119], v45 offset:1088
ds_read_b128 v[120:123], v45 offset:2176
ds_read_b128 v[124:127], v45 offset:3264
s_waitcnt lgkmcnt(0)
ds_write_b64 v44, v[128:129] offset:0
ds_write_b64 v44, v[132:133] offset:32
ds_write_b64 v44, v[136:137] offset:64
ds_write_b64 v44, v[140:141] offset:96
ds_write_b64 v44, v[144:145] offset:128
ds_write_b64 v44, v[148:149] offset:160
ds_write_b64 v44, v[152:153] offset:192
ds_write_b64 v44, v[156:157] offset:224
s_add_u32 s87, s49, 0
buffer_store_dwordx4 v[112:115], v29, s[20:23], s87 offen sc1
s_add_u32 s87, s49, 16384
buffer_store_dwordx4 v[116:119], v29, s[20:23], s87 offen sc1
s_add_u32 s87, s49, 32768
buffer_store_dwordx4 v[120:123], v29, s[20:23], s87 offen sc1
s_add_u32 s87, s49, 49152
buffer_store_dwordx4 v[124:127], v29, s[20:23], s87 offen sc1
s_waitcnt lgkmcnt(0)
ds_read_b128 v[144:147], v45 offset:0
ds_read_b128 v[148:151], v45 offset:1088
ds_read_b128 v[152:155], v45 offset:2176
ds_read_b128 v[156:159], v45 offset:3264
s_waitcnt lgkmcnt(0)
ds_write_b64 v44, v[160:161] offset:0
ds_write_b64 v44, v[164:165] offset:32
ds_write_b64 v44, v[168:169] offset:64
ds_write_b64 v44, v[172:173] offset:96
s_add_u32 s87, s50, 0
buffer_store_dwordx4 v[144:147], v29, s[20:23], s87 offen sc1
s_add_u32 s87, s50, 16384
buffer_store_dwordx4 v[148:151], v29, s[20:23], s87 offen sc1
s_add_u32 s87, s50, 32768
buffer_store_dwordx4 v[152:155], v29, s[20:23], s87 offen sc1
s_add_u32 s87, s50, 49152
buffer_store_dwordx4 v[156:159], v29, s[20:23], s87 offen sc1
s_waitcnt lgkmcnt(0)
ds_read_b128 v[176:179], v46 offset:0
ds_read_b128 v[180:183], v46 offset:2176
s_waitcnt lgkmcnt(0)
s_add_u32 s87, s51, 0
buffer_store_dwordx4 v[176:179], v2, s[20:23], s87 offen sc1
s_add_u32 s87, s51, 32768
buffer_store_dwordx4 v[180:183], v2, s[20:23], s87 offen sc1
s_endpgm
PRO_V211:
s_cmp_lg_u32 s73, 0
s_cbranch_scc1 PRO_V211_skipmax
s_waitcnt lgkmcnt(0)
v_mfma_f32_16x16x32_bf16 v[96:99], a[80:83], a[0:3], 0
v_mov_b64 v[160:161], 0
QK 96,84,4,96
v_mov_b64 v[162:163], 0
QK 96,88,8,96
v_mov_b64 v[164:165], 0
QK 96,92,12,96
v_mov_b64 v[166:167], 0
v_mfma_f32_16x16x32_bf16 v[100:103], a[96:99], a[0:3], 0
v_mov_b64 v[168:169], 0
QK 100,100,4,100
v_mov_b64 v[170:171], 0
QK 100,104,8,100
v_mov_b64 v[172:173], 0
QK 100,108,12,100
v_mov_b64 v[174:175], 0
v_mfma_f32_16x16x32_bf16 v[104:107], a[80:83], a[16:19], 0
v_mov_b64 v[176:177], 0
QK 104,84,20,104
v_mov_b64 v[178:179], 0
QK 104,88,24,104
v_mov_b64 v[180:181], 0
QK 104,92,28,104
v_mov_b64 v[182:183], 0
v_mfma_f32_16x16x32_bf16 v[108:111], a[96:99], a[16:19], 0
v_mov_b64 v[184:185], 0
QK 108,100,20,108
v_mov_b64 v[186:187], 0
QK 108,104,24,108
v_mov_b64 v[188:189], 0
QK 108,108,28,108
v_mov_b64 v[190:191], 0
v_mfma_f32_16x16x32_bf16 v[112:115], a[80:83], a[32:35], 0
QK 112,84,36,112
QK 112,88,40,112
QK 112,92,44,112
v_mfma_f32_16x16x32_bf16 v[116:119], a[96:99], a[32:35], 0
QK 116,100,36,116
QK 116,104,40,116
QK 116,108,44,116
s_nop 8
v_max3_f32 v32, v96, v97, v98
v_max3_f32 v33, v104, v105, v106
v_max3_f32 v34, v112, v113, v114
v_max3_f32 v32, v32, v99, v100
v_max3_f32 v33, v33, v107, v108
v_max3_f32 v34, v34, v115, v116
v_max3_f32 v32, v32, v101, v102
v_max3_f32 v33, v33, v109, v110
v_max3_f32 v34, v34, v117, v118
v_max_f32 v32, v32, v103
v_max_f32 v33, v33, v111
v_max_f32 v34, v34, v119
v_mov_b32 v40, v32
v_mov_b32 v41, v33
v_mov_b32 v42, v34
s_nop 1
v_permlane16_swap_b32 v32, v40
v_permlane16_swap_b32 v33, v41
v_permlane16_swap_b32 v34, v42
s_nop 1
v_max_f32 v32, v32, v40
v_max_f32 v33, v33, v41
v_max_f32 v34, v34, v42
v_mov_b32 v40, v32
v_mov_b32 v41, v33
v_mov_b32 v42, v34
s_nop 1
v_permlane32_swap_b32 v32, v40
v_permlane32_swap_b32 v33, v41
v_permlane32_swap_b32 v34, v42
s_nop 1
v_max_f32 v32, v32, v40
v_max_f32 v33, v33, v41
v_max_f32 v34, v34, v42
v_sub_f32 v56, 0, v32
v_sub_f32 v57, 0, v32
v_sub_f32 v58, 0, v32
v_sub_f32 v59, 0, v32
v_sub_f32 v60, 0, v33
v_sub_f32 v61, 0, v33
v_sub_f32 v62, 0, v33
v_sub_f32 v63, 0, v33
v_sub_f32 v64, 0, v34
v_sub_f32 v65, 0, v34
v_sub_f32 v66, 0, v34
v_sub_f32 v67, 0, v34
s_branch PRO_V211_go
PRO_V211_skipmax:
v_mov_b64 v[160:161], 0
v_mov_b64 v[162:163], 0
v_mov_b64 v[164:165], 0
v_mov_b64 v[166:167], 0
v_mov_b64 v[168:169], 0
v_mov_b64 v[170:171], 0
v_mov_b64 v[172:173], 0
v_mov_b64 v[174:175], 0
v_mov_b64 v[176:177], 0
v_mov_b64 v[178:179], 0
v_mov_b64 v[180:181], 0
v_mov_b64 v[182:183], 0
v_mov_b64 v[184:185], 0
v_mov_b64 v[186:187], 0
v_mov_b64 v[188:189], 0
v_mov_b64 v[190:191], 0
s_waitcnt lgkmcnt(0)
PRO_V211_go:
v_mov_b64 v[96:97], 0
v_mov_b64 v[98:99], 0
v_mov_b64 v[100:101], 0
v_mov_b64 v[102:103], 0
v_mov_b64 v[104:105], 0
v_mov_b64 v[106:107], 0
v_mov_b64 v[108:109], 0
v_mov_b64 v[110:111], 0
v_mov_b64 v[112:113], 0
v_mov_b64 v[114:115], 0
v_mov_b64 v[116:117], 0
v_mov_b64 v[118:119], 0
v_mov_b64 v[120:121], 0
v_mov_b64 v[122:123], 0
v_mov_b64 v[124:125], 0
v_mov_b64 v[126:127], 0
v_mov_b64 v[128:129], 0
v_mov_b64 v[130:131], 0
v_mov_b64 v[132:133], 0
v_mov_b64 v[134:135], 0
v_mov_b64 v[136:137], 0
v_mov_b64 v[138:139], 0
v_mov_b64 v[140:141], 0
v_mov_b64 v[142:143], 0
v_mov_b64 v[144:145], 0
v_mov_b64 v[146:147], 0
v_mov_b64 v[148:149], 0
v_mov_b64 v[150:151], 0
v_mov_b64 v[152:153], 0
v_mov_b64 v[154:155], 0
v_mov_b64 v[156:157], 0
v_mov_b64 v[158:159], 0
v_mov_b32 v32, v31
v_mov_b32 v33, v31
v_mov_b32 v34, v31
v_mov_b32 v35, v31
v_mov_b32 v36, v31
v_mov_b32 v37, v31
v_mov_b32 v38, v31
v_mov_b32 v39, v31
v_mov_b32 v40, v31
v_mov_b32 v41, v31
v_mov_b32 v42, v31
v_mov_b32 v43, v31
v_mov_b32 v44, v31
v_mov_b32 v45, v31
v_mov_b32 v46, v31
v_mov_b32 v47, v31
v_mov_b64 v[48:49], 0
v_mov_b64 v[50:51], 0
v_mov_b64 v[52:53], 0
v_mov_b64 v[54:55], 0
s_sub_u32 s71, 3, s45
s_mov_b32 s77, 0
s_sub_u32 s37, s2, s2
s_cmp_eq_u32 s57, 0
s_cselect_b32 s36, 1, -3
s_cmp_eq_u32 s72, 1
s_cbranch_scc1 BODY_V211_1
s_cmp_eq_u32 s72, 2
s_cbranch_scc1 BODY_V211_2
s_cmp_eq_u32 s72, 3
s_cbranch_scc1 BODY_V211_3
BODY_V211_0:
s_waitcnt lgkmcnt(0)
QK 32,80,0,56
EX 40
QK 32,84,4,32
KR 112,8,8192
KR 116,9,8192
QK 32,88,8,32
EX 41
QK 32,92,12,32
KR 120,10,8192
CV 52,40,41
QK 36,96,0,56
EX 42
QK 36,100,4,36
KR 124,11,8192
s_add_u32 m0, s26, 49152
QK 36,104,8,36
EX 43
QK 36,108,12,36
KR 128,8,12288
CV 53,42,43
PV 128,176,48
EX 44
PV 132,180,48
KR 132,9,12288
KR 136,10,12288
PV 136,184,48
EX 45
PV 140,188,48
KR 140,11,12288
CV 54,44,45
PV 144,192,48
EX 46
PV 148,196,48
buffer_load_dwordx4 v20, s[12:15], s28 offen offset:0 nt lds
PV 152,200,48
EX 47
PV 156,204,48
VR 144,12,0
CV 55,46,47
LM 212,48
buffer_load_dwordx4 v21, s[12:15], s28 offen offset:1024 nt lds
QK 40,80,16,60
EX 32
QK 40,84,20,40
buffer_load_dwordx4 v22, s[12:15], s28 offen offset:2048 nt lds
QK 40,88,24,40
EX 33
QK 40,92,28,40
buffer_load_dwordx4 v23, s[12:15], s28 offen offset:3072 nt lds
QK 44,96,16,60
EX 34
QK 44,100,20,44
VR 146,12,4096
CV 48,32,33
QK 44,104,24,44
EX 35
QK 44,108,28,44
s_add_u32 s28, s28, 0x40000
CV 49,34,35
PV 160,176,52
EX 36
PV 164,180,52
VR 148,13,0
VR 150,13,4096
PV 168,184,52
EX 37
PV 172,188,52
VR 152,14,0
CV 50,36,37
PV 176,192,52
EX 38
PV 180,196,52
VR 154,14,4096
VR 156,15,0
PV 184,200,52
EX 39
PV 188,204,52
VR 158,15,4096
CV 51,38,39
LM 216,52
VR 160,16,0
VR 162,16,4096
s_waitcnt vmcnt(12) lgkmcnt(10)
s_barrier
QK 32,112,0,56
EX 40
QK 32,116,4,32
VR 164,17,0
VR 166,17,4096
QK 32,120,8,32
EX 41
QK 32,124,12,32
VR 168,18,0
VR 170,18,4096
QK 36,128,0,56
EX 42
QK 36,132,4,36
VR 172,19,0
VR 174,19,4096
QK 36,136,8,36
EX 43
QK 36,140,12,36
CV 52,40,41
CV 53,42,43
s_waitcnt lgkmcnt(0)
PV 96,144,48
EX 44
PV 100,148,48
VR 176,12,8192
VR 178,12,12288
PV 104,152,48
EX 45
PV 108,156,48
VR 180,13,8192
CV 54,44,45
PV 112,160,48
EX 46
PV 116,164,48
VR 182,13,12288
VR 184,14,8192
PV 120,168,48
EX 47
PV 124,172,48
VR 186,14,12288
CV 55,46,47
LM 208,48
VR 188,15,8192
VR 190,15,12288
QK 40,112,16,60
EX 32
QK 40,116,20,40
VR 192,16,8192
VR 194,16,12288
QK 40,120,24,40
EX 33
QK 40,124,28,40
KR 80,8,16384
CV 48,32,33
QK 44,128,16,60
EX 34
QK 44,132,20,44
KR 84,9,16384
VR 196,17,8192
QK 44,136,24,44
EX 35
QK 44,140,28,44
VR 198,17,12288
CV 49,34,35
PV 128,144,52
EX 36
PV 132,148,52
KR 88,10,16384
KR 92,11,16384
PV 136,152,52
EX 37
PV 140,156,52
VR 200,18,8192
CV 50,36,37
PV 144,160,52
EX 38
PV 148,164,52
VR 202,18,12288
s_add_u32 m0, s27, 49152
PV 152,168,52
EX 39
PV 156,172,52
KR 96,8,20480
CV 51,38,39
LM 212,52
KR 100,9,20480
VR 204,19,8192
QK 32,112,32,64
EX 40
QK 32,116,36,32
VR 206,19,12288
KR 104,10,20480
QK 32,120,40,32
EX 41
QK 32,124,44,32
KR 108,11,20480
CV 52,40,41
QK 36,128,32,64
EX 42
QK 36,132,36,36
buffer_load_dwordx4 v24, s[16:19], s29 offen offset:0 nt lds
QK 36,136,40,36
EX 43
QK 36,140,44,36
buffer_load_dwordx4 v25, s[16:19], s29 offen offset:1024 nt lds
s_waitcnt lgkmcnt(2)
PV 96,176,48
EX 44
PV 100,180,48
buffer_load_dwordx4 v26, s[16:19], s29 offen offset:2048 nt lds
PV 104,184,48
EX 45
PV 108,188,48
buffer_load_dwordx4 v27, s[16:19], s29 offen offset:3072 nt lds
PV 112,192,48
EX 46
PV 116,196,48
CV 53,42,43
CV 54,44,45
PV 120,200,48
EX 47
PV 124,204,48
s_add_u32 s29, s29, 0x40000
CV 55,46,47
LM 208,48
s_add_u32 s71, s71, 1
s_cbranch_scc1 SPEC_V211_0
BODY_V211_1:
s_waitcnt lgkmcnt(0)
QK 40,80,0,56
EX 32
QK 40,84,4,40
KR 112,8,24576
KR 116,9,24576
QK 40,88,8,40
EX 33
QK 40,92,12,40
KR 120,10,24576
CV 48,32,33
QK 44,96,0,56
EX 34
QK 44,100,4,44
KR 124,11,24576
s_add_u32 m0, s26, 0
QK 44,104,8,44
EX 35
QK 44,108,12,44
KR 128,8,28672
CV 49,34,35
PV 128,176,52
EX 36
PV 132,180,52
KR 132,9,28672
KR 136,10,28672
PV 136,184,52
EX 37
PV 140,188,52
KR 140,11,28672
CV 50,36,37
PV 144,192,52
EX 38
PV 148,196,52
buffer_load_dwordx4 v20, s[12:15], s28 offen offset:0 nt lds
PV 152,200,52
EX 39
PV 156,204,52
VR 144,12,16384
CV 51,38,39
LM 212,52
buffer_load_dwordx4 v21, s[12:15], s28 offen offset:1024 nt lds
QK 32,80,16,60
EX 40
QK 32,84,20,32
buffer_load_dwordx4 v22, s[12:15], s28 offen offset:2048 nt lds
QK 32,88,24,32
EX 41
QK 32,92,28,32
buffer_load_dwordx4 v23, s[12:15], s28 offen offset:3072 nt lds
QK 36,96,16,60
EX 42
QK 36,100,20,36
VR 146,12,20480
CV 52,40,41
QK 36,104,24,36
EX 43
QK 36,108,28,36
s_add_u32 s28, s28, 0x40000
CV 53,42,43
PV 160,176,48
EX 44
PV 164,180,48
VR 148,13,16384
VR 150,13,20480
PV 168,184,48
EX 45
PV 172,188,48
VR 152,14,16384
CV 54,44,45
PV 176,192,48
EX 46
PV 180,196,48
VR 154,14,20480
VR 156,15,16384
PV 184,200,48
EX 47
PV 188,204,48
VR 158,15,20480
CV 55,46,47
LM 216,48
VR 160,16,16384
VR 162,16,20480
s_waitcnt vmcnt(12) lgkmcnt(10)
s_barrier
QK 40,112,0,56
EX 32
QK 40,116,4,40
VR 164,17,16384
VR 166,17,20480
QK 40,120,8,40
EX 33
QK 40,124,12,40
VR 168,18,16384
VR 170,18,20480
QK 44,128,0,56
EX 34
QK 44,132,4,44
VR 172,19,16384
VR 174,19,20480
QK 44,136,8,44
EX 35
QK 44,140,12,44
CV 48,32,33
CV 49,34,35
s_waitcnt lgkmcnt(0)
PV 96,144,52
EX 36
PV 100,148,52
VR 176,12,24576
VR 178,12,28672
PV 104,152,52
EX 37
PV 108,156,52
VR 180,13,24576
CV 50,36,37
PV 112,160,52
EX 38
PV 116,164,52
VR 182,13,28672
VR 184,14,24576
PV 120,168,52
EX 39
PV 124,172,52
VR 186,14,28672
CV 51,38,39
LM 208,52
VR 188,15,24576
VR 190,15,28672
QK 32,112,16,60
EX 40
QK 32,116,20,32
VR 192,16,24576
VR 194,16,28672
QK 32,120,24,32
EX 41
QK 32,124,28,32
KR 80,8,32768
CV 52,40,41
QK 36,128,16,60
EX 42
QK 36,132,20,36
KR 84,9,32768
VR 196,17,24576
QK 36,136,24,36
EX 43
QK 36,140,28,36
VR 198,17,28672
CV 53,42,43
PV 128,144,48
EX 44
PV 132,148,48
KR 88,10,32768
KR 92,11,32768
PV 136,152,48
EX 45
PV 140,156,48
VR 200,18,24576
CV 54,44,45
PV 144,160,48
EX 46
PV 148,164,48
VR 202,18,28672
s_add_u32 m0, s27, 0
PV 152,168,48
EX 47
PV 156,172,48
KR 96,8,36864
CV 55,46,47
LM 212,48
KR 100,9,36864
VR 204,19,24576
QK 40,112,32,64
EX 32
QK 40,116,36,40
VR 206,19,28672
KR 104,10,36864
QK 40,120,40,40
EX 33
QK 40,124,44,40
KR 108,11,36864
CV 48,32,33
QK 44,128,32,64
EX 34
QK 44,132,36,44
buffer_load_dwordx4 v24, s[16:19], s29 offen offset:0 nt lds
QK 44,136,40,44
EX 35
QK 44,140,44,44
buffer_load_dwordx4 v25, s[16:19], s29 offen offset:1024 nt lds
s_waitcnt lgkmcnt(2)
PV 96,176,52
EX 36
PV 100,180,52
buffer_load_dwordx4 v26, s[16:19], s29 offen offset:2048 nt lds
PV 104,184,52
EX 37
PV 108,188,52
buffer_load_dwordx4 v27, s[16:19], s29 offen offset:3072 nt lds
PV 112,192,52
EX 38
PV 116,196,52
CV 49,34,35
CV 50,36,37
PV 120,200,52
EX 39
PV 124,204,52
s_add_u32 s29, s29, 0x40000
CV 51,38,39
LM 208,52
s_add_u32 s71, s71, 1
s_cbranch_scc1 SPEC_V211_1
BODY_V211_2:
s_waitcnt lgkmcnt(0)
QK 32,80,0,56
EX 40
QK 32,84,4,32
KR 112,8,40960
KR 116,9,40960
QK 32,88,8,32
EX 41
QK 32,92,12,32
KR 120,10,40960
CV 52,40,41
QK 36,96,0,56
EX 42
QK 36,100,4,36
KR 124,11,40960
s_add_u32 m0, s26, 16384
QK 36,104,8,36
EX 43
QK 36,108,12,36
KR 128,8,45056
CV 53,42,43
PV 128,176,48
EX 44
PV 132,180,48
KR 132,9,45056
KR 136,10,45056
PV 136,184,48
EX 45
PV 140,188,48
KR 140,11,45056
CV 54,44,45
PV 144,192,48
EX 46
PV 148,196,48
buffer_load_dwordx4 v20, s[12:15], s28 offen offset:0 nt lds
PV 152,200,48
EX 47
PV 156,204,48
VR 144,12,32768
CV 55,46,47
LM 212,48
buffer_load_dwordx4 v21, s[12:15], s28 offen offset:1024 nt lds
QK 40,80,16,60
EX 32
QK 40,84,20,40
buffer_load_dwordx4 v22, s[12:15], s28 offen offset:2048 nt lds
QK 40,88,24,40
EX 33
QK 40,92,28,40
buffer_load_dwordx4 v23, s[12:15], s28 offen offset:3072 nt lds
QK 44,96,16,60
EX 34
QK 44,100,20,44
VR 146,12,36864
CV 48,32,33
QK 44,104,24,44
EX 35
QK 44,108,28,44
s_add_u32 s28, s28, 0x40000
CV 49,34,35
PV 160,176,52
EX 36
PV 164,180,52
VR 148,13,32768
VR 150,13,36864
PV 168,184,52
EX 37
PV 172,188,52
VR 152,14,32768
CV 50,36,37
PV 176,192,52
EX 38
PV 180,196,52
VR 154,14,36864
VR 156,15,32768
PV 184,200,52
EX 39
PV 188,204,52
VR 158,15,36864
CV 51,38,39
LM 216,52
VR 160,16,32768
VR 162,16,36864
s_waitcnt vmcnt(12) lgkmcnt(10)
s_barrier
QK 32,112,0,56
EX 40
QK 32,116,4,32
VR 164,17,32768
VR 166,17,36864
QK 32,120,8,32
EX 41
QK 32,124,12,32
VR 168,18,32768
VR 170,18,36864
QK 36,128,0,56
EX 42
QK 36,132,4,36
VR 172,19,32768
VR 174,19,36864
QK 36,136,8,36
EX 43
QK 36,140,12,36
CV 52,40,41
CV 53,42,43
s_waitcnt lgkmcnt(0)
PV 96,144,48
EX 44
PV 100,148,48
VR 176,12,40960
VR 178,12,45056
PV 104,152,48
EX 45
PV 108,156,48
VR 180,13,40960
CV 54,44,45
PV 112,160,48
EX 46
PV 116,164,48
VR 182,13,45056
VR 184,14,40960
PV 120,168,48
EX 47
PV 124,172,48
VR 186,14,45056
CV 55,46,47
LM 208,48
VR 188,15,40960
VR 190,15,45056
QK 40,112,16,60
EX 32
QK 40,116,20,40
VR 192,16,40960
VR 194,16,45056
QK 40,120,24,40
EX 33
QK 40,124,28,40
KR 80,8,49152
CV 48,32,33
QK 44,128,16,60
EX 34
QK 44,132,20,44
KR 84,9,49152
VR 196,17,40960
QK 44,136,24,44
EX 35
QK 44,140,28,44
VR 198,17,45056
CV 49,34,35
PV 128,144,52
EX 36
PV 132,148,52
KR 88,10,49152
KR 92,11,49152
PV 136,152,52
EX 37
PV 140,156,52
VR 200,18,40960
CV 50,36,37
PV 144,160,52
EX 38
PV 148,164,52
VR 202,18,45056
s_add_u32 m0, s27, 16384
PV 152,168,52
EX 39
PV 156,172,52
KR 96,8,53248
CV 51,38,39
LM 212,52
KR 100,9,53248
VR 204,19,40960
QK 32,112,32,64
EX 40
QK 32,116,36,32
VR 206,19,45056
KR 104,10,53248
QK 32,120,40,32
EX 41
QK 32,124,44,32
KR 108,11,53248
CV 52,40,41
QK 36,128,32,64
EX 42
QK 36,132,36,36
buffer_load_dwordx4 v24, s[16:19], s29 offen offset:0 nt lds
QK 36,136,40,36
EX 43
QK 36,140,44,36
buffer_load_dwordx4 v25, s[16:19], s29 offen offset:1024 nt lds
s_waitcnt lgkmcnt(2)
PV 96,176,48
EX 44
PV 100,180,48
buffer_load_dwordx4 v26, s[16:19], s29 offen offset:2048 nt lds
PV 104,184,48
EX 45
PV 108,188,48
buffer_load_dwordx4 v27, s[16:19], s29 offen offset:3072 nt lds
PV 112,192,48
EX 46
PV 116,196,48
CV 53,42,43
CV 54,44,45
PV 120,200,48
EX 47
PV 124,204,48
s_add_u32 s29, s29, 0x40000
CV 55,46,47
LM 208,48
s_add_u32 s71, s71, 1
s_cbranch_scc1 SPEC_V211_2
BODY_V211_3:
s_waitcnt lgkmcnt(0)
QK 40,80,0,56
EX 32
QK 40,84,4,40
KR 112,8,57344
KR 116,9,57344
QK 40,88,8,40
EX 33
QK 40,92,12,40
KR 120,10,57344
CV 48,32,33
QK 44,96,0,56
EX 34
QK 44,100,4,44
KR 124,11,57344
s_add_u32 m0, s26, 32768
QK 44,104,8,44
EX 35
QK 44,108,12,44
KR 128,8,61440
CV 49,34,35
PV 128,176,52
EX 36
PV 132,180,52
KR 132,9,61440
KR 136,10,61440
PV 136,184,52
EX 37
PV 140,188,52
KR 140,11,61440
CV 50,36,37
PV 144,192,52
EX 38
PV 148,196,52
buffer_load_dwordx4 v20, s[12:15], s28 offen offset:0 nt lds
PV 152,200,52
EX 39
PV 156,204,52
VR 144,12,49152
CV 51,38,39
LM 212,52
buffer_load_dwordx4 v21, s[12:15], s28 offen offset:1024 nt lds
QK 32,80,16,60
EX 40
QK 32,84,20,32
buffer_load_dwordx4 v22, s[12:15], s28 offen offset:2048 nt lds
QK 32,88,24,32
EX 41
QK 32,92,28,32
buffer_load_dwordx4 v23, s[12:15], s28 offen offset:3072 nt lds
QK 36,96,16,60
EX 42
QK 36,100,20,36
VR 146,12,53248
CV 52,40,41
QK 36,104,24,36
EX 43
QK 36,108,28,36
s_add_u32 s28, s28, 0x40000
CV 53,42,43
PV 160,176,48
EX 44
PV 164,180,48
VR 148,13,49152
VR 150,13,53248
PV 168,184,48
EX 45
PV 172,188,48
VR 152,14,49152
CV 54,44,45
PV 176,192,48
EX 46
PV 180,196,48
VR 154,14,53248
VR 156,15,49152
PV 184,200,48
EX 47
PV 188,204,48
VR 158,15,53248
CV 55,46,47
LM 216,48
VR 160,16,49152
VR 162,16,53248
s_waitcnt vmcnt(12) lgkmcnt(10)
s_barrier
QK 40,112,0,56
EX 32
QK 40,116,4,40
VR 164,17,49152
VR 166,17,53248
QK 40,120,8,40
EX 33
QK 40,124,12,40
VR 168,18,49152
VR 170,18,53248
QK 44,128,0,56
EX 34
QK 44,132,4,44
VR 172,19,49152
VR 174,19,53248
QK 44,136,8,44
EX 35
QK 44,140,12,44
CV 48,32,33
CV 49,34,35
s_waitcnt lgkmcnt(0)
PV 96,144,52
EX 36
PV 100,148,52
VR 176,12,57344
VR 178,12,61440
PV 104,152,52
EX 37
PV 108,156,52
VR 180,13,57344
CV 50,36,37
PV 112,160,52
EX 38
PV 116,164,52
VR 182,13,61440
VR 184,14,57344
PV 120,168,52
EX 39
PV 124,172,52
VR 186,14,61440
CV 51,38,39
LM 208,52
VR 188,15,57344
VR 190,15,61440
QK 32,112,16,60
EX 40
QK 32,116,20,32
VR 192,16,57344
VR 194,16,61440
QK 32,120,24,32
EX 41
QK 32,124,28,32
KR 80,8,0
CV 52,40,41
QK 36,128,16,60
EX 42
QK 36,132,20,36
KR 84,9,0
VR 196,17,57344
QK 36,136,24,36
EX 43
QK 36,140,28,36
VR 198,17,61440
CV 53,42,43
PV 128,144,48
EX 44
PV 132,148,48
KR 88,10,0
KR 92,11,0
PV 136,152,48
EX 45
PV 140,156,48
VR 200,18,57344
CV 54,44,45
PV 144,160,48
EX 46
PV 148,164,48
VR 202,18,61440
s_add_u32 m0, s27, 32768
PV 152,168,48
EX 47
PV 156,172,48
KR 96,8,4096
CV 55,46,47
LM 212,48
KR 100,9,4096
VR 204,19,57344
QK 40,112,32,64
EX 32
QK 40,116,36,40
VR 206,19,61440
KR 104,10,4096
QK 40,120,40,40
EX 33
QK 40,124,44,40
KR 108,11,4096
CV 48,32,33
QK 44,128,32,64
EX 34
QK 44,132,36,44
buffer_load_dwordx4 v24, s[16:19], s29 offen offset:0 nt lds
QK 44,136,40,44
EX 35
QK 44,140,44,44
buffer_load_dwordx4 v25, s[16:19], s29 offen offset:1024 nt lds
s_waitcnt lgkmcnt(2)
PV 96,176,52
EX 36
PV 100,180,52
buffer_load_dwordx4 v26, s[16:19], s29 offen offset:2048 nt lds
PV 104,184,52
EX 37
PV 108,188,52
buffer_load_dwordx4 v27, s[16:19], s29 offen offset:3072 nt lds
PV 112,192,52
EX 38
PV 116,196,52
CV 49,34,35
CV 50,36,37
PV 120,200,52
EX 39
PV 124,204,52
s_add_u32 s29, s29, 0x40000
CV 51,38,39
LM 208,52
s_add_u32 s71, s71, 1
s_cbranch_scc1 SPEC_V211_3
s_branch BODY_V211_0
SPEC_V211_0:
s_mov_b32 s71, -1
s_add_u32 s77, s77, 1
s_cmp_eq_u32 s77, 3
s_cbranch_scc1 TAIL_V211_1
s_cmp_eq_u32 s77, 2
s_cbranch_scc1 BODY_V211_1
s_mov_b32 s28, s54
s_mov_b32 s29, s54
s_mov_b32 s14, s56
s_mov_b32 s18, s56
s_branch BODY_V211_1
SPEC_V211_1:
s_mov_b32 s71, -1
s_add_u32 s77, s77, 1
s_cmp_eq_u32 s77, 3
s_cbranch_scc1 TAIL_V211_2
s_cmp_eq_u32 s77, 2
s_cbranch_scc1 BODY_V211_2
s_mov_b32 s28, s54
s_mov_b32 s29, s54
s_mov_b32 s14, s56
s_mov_b32 s18, s56
s_branch BODY_V211_2
SPEC_V211_2:
s_mov_b32 s71, -1
s_add_u32 s77, s77, 1
s_cmp_eq_u32 s77, 3
s_cbranch_scc1 TAIL_V211_3
s_cmp_eq_u32 s77, 2
s_cbranch_scc1 BODY_V211_3
s_mov_b32 s28, s54
s_mov_b32 s29, s54
s_mov_b32 s14, s56
s_mov_b32 s18, s56
s_branch BODY_V211_3
SPEC_V211_3:
s_mov_b32 s71, -1
s_add_u32 s77, s77, 1
s_cmp_eq_u32 s77, 3
s_cbranch_scc1 TAIL_V211_0
s_cmp_eq_u32 s77, 2
s_cbranch_scc1 BODY_V211_0
s_mov_b32 s28, s54
s_mov_b32 s29, s54
s_mov_b32 s14, s56
s_mov_b32 s18, s56
s_branch BODY_V211_0
TAIL_V211_0:
s_waitcnt lgkmcnt(0)
QK 32,80,0,56
EX 40
QK 32,84,4,32
KR 112,8,8192
KR 116,9,8192
QK 32,88,8,32
EX 41
QK 32,92,12,32
KR 120,10,8192
CV 52,40,41
QK 36,96,0,56
EX 42
QK 36,100,4,36
KR 124,11,8192
s_add_u32 m0, s26, 49152
QK 36,104,8,36
EX 43
QK 36,108,12,36
KR 128,8,12288
CV 53,42,43
PV 128,176,48
EX 44
PV 132,180,48
KR 132,9,12288
KR 136,10,12288
PV 136,184,48
EX 45
PV 140,188,48
KR 140,11,12288
CV 54,44,45
PV 144,192,48
EX 46
PV 148,196,48
buffer_load_dwordx4 v20, s[12:15], s28 offen offset:0 nt lds
PV 152,200,48
EX 47
PV 156,204,48
VR 144,12,0
CV 55,46,47
LM 212,48
buffer_load_dwordx4 v21, s[12:15], s28 offen offset:1024 nt lds
QK 40,80,16,60
EX 32
QK 40,84,20,40
buffer_load_dwordx4 v22, s[12:15], s28 offen offset:2048 nt lds
QK 40,88,24,40
EX 33
QK 40,92,28,40
buffer_load_dwordx4 v23, s[12:15], s28 offen offset:3072 nt lds
QK 44,96,16,60
EX 34
QK 44,100,20,44
VR 146,12,4096
CV 48,32,33
QK 44,104,24,44
EX 35
QK 44,108,28,44
s_add_u32 s28, s28, 0x40000
CV 49,34,35
PV 160,176,52
EX 36
PV 164,180,52
VR 148,13,0
VR 150,13,4096
PV 168,184,52
EX 37
PV 172,188,52
VR 152,14,0
CV 50,36,37
PV 176,192,52
EX 38
PV 180,196,52
VR 154,14,4096
VR 156,15,0
PV 184,200,52
EX 39
PV 188,204,52
VR 158,15,4096
CV 51,38,39
LM 216,52
VR 160,16,0
VR 162,16,4096
s_waitcnt vmcnt(12) lgkmcnt(10)
s_barrier
v_add_f32 v32, v56, v76
v_add_f32 v33, v56, v77
v_add_f32 v34, v56, v78
v_add_f32 v35, v56, v79
v_add_f32 v36, v56, v80
v_add_f32 v37, v56, v81
v_add_f32 v38, v56, v82
v_add_f32 v39, v56, v83
s_nop 1
QK 32,112,0,32
EX 40
QK 32,116,4,32
VR 164,17,0
VR 166,17,4096
QK 32,120,8,32
EX 41
QK 32,124,12,32
VR 168,18,0
VR 170,18,4096
QK 36,128,0,36
EX 42
QK 36,132,4,36
VR 172,19,0
VR 174,19,4096
QK 36,136,8,36
EX 43
QK 36,140,12,36
CV 52,40,41
CV 53,42,43
s_waitcnt lgkmcnt(0)
PV 96,144,48
EX 44
PV 100,148,48
VR 176,12,8192
VR 178,12,12288
PV 104,152,48
EX 45
PV 108,156,48
VR 180,13,8192
CV 54,44,45
PV 112,160,48
EX 46
PV 116,164,48
VR 182,13,12288
VR 184,14,8192
PV 120,168,48
EX 47
PV 124,172,48
VR 186,14,12288
CV 55,46,47
LM 208,48
VR 188,15,8192
VR 190,15,12288
v_add_f32 v40, v60, v76
v_add_f32 v41, v60, v77
v_add_f32 v42, v60, v78
v_add_f32 v43, v60, v79
v_add_f32 v44, v60, v80
v_add_f32 v45, v60, v81
v_add_f32 v46, v60, v82
v_add_f32 v47, v60, v83
s_nop 1
QK 40,112,16,40
EX 32
QK 40,116,20,40
VR 192,16,8192
VR 194,16,12288
QK 40,120,24,40
EX 33
QK 40,124,28,40
KR 80,8,16384
CV 48,32,33
QK 44,128,16,44
EX 34
QK 44,132,20,44
KR 84,9,16384
VR 196,17,8192
QK 44,136,24,44
EX 35
QK 44,140,28,44
VR 198,17,12288
CV 49,34,35
PV 128,144,52
EX 36
PV 132,148,52
KR 88,10,16384
KR 92,11,16384
PV 136,152,52
EX 37
PV 140,156,52
VR 200,18,8192
CV 50,36,37
PV 144,160,52
EX 38
PV 148,164,52
VR 202,18,12288
s_add_u32 m0, s27, 49152
PV 152,168,52
EX 39
PV 156,172,52
KR 96,8,20480
CV 51,38,39
LM 212,52
KR 100,9,20480
VR 204,19,8192
v_add_f32 v32, v64, v76
v_add_f32 v33, v64, v77
v_add_f32 v34, v64, v78
v_add_f32 v35, v64, v79
v_add_f32 v36, v64, v80
v_add_f32 v37, v64, v81
v_add_f32 v38, v64, v82
v_add_f32 v39, v64, v83
s_nop 1
QK 32,112,32,32
EX 40
QK 32,116,36,32
VR 206,19,12288
KR 104,10,20480
QK 32,120,40,32
EX 41
QK 32,124,44,32
KR 108,11,20480
CV 52,40,41
QK 36,128,32,36
EX 42
QK 36,132,36,36
buffer_load_dwordx4 v24, s[16:19], s29 offen offset:0 nt lds
QK 36,136,40,36
EX 43
QK 36,140,44,36
buffer_load_dwordx4 v25, s[16:19], s29 offen offset:1024 nt lds
s_waitcnt lgkmcnt(2)
PV 96,176,48
EX 44
PV 100,180,48
buffer_load_dwordx4 v26, s[16:19], s29 offen offset:2048 nt lds
PV 104,184,48
EX 45
PV 108,188,48
buffer_load_dwordx4 v27, s[16:19], s29 offen offset:3072 nt lds
PV 112,192,48
EX 46
PV 116,196,48
CV 53,42,43
CV 54,44,45
PV 120,200,48
EX 47
PV 124,204,48
s_add_u32 s29, s29, 0x40000
CV 55,46,47
LM 208,48
s_waitcnt lgkmcnt(0)
PV 128,176,52
EX 32
PV 132,180,52
EX 33
PV 136,184,52
EX 34
PV 140,188,52
EX 35
PV 144,192,52
EX 36
PV 148,196,52
EX 37
PV 152,200,52
EX 38
PV 156,204,52
EX 39
LM 212,52
CV 48,32,33
CV 49,34,35
CV 50,36,37
CV 51,38,39
s_nop 1
LM 216,48
PV 160,176,48
PV 164,180,48
PV 168,184,48
PV 172,188,48
PV 176,192,48
PV 180,196,48
PV 184,200,48
PV 188,204,48
s_mov_b32 s72, 1
s_branch EPI_V211
TAIL_V211_1:
s_waitcnt lgkmcnt(0)
QK 40,80,0,56
EX 32
QK 40,84,4,40
KR 112,8,24576
KR 116,9,24576
QK 40,88,8,40
EX 33
QK 40,92,12,40
KR 120,10,24576
CV 48,32,33
QK 44,96,0,56
EX 34
QK 44,100,4,44
KR 124,11,24576
s_add_u32 m0, s26, 0
QK 44,104,8,44
EX 35
QK 44,108,12,44
KR 128,8,28672
CV 49,34,35
PV 128,176,52
EX 36
PV 132,180,52
KR 132,9,28672
KR 136,10,28672
PV 136,184,52
EX 37
PV 140,188,52
KR 140,11,28672
CV 50,36,37
PV 144,192,52
EX 38
PV 148,196,52
buffer_load_dwordx4 v20, s[12:15], s28 offen offset:0 nt lds
PV 152,200,52
EX 39
PV 156,204,52
VR 144,12,16384
CV 51,38,39
LM 212,52
buffer_load_dwordx4 v21, s[12:15], s28 offen offset:1024 nt lds
QK 32,80,16,60
EX 40
QK 32,84,20,32
buffer_load_dwordx4 v22, s[12:15], s28 offen offset:2048 nt lds
QK 32,88,24,32
EX 41
QK 32,92,28,32
buffer_load_dwordx4 v23, s[12:15], s28 offen offset:3072 nt lds
QK 36,96,16,60
EX 42
QK 36,100,20,36
VR 146,12,20480
CV 52,40,41
QK 36,104,24,36
EX 43
QK 36,108,28,36
s_add_u32 s28, s28, 0x40000
CV 53,42,43
PV 160,176,48
EX 44
PV 164,180,48
VR 148,13,16384
VR 150,13,20480
PV 168,184,48
EX 45
PV 172,188,48
VR 152,14,16384
CV 54,44,45
PV 176,192,48
EX 46
PV 180,196,48
VR 154,14,20480
VR 156,15,16384
PV 184,200,48
EX 47
PV 188,204,48
VR 158,15,20480
CV 55,46,47
LM 216,48
VR 160,16,16384
VR 162,16,20480
s_waitcnt vmcnt(12) lgkmcnt(10)
s_barrier
v_add_f32 v40, v56, v76
v_add_f32 v41, v56, v77
v_add_f32 v42, v56, v78
v_add_f32 v43, v56, v79
v_add_f32 v44, v56, v80
v_add_f32 v45, v56, v81
v_add_f32 v46, v56, v82
v_add_f32 v47, v56, v83
s_nop 1
QK 40,112,0,40
EX 32
QK 40,116,4,40
VR 164,17,16384
VR 166,17,20480
QK 40,120,8,40
EX 33
QK 40,124,12,40
VR 168,18,16384
VR 170,18,20480
QK 44,128,0,44
EX 34
QK 44,132,4,44
VR 172,19,16384
VR 174,19,20480
QK 44,136,8,44
EX 35
QK 44,140,12,44
CV 48,32,33
CV 49,34,35
s_waitcnt lgkmcnt(0)
PV 96,144,52
EX 36
PV 100,148,52
VR 176,12,24576
VR 178,12,28672
PV 104,152,52
EX 37
PV 108,156,52
VR 180,13,24576
CV 50,36,37
PV 112,160,52
EX 38
PV 116,164,52
VR 182,13,28672
VR 184,14,24576
PV 120,168,52
EX 39
PV 124,172,52
VR 186,14,28672
CV 51,38,39
LM 208,52
VR 188,15,24576
VR 190,15,28672
v_add_f32 v32, v60, v76
v_add_f32 v33, v60, v77
v_add_f32 v34, v60, v78
v_add_f32 v35, v60, v79
v_add_f32 v36, v60, v80
v_add_f32 v37, v60, v81
v_add_f32 v38, v60, v82
v_add_f32 v39, v60, v83
s_nop 1
QK 32,112,16,32
EX 40
QK 32,116,20,32
VR 192,16,24576
VR 194,16,28672
QK 32,120,24,32
EX 41
QK 32,124,28,32
KR 80,8,32768
CV 52,40,41
QK 36,128,16,36
EX 42
QK 36,132,20,36
KR 84,9,32768
VR 196,17,24576
QK 36,136,24,36
EX 43
QK 36,140,28,36
VR 198,17,28672
CV 53,42,43
PV 128,144,48
EX 44
PV 132,148,48
KR 88,10,32768
KR 92,11,32768
PV 136,152,48
EX 45
PV 140,156,48
VR 200,18,24576
CV 54,44,45
PV 144,160,48
EX 46
PV 148,164,48
VR 202,18,28672
s_add_u32 m0, s27, 0
PV 152,168,48
EX 47
PV 156,172,48
KR 96,8,36864
CV 55,46,47
LM 212,48
KR 100,9,36864
VR 204,19,24576
v_add_f32 v40, v64, v76
v_add_f32 v41, v64, v77
v_add_f32 v42, v64, v78
v_add_f32 v43, v64, v79
v_add_f32 v44, v64, v80
v_add_f32 v45, v64, v81
v_add_f32 v46, v64, v82
v_add_f32 v47, v64, v83
s_nop 1
QK 40,112,32,40
EX 32
QK 40,116,36,40
VR 206,19,28672
KR 104,10,36864
QK 40,120,40,40
EX 33
QK 40,124,44,40
KR 108,11,36864
CV 48,32,33
QK 44,128,32,44
EX 34
QK 44,132,36,44
buffer_load_dwordx4 v24, s[16:19], s29 offen offset:0 nt lds
QK 44,136,40,44
EX 35
QK 44,140,44,44
buffer_load_dwordx4 v25, s[16:19], s29 offen offset:1024 nt lds
s_waitcnt lgkmcnt(2)
PV 96,176,52
EX 36
PV 100,180,52
buffer_load_dwordx4 v26, s[16:19], s29 offen offset:2048 nt lds
PV 104,184,52
EX 37
PV 108,188,52
buffer_load_dwordx4 v27, s[16:19], s29 offen offset:3072 nt lds
PV 112,192,52
EX 38
PV 116,196,52
CV 49,34,35
CV 50,36,37
PV 120,200,52
EX 39
PV 124,204,52
s_add_u32 s29, s29, 0x40000
CV 51,38,39
LM 208,52
s_waitcnt lgkmcnt(0)
PV 128,176,48
EX 40
PV 132,180,48
EX 41
PV 136,184,48
EX 42
PV 140,188,48
EX 43
PV 144,192,48
EX 44
PV 148,196,48
EX 45
PV 152,200,48
EX 46
PV 156,204,48
EX 47
LM 212,48
CV 52,40,41
CV 53,42,43
CV 54,44,45
CV 55,46,47
s_nop 1
LM 216,52
PV 160,176,52
PV 164,180,52
PV 168,184,52
PV 172,188,52
PV 176,192,52
PV 180,196,52
PV 184,200,52
PV 188,204,52
s_mov_b32 s72, 2
s_branch EPI_V211
TAIL_V211_2:
s_waitcnt lgkmcnt(0)
QK 32,80,0,56
EX 40
QK 32,84,4,32
KR 112,8,40960
KR 116,9,40960
QK 32,88,8,32
EX 41
QK 32,92,12,32
KR 120,10,40960
CV 52,40,41
QK 36,96,0,56
EX 42
QK 36,100,4,36
KR 124,11,40960
s_add_u32 m0, s26, 16384
QK 36,104,8,36
EX 43
QK 36,108,12,36
KR 128,8,45056
CV 53,42,43
PV 128,176,48
EX 44
PV 132,180,48
KR 132,9,45056
KR 136,10,45056
PV 136,184,48
EX 45
PV 140,188,48
KR 140,11,45056
CV 54,44,45
PV 144,192,48
EX 46
PV 148,196,48
buffer_load_dwordx4 v20, s[12:15], s28 offen offset:0 nt lds
PV 152,200,48
EX 47
PV 156,204,48
VR 144,12,32768
CV 55,46,47
LM 212,48
buffer_load_dwordx4 v21, s[12:15], s28 offen offset:1024 nt lds
QK 40,80,16,60
EX 32
QK 40,84,20,40
buffer_load_dwordx4 v22, s[12:15], s28 offen offset:2048 nt lds
QK 40,88,24,40
EX 33
QK 40,92,28,40
buffer_load_dwordx4 v23, s[12:15], s28 offen offset:3072 nt lds
QK 44,96,16,60
EX 34
QK 44,100,20,44
VR 146,12,36864
CV 48,32,33
QK 44,104,24,44
EX 35
QK 44,108,28,44
s_add_u32 s28, s28, 0x40000
CV 49,34,35
PV 160,176,52
EX 36
PV 164,180,52
VR 148,13,32768
VR 150,13,36864
PV 168,184,52
EX 37
PV 172,188,52
VR 152,14,32768
CV 50,36,37
PV 176,192,52
EX 38
PV 180,196,52
VR 154,14,36864
VR 156,15,32768
PV 184,200,52
EX 39
PV 188,204,52
VR 158,15,36864
CV 51,38,39
LM 216,52
VR 160,16,32768
VR 162,16,36864
s_waitcnt vmcnt(12) lgkmcnt(10)
s_barrier
v_add_f32 v32, v56, v76
v_add_f32 v33, v56, v77
v_add_f32 v34, v56, v78
v_add_f32 v35, v56, v79
v_add_f32 v36, v56, v80
v_add_f32 v37, v56, v81
v_add_f32 v38, v56, v82
v_add_f32 v39, v56, v83
s_nop 1
QK 32,112,0,32
EX 40
QK 32,116,4,32
VR 164,17,32768
VR 166,17,36864
QK 32,120,8,32
EX 41
QK 32,124,12,32
VR 168,18,32768
VR 170,18,36864
QK 36,128,0,36
EX 42
QK 36,132,4,36
VR 172,19,32768
VR 174,19,36864
QK 36,136,8,36
EX 43
QK 36,140,12,36
CV 52,40,41
CV 53,42,43
s_waitcnt lgkmcnt(0)
PV 96,144,48
EX 44
PV 100,148,48
VR 176,12,40960
VR 178,12,45056
PV 104,152,48
EX 45
PV 108,156,48
VR 180,13,40960
CV 54,44,45
PV 112,160,48
EX 46
PV 116,164,48
VR 182,13,45056
VR 184,14,40960
PV 120,168,48
EX 47
PV 124,172,48
VR 186,14,45056
CV 55,46,47
LM 208,48
VR 188,15,40960
VR 190,15,45056
v_add_f32 v40, v60, v76
v_add_f32 v41, v60, v77
v_add_f32 v42, v60, v78
v_add_f32 v43, v60, v79
v_add_f32 v44, v60, v80
v_add_f32 v45, v60, v81
v_add_f32 v46, v60, v82
v_add_f32 v47, v60, v83
s_nop 1
QK 40,112,16,40
EX 32
QK 40,116,20,40
VR 192,16,40960
VR 194,16,45056
QK 40,120,24,40
EX 33
QK 40,124,28,40
KR 80,8,49152
CV 48,32,33
QK 44,128,16,44
EX 34
QK 44,132,20,44
KR 84,9,49152
VR 196,17,40960
QK 44,136,24,44
EX 35
QK 44,140,28,44
VR 198,17,45056
CV 49,34,35
PV 128,144,52
EX 36
PV 132,148,52
KR 88,10,49152
KR 92,11,49152
PV 136,152,52
EX 37
PV 140,156,52
VR 200,18,40960
CV 50,36,37
PV 144,160,52
EX 38
PV 148,164,52
VR 202,18,45056
s_add_u32 m0, s27, 16384
PV 152,168,52
EX 39
PV 156,172,52
KR 96,8,53248
CV 51,38,39
LM 212,52
KR 100,9,53248
VR 204,19,40960
v_add_f32 v32, v64, v76
v_add_f32 v33, v64, v77
v_add_f32 v34, v64, v78
v_add_f32 v35, v64, v79
v_add_f32 v36, v64, v80
v_add_f32 v37, v64, v81
v_add_f32 v38, v64, v82
v_add_f32 v39, v64, v83
s_nop 1
QK 32,112,32,32
EX 40
QK 32,116,36,32
VR 206,19,45056
KR 104,10,53248
QK 32,120,40,32
EX 41
QK 32,124,44,32
KR 108,11,53248
CV 52,40,41
QK 36,128,32,36
EX 42
QK 36,132,36,36
buffer_load_dwordx4 v24, s[16:19], s29 offen offset:0 nt lds
QK 36,136,40,36
EX 43
QK 36,140,44,36
buffer_load_dwordx4 v25, s[16:19], s29 offen offset:1024 nt lds
s_waitcnt lgkmcnt(2)
PV 96,176,48
EX 44
PV 100,180,48
buffer_load_dwordx4 v26, s[16:19], s29 offen offset:2048 nt lds
PV 104,184,48
EX 45
PV 108,188,48
buffer_load_dwordx4 v27, s[16:19], s29 offen offset:3072 nt lds
PV 112,192,48
EX 46
PV 116,196,48
CV 53,42,43
CV 54,44,45
PV 120,200,48
EX 47
PV 124,204,48
s_add_u32 s29, s29, 0x40000
CV 55,46,47
LM 208,48
s_waitcnt lgkmcnt(0)
PV 128,176,52
EX 32
PV 132,180,52
EX 33
PV 136,184,52
EX 34
PV 140,188,52
EX 35
PV 144,192,52
EX 36
PV 148,196,52
EX 37
PV 152,200,52
EX 38
PV 156,204,52
EX 39
LM 212,52
CV 48,32,33
CV 49,34,35
CV 50,36,37
CV 51,38,39
s_nop 1
LM 216,48
PV 160,176,48
PV 164,180,48
PV 168,184,48
PV 172,188,48
PV 176,192,48
PV 180,196,48
PV 184,200,48
PV 188,204,48
s_mov_b32 s72, 3
s_branch EPI_V211
TAIL_V211_3:
s_waitcnt lgkmcnt(0)
QK 40,80,0,56
EX 32
QK 40,84,4,40
KR 112,8,57344
KR 116,9,57344
QK 40,88,8,40
EX 33
QK 40,92,12,40
KR 120,10,57344
CV 48,32,33
QK 44,96,0,56
EX 34
QK 44,100,4,44
KR 124,11,57344
s_add_u32 m0, s26, 32768
QK 44,104,8,44
EX 35
QK 44,108,12,44
KR 128,8,61440
CV 49,34,35
PV 128,176,52
EX 36
PV 132,180,52
KR 132,9,61440
KR 136,10,61440
PV 136,184,52
EX 37
PV 140,188,52
KR 140,11,61440
CV 50,36,37
PV 144,192,52
EX 38
PV 148,196,52
buffer_load_dwordx4 v20, s[12:15], s28 offen offset:0 nt lds
PV 152,200,52
EX 39
PV 156,204,52
VR 144,12,49152
CV 51,38,39
LM 212,52
buffer_load_dwordx4 v21, s[12:15], s28 offen offset:1024 nt lds
QK 32,80,16,60
EX 40
QK 32,84,20,32
buffer_load_dwordx4 v22, s[12:15], s28 offen offset:2048 nt lds
QK 32,88,24,32
EX 41
QK 32,92,28,32
buffer_load_dwordx4 v23, s[12:15], s28 offen offset:3072 nt lds
QK 36,96,16,60
EX 42
QK 36,100,20,36
VR 146,12,53248
CV 52,40,41
QK 36,104,24,36
EX 43
QK 36,108,28,36
s_add_u32 s28, s28, 0x40000
CV 53,42,43
PV 160,176,48
EX 44
PV 164,180,48
VR 148,13,49152
VR 150,13,53248
PV 168,184,48
EX 45
PV 172,188,48
VR 152,14,49152
CV 54,44,45
PV 176,192,48
EX 46
PV 180,196,48
VR 154,14,53248
VR 156,15,49152
PV 184,200,48
EX 47
PV 188,204,48
VR 158,15,53248
CV 55,46,47
LM 216,48
VR 160,16,49152
VR 162,16,53248
s_waitcnt vmcnt(12) lgkmcnt(10)
s_barrier
v_add_f32 v40, v56, v76
v_add_f32 v41, v56, v77
v_add_f32 v42, v56, v78
v_add_f32 v43, v56, v79
v_add_f32 v44, v56, v80
v_add_f32 v45, v56, v81
v_add_f32 v46, v56, v82
v_add_f32 v47, v56, v83
s_nop 1
QK 40,112,0,40
EX 32
QK 40,116,4,40
VR 164,17,49152
VR 166,17,53248
QK 40,120,8,40
EX 33
QK 40,124,12,40
VR 168,18,49152
VR 170,18,53248
QK 44,128,0,44
EX 34
QK 44,132,4,44
VR 172,19,49152
VR 174,19,53248
QK 44,136,8,44
EX 35
QK 44,140,12,44
CV 48,32,33
CV 49,34,35
s_waitcnt lgkmcnt(0)
PV 96,144,52
EX 36
PV 100,148,52
VR 176,12,57344
VR 178,12,61440
PV 104,152,52
EX 37
PV 108,156,52
VR 180,13,57344
CV 50,36,37
PV 112,160,52
EX 38
PV 116,164,52
VR 182,13,61440
VR 184,14,57344
PV 120,168,52
EX 39
PV 124,172,52
VR 186,14,61440
CV 51,38,39
LM 208,52
VR 188,15,57344
VR 190,15,61440
v_add_f32 v32, v60, v76
v_add_f32 v33, v60, v77
v_add_f32 v34, v60, v78
v_add_f32 v35, v60, v79
v_add_f32 v36, v60, v80
v_add_f32 v37, v60, v81
v_add_f32 v38, v60, v82
v_add_f32 v39, v60, v83
s_nop 1
QK 32,112,16,32
EX 40
QK 32,116,20,32
VR 192,16,57344
VR 194,16,61440
QK 32,120,24,32
EX 41
QK 32,124,28,32
KR 80,8,0
CV 52,40,41
QK 36,128,16,36
EX 42
QK 36,132,20,36
KR 84,9,0
VR 196,17,57344
QK 36,136,24,36
EX 43
QK 36,140,28,36
VR 198,17,61440
CV 53,42,43
PV 128,144,48
EX 44
PV 132,148,48
KR 88,10,0
KR 92,11,0
PV 136,152,48
EX 45
PV 140,156,48
VR 200,18,57344
CV 54,44,45
PV 144,160,48
EX 46
PV 148,164,48
VR 202,18,61440
s_add_u32 m0, s27, 32768
PV 152,168,48
EX 47
PV 156,172,48
KR 96,8,4096
CV 55,46,47
LM 212,48
KR 100,9,4096
VR 204,19,57344
v_add_f32 v40, v64, v76
v_add_f32 v41, v64, v77
v_add_f32 v42, v64, v78
v_add_f32 v43, v64, v79
v_add_f32 v44, v64, v80
v_add_f32 v45, v64, v81
v_add_f32 v46, v64, v82
v_add_f32 v47, v64, v83
s_nop 1
QK 40,112,32,40
EX 32
QK 40,116,36,40
VR 206,19,61440
KR 104,10,4096
QK 40,120,40,40
EX 33
QK 40,124,44,40
KR 108,11,4096
CV 48,32,33
QK 44,128,32,44
EX 34
QK 44,132,36,44
buffer_load_dwordx4 v24, s[16:19], s29 offen offset:0 nt lds
QK 44,136,40,44
EX 35
QK 44,140,44,44
buffer_load_dwordx4 v25, s[16:19], s29 offen offset:1024 nt lds
s_waitcnt lgkmcnt(2)
PV 96,176,52
EX 36
PV 100,180,52
buffer_load_dwordx4 v26, s[16:19], s29 offen offset:2048 nt lds
PV 104,184,52
EX 37
PV 108,188,52
buffer_load_dwordx4 v27, s[16:19], s29 offen offset:3072 nt lds
PV 112,192,52
EX 38
PV 116,196,52
CV 49,34,35
CV 50,36,37
PV 120,200,52
EX 39
PV 124,204,52
s_add_u32 s29, s29, 0x40000
CV 51,38,39
LM 208,52
s_waitcnt lgkmcnt(0)
PV 128,176,48
EX 40
PV 132,180,48
EX 41
PV 136,184,48
EX 42
PV 140,188,48
EX 43
PV 144,192,48
EX 44
PV 148,196,48
EX 45
PV 152,200,48
EX 46
PV 156,204,48
EX 47
LM 212,48
CV 52,40,41
CV 53,42,43
CV 54,44,45
CV 55,46,47
s_nop 1
LM 216,52
PV 160,176,52
PV 164,180,52
PV 168,184,52
PV 172,188,52
PV 176,192,52
PV 180,196,52
PV 184,200,52
PV 188,204,52
s_mov_b32 s72, 0
EPI_V211:
s_add_u32 s88, s40, 135424
v_mov_b32 v42, s88
v_add_u32 v44, s40, v4
v_add_u32 v45, s40, v3
v_add_u32 v46, s40, v1
v_add_u32 v47, s40, v6
v_add_u32 v48, s40, v5
v_accvgpr_read_b32 v50, a208
v_accvgpr_read_b32 v51, a212
v_accvgpr_read_b32 v52, a216
v_cmp_nge_f32 s[78:79], s76, v50
v_cmp_nge_f32 s[80:81], s76, v51
v_cmp_nge_f32 s[82:83], s76, v52
v_rcp_f32 v32, v50
v_rcp_f32 v34, v51
s_or_b64 s[78:79], s[78:79], s[80:81]
s_or_b64 s[78:79], s[78:79], s[82:83]
s_cmp_lg_u64 s[78:79], 0
s_cselect_b32 s90, 1, 0
v_mov_b32 v43, s90
ds_write_b32 v42, v43
s_nop 3
ds_write_b128 v47, v[160:163] offset:0
ds_write_b128 v47, v[164:167] offset:1024
ds_write_b128 v47, v[168:171] offset:2048
ds_write_b128 v47, v[172:175] offset:3072
ds_write_b32 v48, v52
v_pk_mul_f32 v[96:97], v[96:97], v[32:33] op_sel_hi:[1,0]
v_pk_mul_f32 v[98:99], v[98:99], v[32:33] op_sel_hi:[1,0]
CV 96,96,97
CV 97,98,99
v_pk_mul_f32 v[100:101], v[100:101], v[32:33] op_sel_hi:[1,0]
v_pk_mul_f32 v[102:103], v[102:103], v[32:33] op_sel_hi:[1,0]
CV 100,100,101
CV 101,102,103
v_pk_mul_f32 v[104:105], v[104:105], v[32:33] op_sel_hi:[1,0]
v_pk_mul_f32 v[106:107], v[106:107], v[32:33] op_sel_hi:[1,0]
CV 104,104,105
CV 105,106,107
v_pk_mul_f32 v[108:109], v[108:109], v[32:33] op_sel_hi:[1,0]
v_pk_mul_f32 v[110:111], v[110:111], v[32:33] op_sel_hi:[1,0]
CV 108,108,109
CV 109,110,111
v_pk_mul_f32 v[112:113], v[112:113], v[32:33] op_sel_hi:[1,0]
v_pk_mul_f32 v[114:115], v[114:115], v[32:33] op_sel_hi:[1,0]
CV 112,112,113
CV 113,114,115
v_pk_mul_f32 v[116:117], v[116:117], v[32:33] op_sel_hi:[1,0]
v_pk_mul_f32 v[118:119], v[118:119], v[32:33] op_sel_hi:[1,0]
CV 116,116,117
CV 117,118,119
v_pk_mul_f32 v[120:121], v[120:121], v[32:33] op_sel_hi:[1,0]
v_pk_mul_f32 v[122:123], v[122:123], v[32:33] op_sel_hi:[1,0]
CV 120,120,121
CV 121,122,123
v_pk_mul_f32 v[124:125], v[124:125], v[32:33] op_sel_hi:[1,0]
v_pk_mul_f32 v[126:127], v[126:127], v[32:33] op_sel_hi:[1,0]
CV 124,124,125
CV 125,126,127
s_waitcnt lgkmcnt(0)
s_barrier
ds_read_b32 v43, v28
v_add_u32 v47, 4294959104, v47
v_add_u32 v48, 4294959104, v48
ds_read_b128 v[232:235], v47 offset:0
ds_read_b128 v[236:239], v47 offset:1024
ds_read_b128 v[240:243], v47 offset:2048
ds_read_b128 v[244:247], v47 offset:3072
ds_read_b32 v49, v48
v_pk_mul_f32 v[128:129], v[128:129], v[34:35] op_sel_hi:[1,0]
v_pk_mul_f32 v[130:131], v[130:131], v[34:35] op_sel_hi:[1,0]
CV 128,128,129
CV 129,130,131
v_pk_mul_f32 v[132:133], v[132:133], v[34:35] op_sel_hi:[1,0]
v_pk_mul_f32 v[134:135], v[134:135], v[34:35] op_sel_hi:[1,0]
CV 132,132,133
CV 133,134,135
v_pk_mul_f32 v[136:137], v[136:137], v[34:35] op_sel_hi:[1,0]
v_pk_mul_f32 v[138:139], v[138:139], v[34:35] op_sel_hi:[1,0]
CV 136,136,137
CV 137,138,139
v_pk_mul_f32 v[140:141], v[140:141], v[34:35] op_sel_hi:[1,0]
v_pk_mul_f32 v[142:143], v[142:143], v[34:35] op_sel_hi:[1,0]
CV 140,140,141
CV 141,142,143
v_pk_mul_f32 v[144:145], v[144:145], v[34:35] op_sel_hi:[1,0]
v_pk_mul_f32 v[146:147], v[146:147], v[34:35] op_sel_hi:[1,0]
CV 144,144,145
CV 145,146,147
v_pk_mul_f32 v[148:149], v[148:149], v[34:35] op_sel_hi:[1,0]
v_pk_mul_f32 v[150:151], v[150:151], v[34:35] op_sel_hi:[1,0]
CV 148,148,149
CV 149,150,151
v_pk_mul_f32 v[152:153], v[152:153], v[34:35] op_sel_hi:[1,0]
v_pk_mul_f32 v[154:155], v[154:155], v[34:35] op_sel_hi:[1,0]
CV 152,152,153
CV 153,154,155
v_pk_mul_f32 v[156:157], v[156:157], v[34:35] op_sel_hi:[1,0]
v_pk_mul_f32 v[158:159], v[158:159], v[34:35] op_sel_hi:[1,0]
CV 156,156,157
CV 157,158,159
s_waitcnt lgkmcnt(0)
v_cmp_ne_u32 s[86:87], 0, v43
v_add_f32 v49, v49, v52
s_nop 3
s_cmp_lg_u64 s[86:87], 0
s_cselect_b32 s86, 1, 0
s_andn2_b32 s86, s86, s73
s_cmp_lg_u32 s86, 0
s_cbranch_scc1 MAXPASS
s_barrier
ds_write_b64 v44, v[96:97] offset:0
ds_write_b64 v44, v[100:101] offset:32
ds_write_b64 v44, v[104:105] offset:64
ds_write_b64 v44, v[108:109] offset:96
ds_write_b64 v44, v[112:113] offset:128
ds_write_b64 v44, v[116:117] offset:160
ds_write_b64 v44, v[120:121] offset:192
ds_write_b64 v44, v[124:125] offset:224
v_rcp_f32 v36, v49
v_add_f32 v176, v176, v232
v_add_f32 v177, v177, v233
v_add_f32 v178, v178, v234
v_add_f32 v179, v179, v235
v_add_f32 v180, v180, v236
v_add_f32 v181, v181, v237
v_add_f32 v182, v182, v238
v_add_f32 v183, v183, v239
v_add_f32 v184, v184, v240
v_add_f32 v185, v185, v241
v_add_f32 v186, v186, v242
v_add_f32 v187, v187, v243
v_add_f32 v188, v188, v244
v_add_f32 v189, v189, v245
v_add_f32 v190, v190, v246
v_add_f32 v191, v191, v247
EPI_V211_noq:
v_pk_mul_f32 v[176:177], v[176:177], v[36:37] op_sel_hi:[1,0]
v_pk_mul_f32 v[178:179], v[178:179], v[36:37] op_sel_hi:[1,0]
CV 176,176,177
CV 177,178,179
v_pk_mul_f32 v[180:181], v[180:181], v[36:37] op_sel_hi:[1,0]
v_pk_mul_f32 v[182:183], v[182:183], v[36:37] op_sel_hi:[1,0]
CV 180,180,181
CV 181,182,183
v_pk_mul_f32 v[184:185], v[184:185], v[36:37] op_sel_hi:[1,0]
v_pk_mul_f32 v[186:187], v[186:187], v[36:37] op_sel_hi:[1,0]
CV 184,184,185
CV 185,186,187
v_pk_mul_f32 v[188:189], v[188:189], v[36:37] op_sel_hi:[1,0]
v_pk_mul_f32 v[190:191], v[190:191], v[36:37] op_sel_hi:[1,0]
CV 188,188,189
CV 189,190,191
s_waitcnt lgkmcnt(0)
ds_read_b128 v[112:115], v45 offset:0
ds_read_b128 v[116:119], v45 offset:1088
ds_read_b128 v[120:123], v45 offset:2176
ds_read_b128 v[124:127], v45 offset:3264
s_waitcnt lgkmcnt(0)
ds_write_b64 v44, v[128:129] offset:0
ds_write_b64 v44, v[132:133] offset:32
ds_write_b64 v44, v[136:137] offset:64
ds_write_b64 v44, v[140:141] offset:96
ds_write_b64 v44, v[144:145] offset:128
ds_write_b64 v44, v[148:149] offset:160
ds_write_b64 v44, v[152:153] offset:192
ds_write_b64 v44, v[156:157] offset:224
s_add_u32 s87, s49, 0
buffer_store_dwordx4 v[112:115], v29, s[20:23], s87 offen sc1
s_add_u32 s87, s49, 16384
buffer_store_dwordx4 v[116:119], v29, s[20:23], s87 offen sc1
s_add_u32 s87, s49, 32768
buffer_store_dwordx4 v[120:123], v29, s[20:23], s87 offen sc1
s_add_u32 s87, s49, 49152
buffer_store_dwordx4 v[124:127], v29, s[20:23], s87 offen sc1
s_waitcnt lgkmcnt(0)
ds_read_b128 v[144:147], v45 offset:0
ds_read_b128 v[148:151], v45 offset:1088
ds_read_b128 v[152:155], v45 offset:2176
ds_read_b128 v[156:159], v45 offset:3264
s_waitcnt lgkmcnt(0)
ds_write_b64 v44, v[176:177] offset:0
ds_write_b64 v44, v[180:181] offset:32
ds_write_b64 v44, v[184:185] offset:64
ds_write_b64 v44, v[188:189] offset:96
s_add_u32 s87, s50, 0
buffer_store_dwordx4 v[144:147], v29, s[20:23], s87 offen sc1
s_add_u32 s87, s50, 16384
buffer_store_dwordx4 v[148:151], v29, s[20:23], s87 offen sc1
s_add_u32 s87, s50, 32768
buffer_store_dwordx4 v[152:155], v29, s[20:23], s87 offen sc1
s_add_u32 s87, s50, 49152
buffer_store_dwordx4 v[156:159], v29, s[20:23], s87 offen sc1
s_waitcnt lgkmcnt(0)
ds_read_b128 v[176:179], v46 offset:0
ds_read_b128 v[180:183], v46 offset:2176
s_waitcnt lgkmcnt(0)
s_add_u32 s87, s51, 128
buffer_store_dwordx4 v[176:179], v2, s[20:23], s87 offen sc1
s_add_u32 s87, s51, 32896
buffer_store_dwordx4 v[180:183], v2, s[20:23], s87 offen sc1
s_endpgm
VE_10:
NEXT_PASS:
s_mov_b32 s44, s54
s_mov_b32 s45, s55
s_mov_b32 s46, s56
s_mov_b32 s47, s57
s_mov_b32 s48, s58
s_mov_b32 s49, s59
s_mov_b32 s50, s60
s_mov_b32 s51, s61
s_mov_b32 s52, s62
s_mov_b32 s53, s63
s_mov_b32 s54, 0
s_mov_b32 s55, 0
s_mov_b32 s56, 0
s_mov_b32 s57, 0
s_mov_b32 s58, 0
s_mov_b32 s59, 0
s_mov_b32 s60, 0
s_mov_b32 s61, 0
s_mov_b32 s62, 0
s_mov_b32 s63, 0
s_mov_b32 s22, s46
s_mov_b32 s10, 0
s_mov_b32 s73, 0
s_sub_u32 s86, s48, 32
v_cmp_gt_i32 s[78:79], s86, v30
s_sub_u32 s86, s48, 33
v_cmp_gt_i32 s[80:81], s86, v30
s_sub_u32 s86, s48, 34
v_cmp_gt_i32 s[82:83], s86, v30
s_sub_u32 s86, s48, 35
v_cmp_gt_i32 s[84:85], s86, v30
s_nop 1
v_cndmask_b32 v76, v31, v7, s[78:79]
v_cndmask_b32 v77, v31, v7, s[80:81]
v_cndmask_b32 v78, v31, v7, s[82:83]
v_cndmask_b32 v79, v31, v7, s[84:85]
s_sub_u32 s86, s48, 48
v_cmp_gt_i32 s[78:79], s86, v30
s_sub_u32 s86, s48, 49
v_cmp_gt_i32 s[80:81], s86, v30
s_sub_u32 s86, s48, 50
v_cmp_gt_i32 s[82:83], s86, v30
s_sub_u32 s86, s48, 51
v_cmp_gt_i32 s[84:85], s86, v30
s_nop 1
v_cndmask_b32 v80, v31, v7, s[78:79]
v_cndmask_b32 v81, v31, v7, s[80:81]
v_cndmask_b32 v82, v31, v7, s[82:83]
v_cndmask_b32 v83, v31, v7, s[84:85]
s_cmp_lt_u32 s47, 9
s_cbranch_scc1 DISPATCH
v_accvgpr_read_b32 v33, a64
v_accvgpr_read_b32 v35, a65
v_accvgpr_read_b32 v37, a66
v_accvgpr_read_b32 v39, a67
v_lshlrev_b32 v32, 16, v33
v_and_b32 v33, 0xffff0000, v33
v_lshlrev_b32 v34, 16, v35
v_and_b32 v35, 0xffff0000, v35
v_lshlrev_b32 v36, 16, v37
v_and_b32 v37, 0xffff0000, v37
v_lshlrev_b32 v38, 16, v39
v_and_b32 v39, 0xffff0000, v39
v_pk_mul_f32 v[32:33], v[32:33], s[74:75]
v_pk_mul_f32 v[34:35], v[34:35], s[74:75]
v_pk_mul_f32 v[36:37], v[36:37], s[74:75]
v_pk_mul_f32 v[38:39], v[38:39], s[74:75]
CV 32,32,33
CV 34,34,35
CV 36,36,37
CV 38,38,39
v_accvgpr_write_b32 a32, v32
v_accvgpr_write_b32 a33, v34
v_accvgpr_write_b32 a34, v36
v_accvgpr_write_b32 a35, v38
v_accvgpr_read_b32 v33, a68
v_accvgpr_read_b32 v35, a69
v_accvgpr_read_b32 v37, a70
v_accvgpr_read_b32 v39, a71
v_lshlrev_b32 v32, 16, v33
v_and_b32 v33, 0xffff0000, v33
v_lshlrev_b32 v34, 16, v35
v_and_b32 v35, 0xffff0000, v35
v_lshlrev_b32 v36, 16, v37
v_and_b32 v37, 0xffff0000, v37
v_lshlrev_b32 v38, 16, v39
v_and_b32 v39, 0xffff0000, v39
v_pk_mul_f32 v[32:33], v[32:33], s[74:75]
v_pk_mul_f32 v[34:35], v[34:35], s[74:75]
v_pk_mul_f32 v[36:37], v[36:37], s[74:75]
v_pk_mul_f32 v[38:39], v[38:39], s[74:75]
CV 32,32,33
CV 34,34,35
CV 36,36,37
CV 38,38,39
v_accvgpr_write_b32 a36, v32
v_accvgpr_write_b32 a37, v34
v_accvgpr_write_b32 a38, v36
v_accvgpr_write_b32 a39, v38
v_accvgpr_read_b32 v33, a72
v_accvgpr_read_b32 v35, a73
v_accvgpr_read_b32 v37, a74
v_accvgpr_read_b32 v39, a75
v_lshlrev_b32 v32, 16, v33
v_and_b32 v33, 0xffff0000, v33
v_lshlrev_b32 v34, 16, v35
v_and_b32 v35, 0xffff0000, v35
v_lshlrev_b32 v36, 16, v37
v_and_b32 v37, 0xffff0000, v37
v_lshlrev_b32 v38, 16, v39
v_and_b32 v39, 0xffff0000, v39
v_pk_mul_f32 v[32:33], v[32:33], s[74:75]
v_pk_mul_f32 v[34:35], v[34:35], s[74:75]
v_pk_mul_f32 v[36:37], v[36:37], s[74:75]
v_pk_mul_f32 v[38:39], v[38:39], s[74:75]
CV 32,32,33
CV 34,34,35
CV 36,36,37
CV 38,38,39
v_accvgpr_write_b32 a40, v32
v_accvgpr_write_b32 a41, v34
v_accvgpr_write_b32 a42, v36
v_accvgpr_write_b32 a43, v38
v_accvgpr_read_b32 v33, a76
v_accvgpr_read_b32 v35, a77
v_accvgpr_read_b32 v37, a78
v_accvgpr_read_b32 v39, a79
v_lshlrev_b32 v32, 16, v33
v_and_b32 v33, 0xffff0000, v33
v_lshlrev_b32 v34, 16, v35
v_and_b32 v35, 0xffff0000, v35
v_lshlrev_b32 v36, 16, v37
v_and_b32 v37, 0xffff0000, v37
v_lshlrev_b32 v38, 16, v39
v_and_b32 v39, 0xffff0000, v39
v_pk_mul_f32 v[32:33], v[32:33], s[74:75]
v_pk_mul_f32 v[34:35], v[34:35], s[74:75]
v_pk_mul_f32 v[36:37], v[36:37], s[74:75]
v_pk_mul_f32 v[38:39], v[38:39], s[74:75]
CV 32,32,33
CV 34,34,35
CV 36,36,37
CV 38,38,39
v_accvgpr_write_b32 a44, v32
v_accvgpr_write_b32 a45, v34
v_accvgpr_write_b32 a46, v36
v_accvgpr_write_b32 a47, v38
DISPATCH:
s_cmp_eq_u32 s47, 10
s_cbranch_scc0 DS_33
s_cmp_eq_u32 s25, 0
s_cbranch_scc1 PRO_V210
s_branch PRO_V211
DS_33:
s_cmp_eq_u32 s47, 12
s_cbranch_scc1 PRO_V300
s_cmp_eq_u32 s47, 16
s_cbranch_scc1 PRO_V400
s_cmp_eq_u32 s47, 20
s_cbranch_scc1 PRO_V500
FIN:
END:
s_endpgm
QX:
s_mov_b32 s36, -1
s_add_u32 s37, s37, 1
s_cmp_eq_u32 s37, 1
s_cbranch_scc1 QX_ISSUE0
s_add_u32 s78, s40, 131072
s_waitcnt vmcnt(8)
s_cmp_eq_u32 s37, 3
s_cbranch_scc1 QX_READ1
v_add_u32 v92, s78, v8
KR 224,92,0
KR 240,92,4096
v_add_u32 v93, s78, v9
KR 228,93,0
KR 244,93,4096
v_add_u32 v92, s78, v10
KR 232,92,0
KR 248,92,4096
v_add_u32 v93, s78, v11
KR 236,93,0
KR 252,93,4096
s_waitcnt lgkmcnt(0)
s_add_u32 m0, s40, 131072
s_nop 0
buffer_load_dwordx4 v88, s[8:11], s61 offen offset:0 nt lds
buffer_load_dwordx4 v89, s[8:11], s61 offen offset:1024 nt lds
buffer_load_dwordx4 v90, s[8:11], s61 offen offset:2048 nt lds
buffer_load_dwordx4 v91, s[8:11], s61 offen offset:3072 nt lds
s_setpc_b64 s[38:39]
QX_READ1:
v_add_u32 v92, s78, v8
ds_read_b128 a[64:67], v92
v_add_u32 v93, s78, v9
ds_read_b128 a[68:71], v93
v_add_u32 v92, s78, v10
ds_read_b128 a[72:75], v92
v_add_u32 v93, s78, v11
ds_read_b128 a[76:79], v93
s_waitcnt lgkmcnt(0)
s_mov_b32 s36, 1
s_setpc_b64 s[38:39]
QX_ISSUE0:
s_add_u32 m0, s40, 131072
s_nop 0
buffer_load_dwordx4 v88, s[8:11], s59 offen offset:0 nt lds
buffer_load_dwordx4 v89, s[8:11], s59 offen offset:1024 nt lds
buffer_load_dwordx4 v90, s[8:11], s59 offen offset:2048 nt lds
buffer_load_dwordx4 v91, s[8:11], s59 offen offset:3072 nt lds
s_add_u32 m0, s40, 135168
s_nop 0
buffer_load_dwordx4 v88, s[8:11], s60 offen offset:0 nt lds
buffer_load_dwordx4 v89, s[8:11], s60 offen offset:1024 nt lds
buffer_load_dwordx4 v90, s[8:11], s60 offen offset:2048 nt lds
buffer_load_dwordx4 v91, s[8:11], s60 offen offset:3072 nt lds
s_setpc_b64 s[38:39]
MAXPASS:
s_waitcnt vmcnt(0) lgkmcnt(0)
s_barrier
v_mov_b32 v48, v31
v_mov_b32 v49, v31
v_mov_b32 v50, v31
v_mov_b32 v51, v31
v_mov_b32 v52, v31
s_mov_b32 s14, s46
s_mov_b32 s28, s44
s_mov_b32 s71, s45
s_sub_u32 s88, s45, 1
s_lshl_b32 s88, s88, 6
s_add_u32 s88, s88, s48
MAXP_LOOP:
s_mov_b32 m0, s26
s_nop 0
buffer_load_dwordx4 v20, s[12:15], s28 offen offset:0 lds
buffer_load_dwordx4 v21, s[12:15], s28 offen offset:1024 lds
buffer_load_dwordx4 v22, s[12:15], s28 offen offset:2048 lds
buffer_load_dwordx4 v23, s[12:15], s28 offen offset:3072 lds
s_waitcnt vmcnt(0)
s_barrier
KR 80,8,0
KR 84,9,0
KR 88,10,0
KR 92,11,0
s_sub_u32 s86, s88, 0
v_cmp_gt_i32 s[78:79], s86, v30
s_sub_u32 s86, s88, 1
v_cmp_gt_i32 s[80:81], s86, v30
s_sub_u32 s86, s88, 2
v_cmp_gt_i32 s[82:83], s86, v30
s_sub_u32 s86, s88, 3
v_cmp_gt_i32 s[84:85], s86, v30
s_nop 1
v_cndmask_b32 v40, v31, v7, s[78:79]
v_cndmask_b32 v41, v31, v7, s[80:81]
v_cndmask_b32 v42, v31, v7, s[82:83]
v_cndmask_b32 v43, v31, v7, s[84:85]
s_waitcnt lgkmcnt(0)
QK 96,80,0,40
QK 96,84,4,96
QK 96,88,8,96
QK 96,92,12,96
QK 100,80,16,40
QK 100,84,20,100
QK 100,88,24,100
QK 100,92,28,100
QK 104,80,32,40
QK 104,84,36,104
QK 104,88,40,104
QK 104,92,44,104
QK 108,80,48,40
QK 108,84,52,108
QK 108,88,56,108
QK 108,92,60,108
QK 112,80,64,40
QK 112,84,68,112
QK 112,88,72,112
QK 112,92,76,112
s_nop 9
v_max3_f32 v48, v48, v96, v97
v_max3_f32 v48, v48, v98, v99
v_max3_f32 v49, v49, v100, v101
v_max3_f32 v49, v49, v102, v103
v_max3_f32 v50, v50, v104, v105
v_max3_f32 v50, v50, v106, v107
v_max3_f32 v51, v51, v108, v109
v_max3_f32 v51, v51, v110, v111
v_max3_f32 v52, v52, v112, v113
v_max3_f32 v52, v52, v114, v115
s_nop 3
KR 80,8,4096
KR 84,9,4096
KR 88,10,4096
KR 92,11,4096
s_sub_u32 s86, s88, 16
v_cmp_gt_i32 s[78:79], s86, v30
s_sub_u32 s86, s88, 17
v_cmp_gt_i32 s[80:81], s86, v30
s_sub_u32 s86, s88, 18
v_cmp_gt_i32 s[82:83], s86, v30
s_sub_u32 s86, s88, 19
v_cmp_gt_i32 s[84:85], s86, v30
s_nop 1
v_cndmask_b32 v40, v31, v7, s[78:79]
v_cndmask_b32 v41, v31, v7, s[80:81]
v_cndmask_b32 v42, v31, v7, s[82:83]
v_cndmask_b32 v43, v31, v7, s[84:85]
s_waitcnt lgkmcnt(0)
QK 96,80,0,40
QK 96,84,4,96
QK 96,88,8,96
QK 96,92,12,96
QK 100,80,16,40
QK 100,84,20,100
QK 100,88,24,100
QK 100,92,28,100
QK 104,80,32,40
QK 104,84,36,104
QK 104,88,40,104
QK 104,92,44,104
QK 108,80,48,40
QK 108,84,52,108
QK 108,88,56,108
QK 108,92,60,108
QK 112,80,64,40
QK 112,84,68,112
QK 112,88,72,112
QK 112,92,76,112
s_nop 9
v_max3_f32 v48, v48, v96, v97
v_max3_f32 v48, v48, v98, v99
v_max3_f32 v49, v49, v100, v101
v_max3_f32 v49, v49, v102, v103
v_max3_f32 v50, v50, v104, v105
v_max3_f32 v50, v50, v106, v107
v_max3_f32 v51, v51, v108, v109
v_max3_f32 v51, v51, v110, v111
v_max3_f32 v52, v52, v112, v113
v_max3_f32 v52, v52, v114, v115
s_nop 3
KR 80,8,8192
KR 84,9,8192
KR 88,10,8192
KR 92,11,8192
s_sub_u32 s86, s88, 32
v_cmp_gt_i32 s[78:79], s86, v30
s_sub_u32 s86, s88, 33
v_cmp_gt_i32 s[80:81], s86, v30
s_sub_u32 s86, s88, 34
v_cmp_gt_i32 s[82:83], s86, v30
s_sub_u32 s86, s88, 35
v_cmp_gt_i32 s[84:85], s86, v30
s_nop 1
v_cndmask_b32 v40, v31, v7, s[78:79]
v_cndmask_b32 v41, v31, v7, s[80:81]
v_cndmask_b32 v42, v31, v7, s[82:83]
v_cndmask_b32 v43, v31, v7, s[84:85]
s_waitcnt lgkmcnt(0)
QK 96,80,0,40
QK 96,84,4,96
QK 96,88,8,96
QK 96,92,12,96
QK 100,80,16,40
QK 100,84,20,100
QK 100,88,24,100
QK 100,92,28,100
QK 104,80,32,40
QK 104,84,36,104
QK 104,88,40,104
QK 104,92,44,104
QK 108,80,48,40
QK 108,84,52,108
QK 108,88,56,108
QK 108,92,60,108
QK 112,80,64,40
QK 112,84,68,112
QK 112,88,72,112
QK 112,92,76,112
s_nop 9
v_max3_f32 v48, v48, v96, v97
v_max3_f32 v48, v48, v98, v99
v_max3_f32 v49, v49, v100, v101
v_max3_f32 v49, v49, v102, v103
v_max3_f32 v50, v50, v104, v105
v_max3_f32 v50, v50, v106, v107
v_max3_f32 v51, v51, v108, v109
v_max3_f32 v51, v51, v110, v111
v_max3_f32 v52, v52, v112, v113
v_max3_f32 v52, v52, v114, v115
s_nop 3
KR 80,8,12288
KR 84,9,12288
KR 88,10,12288
KR 92,11,12288
s_sub_u32 s86, s88, 48
v_cmp_gt_i32 s[78:79], s86, v30
s_sub_u32 s86, s88, 49
v_cmp_gt_i32 s[80:81], s86, v30
s_sub_u32 s86, s88, 50
v_cmp_gt_i32 s[82:83], s86, v30
s_sub_u32 s86, s88, 51
v_cmp_gt_i32 s[84:85], s86, v30
s_nop 1
v_cndmask_b32 v40, v31, v7, s[78:79]
v_cndmask_b32 v41, v31, v7, s[80:81]
v_cndmask_b32 v42, v31, v7, s[82:83]
v_cndmask_b32 v43, v31, v7, s[84:85]
s_waitcnt lgkmcnt(0)
QK 96,80,0,40
QK 96,84,4,96
QK 96,88,8,96
QK 96,92,12,96
QK 100,80,16,40
QK 100,84,20,100
QK 100,88,24,100
QK 100,92,28,100
QK 104,80,32,40
QK 104,84,36,104
QK 104,88,40,104
QK 104,92,44,104
QK 108,80,48,40
QK 108,84,52,108
QK 108,88,56,108
QK 108,92,60,108
QK 112,80,64,40
QK 112,84,68,112
QK 112,88,72,112
QK 112,92,76,112
s_nop 9
v_max3_f32 v48, v48, v96, v97
v_max3_f32 v48, v48, v98, v99
v_max3_f32 v49, v49, v100, v101
v_max3_f32 v49, v49, v102, v103
v_max3_f32 v50, v50, v104, v105
v_max3_f32 v50, v50, v106, v107
v_max3_f32 v51, v51, v108, v109
v_max3_f32 v51, v51, v110, v111
v_max3_f32 v52, v52, v112, v113
v_max3_f32 v52, v52, v114, v115
s_nop 3
s_barrier
s_add_u32 s28, s28, 0x40000
s_sub_u32 s88, s88, 64
s_sub_u32 s71, s71, 1
s_cmp_lg_u32 s71, 0
s_cbranch_scc1 MAXP_LOOP
v_mov_b32 v32, v48
v_mov_b32 v33, v49
v_mov_b32 v34, v50
v_mov_b32 v35, v51
v_mov_b32 v36, v52
v_mov_b32 v40, v32
v_mov_b32 v41, v33
v_mov_b32 v42, v34
v_mov_b32 v43, v35
v_mov_b32 v44, v36
s_nop 1
v_permlane16_swap_b32 v32, v40
v_permlane16_swap_b32 v33, v41
v_permlane16_swap_b32 v34, v42
v_permlane16_swap_b32 v35, v43
v_permlane16_swap_b32 v36, v44
s_nop 1
v_max_f32 v32, v32, v40
v_max_f32 v33, v33, v41
v_max_f32 v34, v34, v42
v_max_f32 v35, v35, v43
v_max_f32 v36, v36, v44
v_mov_b32 v40, v32
v_mov_b32 v41, v33
v_mov_b32 v42, v34
v_mov_b32 v43, v35
v_mov_b32 v44, v36
s_nop 1
v_permlane32_swap_b32 v32, v40
v_permlane32_swap_b32 v33, v41
v_permlane32_swap_b32 v34, v42
v_permlane32_swap_b32 v35, v43
v_permlane32_swap_b32 v36, v44
s_nop 1
v_max_f32 v32, v32, v40
v_max_f32 v33, v33, v41
v_max_f32 v34, v34, v42
v_max_f32 v35, v35, v43
v_max_f32 v36, v36, v44
v_sub_f32 v56, 0, v32
v_sub_f32 v57, 0, v32
v_sub_f32 v58, 0, v32
v_sub_f32 v59, 0, v32
v_sub_f32 v60, 0, v33
v_sub_f32 v61, 0, v33
v_sub_f32 v62, 0, v33
v_sub_f32 v63, 0, v33
v_sub_f32 v64, 0, v34
v_sub_f32 v65, 0, v34
v_sub_f32 v66, 0, v34
v_sub_f32 v67, 0, v34
v_sub_f32 v68, 0, v35
v_sub_f32 v69, 0, v35
v_sub_f32 v70, 0, v35
v_sub_f32 v71, 0, v35
v_sub_f32 v72, 0, v36
v_sub_f32 v73, 0, v36
v_sub_f32 v74, 0, v36
v_sub_f32 v75, 0, v36
s_mov_b32 s73, 1
s_mov_b32 s28, s44
s_mov_b32 s14, s46
s_mov_b32 s29, s44
s_mov_b32 s18, s46
s_add_u32 m0, s26, 0
s_nop 0
buffer_load_dwordx4 v20, s[12:15], s28 offen offset:0 nt lds
buffer_load_dwordx4 v21, s[12:15], s28 offen offset:1024 nt lds
buffer_load_dwordx4 v22, s[12:15], s28 offen offset:2048 nt lds
buffer_load_dwordx4 v23, s[12:15], s28 offen offset:3072 nt lds
s_add_u32 s28, s28, 0x40000
s_add_u32 m0, s27, 0
s_nop 0
buffer_load_dwordx4 v24, s[16:19], s29 offen offset:0 nt lds
buffer_load_dwordx4 v25, s[16:19], s29 offen offset:1024 nt lds
buffer_load_dwordx4 v26, s[16:19], s29 offen offset:2048 nt lds
buffer_load_dwordx4 v27, s[16:19], s29 offen offset:3072 nt lds
s_add_u32 s29, s29, 0x40000
s_add_u32 m0, s26, 16384
s_nop 0
buffer_load_dwordx4 v20, s[12:15], s28 offen offset:0 nt lds
buffer_load_dwordx4 v21, s[12:15], s28 offen offset:1024 nt lds
buffer_load_dwordx4 v22, s[12:15], s28 offen offset:2048 nt lds
buffer_load_dwordx4 v23, s[12:15], s28 offen offset:3072 nt lds
s_add_u32 s28, s28, 0x40000
s_add_u32 m0, s27, 16384
s_nop 0
buffer_load_dwordx4 v24, s[16:19], s29 offen offset:0 nt lds
buffer_load_dwordx4 v25, s[16:19], s29 offen offset:1024 nt lds
buffer_load_dwordx4 v26, s[16:19], s29 offen offset:2048 nt lds
buffer_load_dwordx4 v27, s[16:19], s29 offen offset:3072 nt lds
s_add_u32 s29, s29, 0x40000
s_add_u32 m0, s26, 32768
s_nop 0
buffer_load_dwordx4 v20, s[12:15], s28 offen offset:0 nt lds
buffer_load_dwordx4 v21, s[12:15], s28 offen offset:1024 nt lds
buffer_load_dwordx4 v22, s[12:15], s28 offen offset:2048 nt lds
buffer_load_dwordx4 v23, s[12:15], s28 offen offset:3072 nt lds
s_add_u32 s28, s28, 0x40000
s_add_u32 m0, s27, 32768
s_nop 0
buffer_load_dwordx4 v24, s[16:19], s29 offen offset:0 nt lds
buffer_load_dwordx4 v25, s[16:19], s29 offen offset:1024 nt lds
buffer_load_dwordx4 v26, s[16:19], s29 offen offset:2048 nt lds
buffer_load_dwordx4 v27, s[16:19], s29 offen offset:3072 nt lds
s_add_u32 s29, s29, 0x40000
s_mov_b32 s72, 0
v_accvgpr_write_b32 a176, 0
v_accvgpr_write_b32 a177, 0
v_accvgpr_write_b32 a178, 0
v_accvgpr_write_b32 a179, 0
v_accvgpr_write_b32 a180, 0
v_accvgpr_write_b32 a181, 0
v_accvgpr_write_b32 a182, 0
v_accvgpr_write_b32 a183, 0
v_accvgpr_write_b32 a184, 0
v_accvgpr_write_b32 a185, 0
v_accvgpr_write_b32 a186, 0
v_accvgpr_write_b32 a187, 0
v_accvgpr_write_b32 a188, 0
v_accvgpr_write_b32 a189, 0
v_accvgpr_write_b32 a190, 0
v_accvgpr_write_b32 a191, 0
v_accvgpr_write_b32 a192, 0
v_accvgpr_write_b32 a193, 0
v_accvgpr_write_b32 a194, 0
v_accvgpr_write_b32 a195, 0
v_accvgpr_write_b32 a196, 0
v_accvgpr_write_b32 a197, 0
v_accvgpr_write_b32 a198, 0
v_accvgpr_write_b32 a199, 0
v_accvgpr_write_b32 a200, 0
v_accvgpr_write_b32 a201, 0
v_accvgpr_write_b32 a202, 0
v_accvgpr_write_b32 a203, 0
v_accvgpr_write_b32 a204, 0
v_accvgpr_write_b32 a205, 0
v_accvgpr_write_b32 a206, 0
v_accvgpr_write_b32 a207, 0
v_accvgpr_write_b32 a208, 0
v_accvgpr_write_b32 a209, 0
v_accvgpr_write_b32 a210, 0
v_accvgpr_write_b32 a211, 0
v_accvgpr_write_b32 a212, 0
v_accvgpr_write_b32 a213, 0
v_accvgpr_write_b32 a214, 0
v_accvgpr_write_b32 a215, 0
v_accvgpr_write_b32 a216, 0
v_accvgpr_write_b32 a217, 0
v_accvgpr_write_b32 a218, 0
v_accvgpr_write_b32 a219, 0
v_accvgpr_write_b32 a220, 0
v_accvgpr_write_b32 a221, 0
v_accvgpr_write_b32 a222, 0
v_accvgpr_write_b32 a223, 0
v_accvgpr_write_b32 a224, 0
v_accvgpr_write_b32 a225, 0
v_accvgpr_write_b32 a226, 0
v_accvgpr_write_b32 a227, 0
s_waitcnt vmcnt(16)
s_barrier
KR 80,8,0
KR 84,9,0
KR 88,10,0
KR 92,11,0
KR 96,8,4096
KR 100,9,4096
KR 104,10,4096
KR 108,11,4096
s_branch DISPATCH
PRO_V400:
s_cmp_lg_u32 s73, 0
s_cbranch_scc1 PRO_V400_skipmax
s_waitcnt lgkmcnt(0)
v_mfma_f32_16x16x32_bf16 v[96:99], a[80:83], a[0:3], 0
v_mov_b64 v[160:161], 0
QK 96,84,4,96
v_mov_b64 v[162:163], 0
QK 96,88,8,96
v_mov_b64 v[164:165], 0
QK 96,92,12,96
v_mov_b64 v[166:167], 0
v_mfma_f32_16x16x32_bf16 v[100:103], a[96:99], a[0:3], 0
v_mov_b64 v[168:169], 0
QK 100,100,4,100
v_mov_b64 v[170:171], 0
QK 100,104,8,100
v_mov_b64 v[172:173], 0
QK 100,108,12,100
v_mov_b64 v[174:175], 0
v_mfma_f32_16x16x32_bf16 v[104:107], a[80:83], a[16:19], 0
v_mov_b64 v[176:177], 0
QK 104,84,20,104
v_mov_b64 v[178:179], 0
QK 104,88,24,104
v_mov_b64 v[180:181], 0
QK 104,92,28,104
v_mov_b64 v[182:183], 0
v_mfma_f32_16x16x32_bf16 v[108:111], a[96:99], a[16:19], 0
v_mov_b64 v[184:185], 0
QK 108,100,20,108
v_mov_b64 v[186:187], 0
QK 108,104,24,108
v_mov_b64 v[188:189], 0
QK 108,108,28,108
v_mov_b64 v[190:191], 0
v_mfma_f32_16x16x32_bf16 v[112:115], a[80:83], a[32:35], 0
v_mov_b64 v[192:193], 0
QK 112,84,36,112
v_mov_b64 v[194:195], 0
QK 112,88,40,112
v_mov_b64 v[196:197], 0
QK 112,92,44,112
v_mov_b64 v[198:199], 0
v_mfma_f32_16x16x32_bf16 v[116:119], a[96:99], a[32:35], 0
v_mov_b64 v[200:201], 0
QK 116,100,36,116
v_mov_b64 v[202:203], 0
QK 116,104,40,116
v_mov_b64 v[204:205], 0
QK 116,108,44,116
v_mov_b64 v[206:207], 0
v_mfma_f32_16x16x32_bf16 v[120:123], a[80:83], a[48:51], 0
v_mov_b64 v[208:209], 0
QK 120,84,52,120
v_mov_b64 v[210:211], 0
QK 120,88,56,120
v_mov_b64 v[212:213], 0
QK 120,92,60,120
v_mov_b64 v[214:215], 0
v_mfma_f32_16x16x32_bf16 v[124:127], a[96:99], a[48:51], 0
v_mov_b64 v[216:217], 0
QK 124,100,52,124
v_mov_b64 v[218:219], 0
QK 124,104,56,124
v_mov_b64 v[220:221], 0
QK 124,108,60,124
v_mov_b64 v[222:223], 0
s_nop 8
v_max3_f32 v32, v96, v97, v98
v_max3_f32 v33, v104, v105, v106
v_max3_f32 v34, v112, v113, v114
v_max3_f32 v35, v120, v121, v122
v_max3_f32 v32, v32, v99, v100
v_max3_f32 v33, v33, v107, v108
v_max3_f32 v34, v34, v115, v116
v_max3_f32 v35, v35, v123, v124
v_max3_f32 v32, v32, v101, v102
v_max3_f32 v33, v33, v109, v110
v_max3_f32 v34, v34, v117, v118
v_max3_f32 v35, v35, v125, v126
v_max_f32 v32, v32, v103
v_max_f32 v33, v33, v111
v_max_f32 v34, v34, v119
v_max_f32 v35, v35, v127
v_mov_b32 v40, v32
v_mov_b32 v41, v33
v_mov_b32 v42, v34
v_mov_b32 v43, v35
s_nop 1
v_permlane16_swap_b32 v32, v40
v_permlane16_swap_b32 v33, v41
v_permlane16_swap_b32 v34, v42
v_permlane16_swap_b32 v35, v43
s_nop 1
v_max_f32 v32, v32, v40
v_max_f32 v33, v33, v41
v_max_f32 v34, v34, v42
v_max_f32 v35, v35, v43
v_mov_b32 v40, v32
v_mov_b32 v41, v33
v_mov_b32 v42, v34
v_mov_b32 v43, v35
s_nop 1
v_permlane32_swap_b32 v32, v40
v_permlane32_swap_b32 v33, v41
v_permlane32_swap_b32 v34, v42
v_permlane32_swap_b32 v35, v43
s_nop 1
v_max_f32 v32, v32, v40
v_max_f32 v33, v33, v41
v_max_f32 v34, v34, v42
v_max_f32 v35, v35, v43
v_sub_f32 v56, 0, v32
v_sub_f32 v57, 0, v32
v_sub_f32 v58, 0, v32
v_sub_f32 v59, 0, v32
v_sub_f32 v60, 0, v33
v_sub_f32 v61, 0, v33
v_sub_f32 v62, 0, v33
v_sub_f32 v63, 0, v33
v_sub_f32 v64, 0, v34
v_sub_f32 v65, 0, v34
v_sub_f32 v66, 0, v34
v_sub_f32 v67, 0, v34
v_sub_f32 v68, 0, v35
v_sub_f32 v69, 0, v35
v_sub_f32 v70, 0, v35
v_sub_f32 v71, 0, v35
s_branch PRO_V400_go
PRO_V400_skipmax:
v_mov_b64 v[160:161], 0
v_mov_b64 v[162:163], 0
v_mov_b64 v[164:165], 0
v_mov_b64 v[166:167], 0
v_mov_b64 v[168:169], 0
v_mov_b64 v[170:171], 0
v_mov_b64 v[172:173], 0
v_mov_b64 v[174:175], 0
v_mov_b64 v[176:177], 0
v_mov_b64 v[178:179], 0
v_mov_b64 v[180:181], 0
v_mov_b64 v[182:183], 0
v_mov_b64 v[184:185], 0
v_mov_b64 v[186:187], 0
v_mov_b64 v[188:189], 0
v_mov_b64 v[190:191], 0
v_mov_b64 v[192:193], 0
v_mov_b64 v[194:195], 0
v_mov_b64 v[196:197], 0
v_mov_b64 v[198:199], 0
v_mov_b64 v[200:201], 0
v_mov_b64 v[202:203], 0
v_mov_b64 v[204:205], 0
v_mov_b64 v[206:207], 0
v_mov_b64 v[208:209], 0
v_mov_b64 v[210:211], 0
v_mov_b64 v[212:213], 0
v_mov_b64 v[214:215], 0
v_mov_b64 v[216:217], 0
v_mov_b64 v[218:219], 0
v_mov_b64 v[220:221], 0
v_mov_b64 v[222:223], 0
s_waitcnt lgkmcnt(0)
PRO_V400_go:
v_mov_b64 v[96:97], 0
v_mov_b64 v[98:99], 0
v_mov_b64 v[100:101], 0
v_mov_b64 v[102:103], 0
v_mov_b64 v[104:105], 0
v_mov_b64 v[106:107], 0
v_mov_b64 v[108:109], 0
v_mov_b64 v[110:111], 0
v_mov_b64 v[112:113], 0
v_mov_b64 v[114:115], 0
v_mov_b64 v[116:117], 0
v_mov_b64 v[118:119], 0
v_mov_b64 v[120:121], 0
v_mov_b64 v[122:123], 0
v_mov_b64 v[124:125], 0
v_mov_b64 v[126:127], 0
v_mov_b64 v[128:129], 0
v_mov_b64 v[130:131], 0
v_mov_b64 v[132:133], 0
v_mov_b64 v[134:135], 0
v_mov_b64 v[136:137], 0
v_mov_b64 v[138:139], 0
v_mov_b64 v[140:141], 0
v_mov_b64 v[142:143], 0
v_mov_b64 v[144:145], 0
v_mov_b64 v[146:147], 0
v_mov_b64 v[148:149], 0
v_mov_b64 v[150:151], 0
v_mov_b64 v[152:153], 0
v_mov_b64 v[154:155], 0
v_mov_b64 v[156:157], 0
v_mov_b64 v[158:159], 0
v_mov_b32 v32, v31
v_mov_b32 v33, v31
v_mov_b32 v34, v31
v_mov_b32 v35, v31
v_mov_b32 v36, v31
v_mov_b32 v37, v31
v_mov_b32 v38, v31
v_mov_b32 v39, v31
v_mov_b32 v40, v31
v_mov_b32 v41, v31
v_mov_b32 v42, v31
v_mov_b32 v43, v31
v_mov_b32 v44, v31
v_mov_b32 v45, v31
v_mov_b32 v46, v31
v_mov_b32 v47, v31
v_mov_b64 v[48:49], 0
v_mov_b64 v[50:51], 0
v_mov_b64 v[52:53], 0
v_mov_b64 v[54:55], 0
s_sub_u32 s71, 3, s45
s_mov_b32 s77, 0
s_sub_u32 s37, s2, s2
s_cmp_eq_u32 s57, 0
s_cselect_b32 s36, 1, -3
s_cmp_eq_u32 s72, 1
s_cbranch_scc1 BODY_V400_1
s_cmp_eq_u32 s72, 2
s_cbranch_scc1 BODY_V400_2
s_cmp_eq_u32 s72, 3
s_cbranch_scc1 BODY_V400_3
BODY_V400_0:
s_waitcnt lgkmcnt(0)
QK 32,80,0,56
EX 40
QK 32,84,4,32
VR 144,12,0
VR 146,12,4096
QK 32,88,8,32
EX 41
QK 32,92,12,32
VR 148,13,0
CV 52,40,41
QK 36,96,0,56
EX 42
QK 36,100,4,36
VR 150,13,4096
VR 152,14,0
QK 36,104,8,36
EX 43
QK 36,108,12,36
VR 154,14,4096
CV 53,42,43
PV 160,176,48
EX 44
PV 164,180,48
VR 156,15,0
VR 158,15,4096
PV 168,184,48
EX 45
PV 172,188,48
VR 160,16,0
CV 54,44,45
PV 176,192,48
EX 46
PV 180,196,48
VR 162,16,4096
VR 164,17,0
PV 184,200,48
EX 47
PV 188,204,48
VR 166,17,4096
CV 55,46,47
LM 216,48
VR 168,18,0
VR 170,18,4096
QK 40,80,16,60
EX 32
QK 40,84,20,40
VR 172,19,0
VR 174,19,4096
QK 40,88,24,40
EX 33
QK 40,92,28,40
KR 112,8,8192
CV 48,32,33
QK 44,96,16,60
EX 34
QK 44,100,20,44
KR 116,9,8192
KR 120,10,8192
QK 44,104,24,44
EX 35
QK 44,108,28,44
KR 124,11,8192
CV 49,34,35
PV 192,176,52
EX 36
PV 196,180,52
s_add_u32 m0, s26, 49152
KR 128,8,12288
PV 200,184,52
EX 37
PV 204,188,52
KR 132,9,12288
CV 50,36,37
PV 208,192,52
EX 38
PV 212,196,52
KR 136,10,12288
KR 140,11,12288
PV 216,200,52
EX 39
PV 220,204,52
CV 51,38,39
LM 220,52
buffer_load_dwordx4 v20, s[12:15], s28 offen offset:0 nt lds
QK 32,80,32,64
EX 40
QK 32,84,36,32
buffer_load_dwordx4 v21, s[12:15], s28 offen offset:1024 nt lds
QK 32,88,40,32
EX 41
QK 32,92,44,32
VR 176,12,8192
CV 52,40,41
QK 36,96,32,64
EX 42
QK 36,100,36,36
buffer_load_dwordx4 v22, s[12:15], s28 offen offset:2048 nt lds
QK 36,104,40,36
EX 43
QK 36,108,44,36
VR 178,12,12288
CV 53,42,43
s_waitcnt lgkmcnt(10)
PV 96,144,48
EX 44
PV 100,148,48
buffer_load_dwordx4 v23, s[12:15], s28 offen offset:3072 nt lds
PV 104,152,48
EX 45
PV 108,156,48
s_add_u32 s28, s28, 0x40000
CV 54,44,45
PV 112,160,48
EX 46
PV 116,164,48
VR 180,13,8192
VR 182,13,12288
PV 120,168,48
EX 47
PV 124,172,48
VR 184,14,8192
CV 55,46,47
LM 208,48
VR 186,14,12288
VR 188,15,8192
QK 40,80,48,68
EX 32
QK 40,84,52,40
VR 190,15,12288
VR 192,16,8192
QK 40,88,56,40
EX 33
QK 40,92,60,40
VR 194,16,12288
CV 48,32,33
QK 44,96,48,68
EX 34
QK 44,100,52,44
VR 196,17,8192
VR 198,17,12288
QK 44,104,56,44
EX 35
QK 44,108,60,44
VR 200,18,8192
CV 49,34,35
PV 128,144,52
EX 36
PV 132,148,52
VR 202,18,12288
VR 204,19,8192
PV 136,152,52
EX 37
PV 140,156,52
VR 206,19,12288
CV 50,36,37
PV 144,160,52
EX 38
PV 148,164,52
PV 152,168,52
EX 39
PV 156,172,52
CV 51,38,39
LM 212,52
s_waitcnt vmcnt(12) lgkmcnt(15)
s_barrier
s_add_u32 s36, s36, 1
s_cbranch_scc1 QS_V400_0__34_s
QS_V400_0__34:
QK 32,112,0,56
EX 40
QK 32,116,4,32
KR 80,8,16384
KR 84,9,16384
QK 32,120,8,32
EX 41
QK 32,124,12,32
KR 88,10,16384
CV 52,40,41
QK 36,128,0,56
EX 42
QK 36,132,4,36
KR 92,11,16384
s_add_u32 m0, s27, 49152
QK 36,136,8,36
EX 43
QK 36,140,12,36
KR 96,8,20480
CV 53,42,43
PV 160,144,48
EX 44
PV 164,148,48
KR 100,9,20480
KR 104,10,20480
PV 168,152,48
EX 45
PV 172,156,48
KR 108,11,20480
CV 54,44,45
PV 176,160,48
EX 46
PV 180,164,48
buffer_load_dwordx4 v24, s[16:19], s29 offen offset:0 nt lds
PV 184,168,48
EX 47
PV 188,172,48
CV 55,46,47
LM 216,48
buffer_load_dwordx4 v25, s[16:19], s29 offen offset:1024 nt lds
QK 40,112,16,60
EX 32
QK 40,116,20,40
buffer_load_dwordx4 v26, s[16:19], s29 offen offset:2048 nt lds
QK 40,120,24,40
EX 33
QK 40,124,28,40
CV 48,32,33
QK 44,128,16,60
EX 34
QK 44,132,20,44
buffer_load_dwordx4 v27, s[16:19], s29 offen offset:3072 nt lds
QK 44,136,24,44
EX 35
QK 44,140,28,44
s_add_u32 s29, s29, 0x40000
CV 49,34,35
PV 192,144,52
EX 36
PV 196,148,52
PV 200,152,52
EX 37
PV 204,156,52
CV 50,36,37
PV 208,160,52
EX 38
PV 212,164,52
PV 216,168,52
EX 39
PV 220,172,52
CV 51,38,39
LM 220,52
QK 32,112,32,64
EX 40
QK 32,116,36,32
QK 32,120,40,32
EX 41
QK 32,124,44,32
CV 52,40,41
QK 36,128,32,64
EX 42
QK 36,132,36,36
QK 36,136,40,36
EX 43
QK 36,140,44,36
CV 53,42,43
s_waitcnt lgkmcnt(8)
PV 96,176,48
EX 44
PV 100,180,48
PV 104,184,48
EX 45
PV 108,188,48
CV 54,44,45
PV 112,192,48
EX 46
PV 116,196,48
PV 120,200,48
EX 47
PV 124,204,48
CV 55,46,47
LM 208,48
QK 40,112,48,68
EX 32
QK 40,116,52,40
QK 40,120,56,40
EX 33
QK 40,124,60,40
CV 48,32,33
QK 44,128,48,68
EX 34
QK 44,132,52,44
QK 44,136,56,44
EX 35
QK 44,140,60,44
CV 49,34,35
PV 128,176,52
EX 36
PV 132,180,52
PV 136,184,52
EX 37
PV 140,188,52
CV 50,36,37
PV 144,192,52
EX 38
PV 148,196,52
PV 152,200,52
EX 39
PV 156,204,52
CV 51,38,39
LM 212,52
s_add_u32 s71, s71, 1
s_cbranch_scc1 SPEC_V400_0
BODY_V400_1:
s_waitcnt lgkmcnt(0)
QK 32,80,0,56
EX 40
QK 32,84,4,32
VR 144,12,16384
VR 146,12,20480
QK 32,88,8,32
EX 41
QK 32,92,12,32
VR 148,13,16384
CV 52,40,41
QK 36,96,0,56
EX 42
QK 36,100,4,36
VR 150,13,20480
VR 152,14,16384
QK 36,104,8,36
EX 43
QK 36,108,12,36
VR 154,14,20480
CV 53,42,43
PV 160,176,48
EX 44
PV 164,180,48
VR 156,15,16384
VR 158,15,20480
PV 168,184,48
EX 45
PV 172,188,48
VR 160,16,16384
CV 54,44,45
PV 176,192,48
EX 46
PV 180,196,48
VR 162,16,20480
VR 164,17,16384
PV 184,200,48
EX 47
PV 188,204,48
VR 166,17,20480
CV 55,46,47
LM 216,48
VR 168,18,16384
VR 170,18,20480
QK 40,80,16,60
EX 32
QK 40,84,20,40
VR 172,19,16384
VR 174,19,20480
QK 40,88,24,40
EX 33
QK 40,92,28,40
KR 112,8,24576
CV 48,32,33
QK 44,96,16,60
EX 34
QK 44,100,20,44
KR 116,9,24576
KR 120,10,24576
QK 44,104,24,44
EX 35
QK 44,108,28,44
KR 124,11,24576
CV 49,34,35
PV 192,176,52
EX 36
PV 196,180,52
s_add_u32 m0, s26, 0
KR 128,8,28672
PV 200,184,52
EX 37
PV 204,188,52
KR 132,9,28672
CV 50,36,37
PV 208,192,52
EX 38
PV 212,196,52
KR 136,10,28672
KR 140,11,28672
PV 216,200,52
EX 39
PV 220,204,52
CV 51,38,39
LM 220,52
buffer_load_dwordx4 v20, s[12:15], s28 offen offset:0 nt lds
QK 32,80,32,64
EX 40
QK 32,84,36,32
buffer_load_dwordx4 v21, s[12:15], s28 offen offset:1024 nt lds
QK 32,88,40,32
EX 41
QK 32,92,44,32
VR 176,12,24576
CV 52,40,41
QK 36,96,32,64
EX 42
QK 36,100,36,36
buffer_load_dwordx4 v22, s[12:15], s28 offen offset:2048 nt lds
QK 36,104,40,36
EX 43
QK 36,108,44,36
VR 178,12,28672
CV 53,42,43
s_waitcnt lgkmcnt(10)
PV 96,144,48
EX 44
PV 100,148,48
buffer_load_dwordx4 v23, s[12:15], s28 offen offset:3072 nt lds
PV 104,152,48
EX 45
PV 108,156,48
s_add_u32 s28, s28, 0x40000
CV 54,44,45
PV 112,160,48
EX 46
PV 116,164,48
VR 180,13,24576
VR 182,13,28672
PV 120,168,48
EX 47
PV 124,172,48
VR 184,14,24576
CV 55,46,47
LM 208,48
VR 186,14,28672
VR 188,15,24576
QK 40,80,48,68
EX 32
QK 40,84,52,40
VR 190,15,28672
VR 192,16,24576
QK 40,88,56,40
EX 33
QK 40,92,60,40
VR 194,16,28672
CV 48,32,33
QK 44,96,48,68
EX 34
QK 44,100,52,44
VR 196,17,24576
VR 198,17,28672
QK 44,104,56,44
EX 35
QK 44,108,60,44
VR 200,18,24576
CV 49,34,35
PV 128,144,52
EX 36
PV 132,148,52
VR 202,18,28672
VR 204,19,24576
PV 136,152,52
EX 37
PV 140,156,52
VR 206,19,28672
CV 50,36,37
PV 144,160,52
EX 38
PV 148,164,52
PV 152,168,52
EX 39
PV 156,172,52
CV 51,38,39
LM 212,52
s_waitcnt vmcnt(12) lgkmcnt(15)
s_barrier
s_add_u32 s36, s36, 1
s_cbranch_scc1 QS_V400_1__35_s
QS_V400_1__35:
QK 32,112,0,56
EX 40
QK 32,116,4,32
KR 80,8,32768
KR 84,9,32768
QK 32,120,8,32
EX 41
QK 32,124,12,32
KR 88,10,32768
CV 52,40,41
QK 36,128,0,56
EX 42
QK 36,132,4,36
KR 92,11,32768
s_add_u32 m0, s27, 0
QK 36,136,8,36
EX 43
QK 36,140,12,36
KR 96,8,36864
CV 53,42,43
PV 160,144,48
EX 44
PV 164,148,48
KR 100,9,36864
KR 104,10,36864
PV 168,152,48
EX 45
PV 172,156,48
KR 108,11,36864
CV 54,44,45
PV 176,160,48
EX 46
PV 180,164,48
buffer_load_dwordx4 v24, s[16:19], s29 offen offset:0 nt lds
PV 184,168,48
EX 47
PV 188,172,48
CV 55,46,47
LM 216,48
buffer_load_dwordx4 v25, s[16:19], s29 offen offset:1024 nt lds
QK 40,112,16,60
EX 32
QK 40,116,20,40
buffer_load_dwordx4 v26, s[16:19], s29 offen offset:2048 nt lds
QK 40,120,24,40
EX 33
QK 40,124,28,40
CV 48,32,33
QK 44,128,16,60
EX 34
QK 44,132,20,44
buffer_load_dwordx4 v27, s[16:19], s29 offen offset:3072 nt lds
QK 44,136,24,44
EX 35
QK 44,140,28,44
s_add_u32 s29, s29, 0x40000
CV 49,34,35
PV 192,144,52
EX 36
PV 196,148,52
PV 200,152,52
EX 37
PV 204,156,52
CV 50,36,37
PV 208,160,52
EX 38
PV 212,164,52
PV 216,168,52
EX 39
PV 220,172,52
CV 51,38,39
LM 220,52
QK 32,112,32,64
EX 40
QK 32,116,36,32
QK 32,120,40,32
EX 41
QK 32,124,44,32
CV 52,40,41
QK 36,128,32,64
EX 42
QK 36,132,36,36
QK 36,136,40,36
EX 43
QK 36,140,44,36
CV 53,42,43
s_waitcnt lgkmcnt(8)
PV 96,176,48
EX 44
PV 100,180,48
PV 104,184,48
EX 45
PV 108,188,48
CV 54,44,45
PV 112,192,48
EX 46
PV 116,196,48
PV 120,200,48
EX 47
PV 124,204,48
CV 55,46,47
LM 208,48
QK 40,112,48,68
EX 32
QK 40,116,52,40
QK 40,120,56,40
EX 33
QK 40,124,60,40
CV 48,32,33
QK 44,128,48,68
EX 34
QK 44,132,52,44
QK 44,136,56,44
EX 35
QK 44,140,60,44
CV 49,34,35
PV 128,176,52
EX 36
PV 132,180,52
PV 136,184,52
EX 37
PV 140,188,52
CV 50,36,37
PV 144,192,52
EX 38
PV 148,196,52
PV 152,200,52
EX 39
PV 156,204,52
CV 51,38,39
LM 212,52
s_add_u32 s71, s71, 1
s_cbranch_scc1 SPEC_V400_1
BODY_V400_2:
s_waitcnt lgkmcnt(0)
QK 32,80,0,56
EX 40
QK 32,84,4,32
VR 144,12,32768
VR 146,12,36864
QK 32,88,8,32
EX 41
QK 32,92,12,32
VR 148,13,32768
CV 52,40,41
QK 36,96,0,56
EX 42
QK 36,100,4,36
VR 150,13,36864
VR 152,14,32768
QK 36,104,8,36
EX 43
QK 36,108,12,36
VR 154,14,36864
CV 53,42,43
PV 160,176,48
EX 44
PV 164,180,48
VR 156,15,32768
VR 158,15,36864
PV 168,184,48
EX 45
PV 172,188,48
VR 160,16,32768
CV 54,44,45
PV 176,192,48
EX 46
PV 180,196,48
VR 162,16,36864
VR 164,17,32768
PV 184,200,48
EX 47
PV 188,204,48
VR 166,17,36864
CV 55,46,47
LM 216,48
VR 168,18,32768
VR 170,18,36864
QK 40,80,16,60
EX 32
QK 40,84,20,40
VR 172,19,32768
VR 174,19,36864
QK 40,88,24,40
EX 33
QK 40,92,28,40
KR 112,8,40960
CV 48,32,33
QK 44,96,16,60
EX 34
QK 44,100,20,44
KR 116,9,40960
KR 120,10,40960
QK 44,104,24,44
EX 35
QK 44,108,28,44
KR 124,11,40960
CV 49,34,35
PV 192,176,52
EX 36
PV 196,180,52
s_add_u32 m0, s26, 16384
KR 128,8,45056
PV 200,184,52
EX 37
PV 204,188,52
KR 132,9,45056
CV 50,36,37
PV 208,192,52
EX 38
PV 212,196,52
KR 136,10,45056
KR 140,11,45056
PV 216,200,52
EX 39
PV 220,204,52
CV 51,38,39
LM 220,52
buffer_load_dwordx4 v20, s[12:15], s28 offen offset:0 nt lds
QK 32,80,32,64
EX 40
QK 32,84,36,32
buffer_load_dwordx4 v21, s[12:15], s28 offen offset:1024 nt lds
QK 32,88,40,32
EX 41
QK 32,92,44,32
VR 176,12,40960
CV 52,40,41
QK 36,96,32,64
EX 42
QK 36,100,36,36
buffer_load_dwordx4 v22, s[12:15], s28 offen offset:2048 nt lds
QK 36,104,40,36
EX 43
QK 36,108,44,36
VR 178,12,45056
CV 53,42,43
s_waitcnt lgkmcnt(10)
PV 96,144,48
EX 44
PV 100,148,48
buffer_load_dwordx4 v23, s[12:15], s28 offen offset:3072 nt lds
PV 104,152,48
EX 45
PV 108,156,48
s_add_u32 s28, s28, 0x40000
CV 54,44,45
PV 112,160,48
EX 46
PV 116,164,48
VR 180,13,40960
VR 182,13,45056
PV 120,168,48
EX 47
PV 124,172,48
VR 184,14,40960
CV 55,46,47
LM 208,48
VR 186,14,45056
VR 188,15,40960
QK 40,80,48,68
EX 32
QK 40,84,52,40
VR 190,15,45056
VR 192,16,40960
QK 40,88,56,40
EX 33
QK 40,92,60,40
VR 194,16,45056
CV 48,32,33
QK 44,96,48,68
EX 34
QK 44,100,52,44
VR 196,17,40960
VR 198,17,45056
QK 44,104,56,44
EX 35
QK 44,108,60,44
VR 200,18,40960
CV 49,34,35
PV 128,144,52
EX 36
PV 132,148,52
VR 202,18,45056
VR 204,19,40960
PV 136,152,52
EX 37
PV 140,156,52
VR 206,19,45056
CV 50,36,37
PV 144,160,52
EX 38
PV 148,164,52
PV 152,168,52
EX 39
PV 156,172,52
CV 51,38,39
LM 212,52
s_waitcnt vmcnt(12) lgkmcnt(15)
s_barrier
s_add_u32 s36, s36, 1
s_cbranch_scc1 QS_V400_2__36_s
QS_V400_2__36:
QK 32,112,0,56
EX 40
QK 32,116,4,32
KR 80,8,49152
KR 84,9,49152
QK 32,120,8,32
EX 41
QK 32,124,12,32
KR 88,10,49152
CV 52,40,41
QK 36,128,0,56
EX 42
QK 36,132,4,36
KR 92,11,49152
s_add_u32 m0, s27, 16384
QK 36,136,8,36
EX 43
QK 36,140,12,36
KR 96,8,53248
CV 53,42,43
PV 160,144,48
EX 44
PV 164,148,48
KR 100,9,53248
KR 104,10,53248
PV 168,152,48
EX 45
PV 172,156,48
KR 108,11,53248
CV 54,44,45
PV 176,160,48
EX 46
PV 180,164,48
buffer_load_dwordx4 v24, s[16:19], s29 offen offset:0 nt lds
PV 184,168,48
EX 47
PV 188,172,48
CV 55,46,47
LM 216,48
buffer_load_dwordx4 v25, s[16:19], s29 offen offset:1024 nt lds
QK 40,112,16,60
EX 32
QK 40,116,20,40
buffer_load_dwordx4 v26, s[16:19], s29 offen offset:2048 nt lds
QK 40,120,24,40
EX 33
QK 40,124,28,40
CV 48,32,33
QK 44,128,16,60
EX 34
QK 44,132,20,44
buffer_load_dwordx4 v27, s[16:19], s29 offen offset:3072 nt lds
QK 44,136,24,44
EX 35
QK 44,140,28,44
s_add_u32 s29, s29, 0x40000
CV 49,34,35
PV 192,144,52
EX 36
PV 196,148,52
PV 200,152,52
EX 37
PV 204,156,52
CV 50,36,37
PV 208,160,52
EX 38
PV 212,164,52
PV 216,168,52
EX 39
PV 220,172,52
CV 51,38,39
LM 220,52
QK 32,112,32,64
EX 40
QK 32,116,36,32
QK 32,120,40,32
EX 41
QK 32,124,44,32
CV 52,40,41
QK 36,128,32,64
EX 42
QK 36,132,36,36
QK 36,136,40,36
EX 43
QK 36,140,44,36
CV 53,42,43
s_waitcnt lgkmcnt(8)
PV 96,176,48
EX 44
PV 100,180,48
PV 104,184,48
EX 45
PV 108,188,48
CV 54,44,45
PV 112,192,48
EX 46
PV 116,196,48
PV 120,200,48
EX 47
PV 124,204,48
CV 55,46,47
LM 208,48
QK 40,112,48,68
EX 32
QK 40,116,52,40
QK 40,120,56,40
EX 33
QK 40,124,60,40
CV 48,32,33
QK 44,128,48,68
EX 34
QK 44,132,52,44
QK 44,136,56,44
EX 35
QK 44,140,60,44
CV 49,34,35
PV 128,176,52
EX 36
PV 132,180,52
PV 136,184,52
EX 37
PV 140,188,52
CV 50,36,37
PV 144,192,52
EX 38
PV 148,196,52
PV 152,200,52
EX 39
PV 156,204,52
CV 51,38,39
LM 212,52
s_add_u32 s71, s71, 1
s_cbranch_scc1 SPEC_V400_2
BODY_V400_3:
s_waitcnt lgkmcnt(0)
QK 32,80,0,56
EX 40
QK 32,84,4,32
VR 144,12,49152
VR 146,12,53248
QK 32,88,8,32
EX 41
QK 32,92,12,32
VR 148,13,49152
CV 52,40,41
QK 36,96,0,56
EX 42
QK 36,100,4,36
VR 150,13,53248
VR 152,14,49152
QK 36,104,8,36
EX 43
QK 36,108,12,36
VR 154,14,53248
CV 53,42,43
PV 160,176,48
EX 44
PV 164,180,48
VR 156,15,49152
VR 158,15,53248
PV 168,184,48
EX 45
PV 172,188,48
VR 160,16,49152
CV 54,44,45
PV 176,192,48
EX 46
PV 180,196,48
VR 162,16,53248
VR 164,17,49152
PV 184,200,48
EX 47
PV 188,204,48
VR 166,17,53248
CV 55,46,47
LM 216,48
VR 168,18,49152
VR 170,18,53248
QK 40,80,16,60
EX 32
QK 40,84,20,40
VR 172,19,49152
VR 174,19,53248
QK 40,88,24,40
EX 33
QK 40,92,28,40
KR 112,8,57344
CV 48,32,33
QK 44,96,16,60
EX 34
QK 44,100,20,44
KR 116,9,57344
KR 120,10,57344
QK 44,104,24,44
EX 35
QK 44,108,28,44
KR 124,11,57344
CV 49,34,35
PV 192,176,52
EX 36
PV 196,180,52
s_add_u32 m0, s26, 32768
KR 128,8,61440
PV 200,184,52
EX 37
PV 204,188,52
KR 132,9,61440
CV 50,36,37
PV 208,192,52
EX 38
PV 212,196,52
KR 136,10,61440
KR 140,11,61440
PV 216,200,52
EX 39
PV 220,204,52
CV 51,38,39
LM 220,52
buffer_load_dwordx4 v20, s[12:15], s28 offen offset:0 nt lds
QK 32,80,32,64
EX 40
QK 32,84,36,32
buffer_load_dwordx4 v21, s[12:15], s28 offen offset:1024 nt lds
QK 32,88,40,32
EX 41
QK 32,92,44,32
VR 176,12,57344
CV 52,40,41
QK 36,96,32,64
EX 42
QK 36,100,36,36
buffer_load_dwordx4 v22, s[12:15], s28 offen offset:2048 nt lds
QK 36,104,40,36
EX 43
QK 36,108,44,36
VR 178,12,61440
CV 53,42,43
s_waitcnt lgkmcnt(10)
PV 96,144,48
EX 44
PV 100,148,48
buffer_load_dwordx4 v23, s[12:15], s28 offen offset:3072 nt lds
PV 104,152,48
EX 45
PV 108,156,48
s_add_u32 s28, s28, 0x40000
CV 54,44,45
PV 112,160,48
EX 46
PV 116,164,48
VR 180,13,57344
VR 182,13,61440
PV 120,168,48
EX 47
PV 124,172,48
VR 184,14,57344
CV 55,46,47
LM 208,48
VR 186,14,61440
VR 188,15,57344
QK 40,80,48,68
EX 32
QK 40,84,52,40
VR 190,15,61440
VR 192,16,57344
QK 40,88,56,40
EX 33
QK 40,92,60,40
VR 194,16,61440
CV 48,32,33
QK 44,96,48,68
EX 34
QK 44,100,52,44
VR 196,17,57344
VR 198,17,61440
QK 44,104,56,44
EX 35
QK 44,108,60,44
VR 200,18,57344
CV 49,34,35
PV 128,144,52
EX 36
PV 132,148,52
VR 202,18,61440
VR 204,19,57344
PV 136,152,52
EX 37
PV 140,156,52
VR 206,19,61440
CV 50,36,37
PV 144,160,52
EX 38
PV 148,164,52
PV 152,168,52
EX 39
PV 156,172,52
CV 51,38,39
LM 212,52
s_waitcnt vmcnt(12) lgkmcnt(15)
s_barrier
s_add_u32 s36, s36, 1
s_cbranch_scc1 QS_V400_3__37_s
QS_V400_3__37:
QK 32,112,0,56
EX 40
QK 32,116,4,32
KR 80,8,0
KR 84,9,0
QK 32,120,8,32
EX 41
QK 32,124,12,32
KR 88,10,0
CV 52,40,41
QK 36,128,0,56
EX 42
QK 36,132,4,36
KR 92,11,0
s_add_u32 m0, s27, 32768
QK 36,136,8,36
EX 43
QK 36,140,12,36
KR 96,8,4096
CV 53,42,43
PV 160,144,48
EX 44
PV 164,148,48
KR 100,9,4096
KR 104,10,4096
PV 168,152,48
EX 45
PV 172,156,48
KR 108,11,4096
CV 54,44,45
PV 176,160,48
EX 46
PV 180,164,48
buffer_load_dwordx4 v24, s[16:19], s29 offen offset:0 nt lds
PV 184,168,48
EX 47
PV 188,172,48
CV 55,46,47
LM 216,48
buffer_load_dwordx4 v25, s[16:19], s29 offen offset:1024 nt lds
QK 40,112,16,60
EX 32
QK 40,116,20,40
buffer_load_dwordx4 v26, s[16:19], s29 offen offset:2048 nt lds
QK 40,120,24,40
EX 33
QK 40,124,28,40
CV 48,32,33
QK 44,128,16,60
EX 34
QK 44,132,20,44
buffer_load_dwordx4 v27, s[16:19], s29 offen offset:3072 nt lds
QK 44,136,24,44
EX 35
QK 44,140,28,44
s_add_u32 s29, s29, 0x40000
CV 49,34,35
PV 192,144,52
EX 36
PV 196,148,52
PV 200,152,52
EX 37
PV 204,156,52
CV 50,36,37
PV 208,160,52
EX 38
PV 212,164,52
PV 216,168,52
EX 39
PV 220,172,52
CV 51,38,39
LM 220,52
QK 32,112,32,64
EX 40
QK 32,116,36,32
QK 32,120,40,32
EX 41
QK 32,124,44,32
CV 52,40,41
QK 36,128,32,64
EX 42
QK 36,132,36,36
QK 36,136,40,36
EX 43
QK 36,140,44,36
CV 53,42,43
s_waitcnt lgkmcnt(8)
PV 96,176,48
EX 44
PV 100,180,48
PV 104,184,48
EX 45
PV 108,188,48
CV 54,44,45
PV 112,192,48
EX 46
PV 116,196,48
PV 120,200,48
EX 47
PV 124,204,48
CV 55,46,47
LM 208,48
QK 40,112,48,68
EX 32
QK 40,116,52,40
QK 40,120,56,40
EX 33
QK 40,124,60,40
CV 48,32,33
QK 44,128,48,68
EX 34
QK 44,132,52,44
QK 44,136,56,44
EX 35
QK 44,140,60,44
CV 49,34,35
PV 128,176,52
EX 36
PV 132,180,52
PV 136,184,52
EX 37
PV 140,188,52
CV 50,36,37
PV 144,192,52
EX 38
PV 148,196,52
PV 152,200,52
EX 39
PV 156,204,52
CV 51,38,39
LM 212,52
s_add_u32 s71, s71, 1
s_cbranch_scc1 SPEC_V400_3
s_branch BODY_V400_0
QS_V400_0__34_s:
s_call_b64 s[38:39], QX
s_branch QS_V400_0__34
QS_V400_1__35_s:
s_call_b64 s[38:39], QX
s_branch QS_V400_1__35
QS_V400_2__36_s:
s_call_b64 s[38:39], QX
s_branch QS_V400_2__36
QS_V400_3__37_s:
s_call_b64 s[38:39], QX
s_branch QS_V400_3__37
SPEC_V400_0:
s_mov_b32 s71, -1
s_add_u32 s77, s77, 1
s_cmp_eq_u32 s77, 3
s_cbranch_scc1 TAIL_V400_1
s_cmp_eq_u32 s77, 2
s_cbranch_scc1 BODY_V400_1
s_mov_b32 s28, s54
s_mov_b32 s29, s54
s_mov_b32 s14, s56
s_mov_b32 s18, s56
s_branch BODY_V400_1
SPEC_V400_1:
s_mov_b32 s71, -1
s_add_u32 s77, s77, 1
s_cmp_eq_u32 s77, 3
s_cbranch_scc1 TAIL_V400_2
s_cmp_eq_u32 s77, 2
s_cbranch_scc1 BODY_V400_2
s_mov_b32 s28, s54
s_mov_b32 s29, s54
s_mov_b32 s14, s56
s_mov_b32 s18, s56
s_branch BODY_V400_2
SPEC_V400_2:
s_mov_b32 s71, -1
s_add_u32 s77, s77, 1
s_cmp_eq_u32 s77, 3
s_cbranch_scc1 TAIL_V400_3
s_cmp_eq_u32 s77, 2
s_cbranch_scc1 BODY_V400_3
s_mov_b32 s28, s54
s_mov_b32 s29, s54
s_mov_b32 s14, s56
s_mov_b32 s18, s56
s_branch BODY_V400_3
SPEC_V400_3:
s_mov_b32 s71, -1
s_add_u32 s77, s77, 1
s_cmp_eq_u32 s77, 3
s_cbranch_scc1 TAIL_V400_0
s_cmp_eq_u32 s77, 2
s_cbranch_scc1 BODY_V400_0
s_mov_b32 s28, s54
s_mov_b32 s29, s54
s_mov_b32 s14, s56
s_mov_b32 s18, s56
s_branch BODY_V400_0
TAIL_V400_0:
s_waitcnt lgkmcnt(0)
QK 32,80,0,56
EX 40
QK 32,84,4,32
VR 144,12,0
VR 146,12,4096
QK 32,88,8,32
EX 41
QK 32,92,12,32
VR 148,13,0
CV 52,40,41
QK 36,96,0,56
EX 42
QK 36,100,4,36
VR 150,13,4096
VR 152,14,0
QK 36,104,8,36
EX 43
QK 36,108,12,36
VR 154,14,4096
CV 53,42,43
PV 160,176,48
EX 44
PV 164,180,48
VR 156,15,0
VR 158,15,4096
PV 168,184,48
EX 45
PV 172,188,48
VR 160,16,0
CV 54,44,45
PV 176,192,48
EX 46
PV 180,196,48
VR 162,16,4096
VR 164,17,0
PV 184,200,48
EX 47
PV 188,204,48
VR 166,17,4096
CV 55,46,47
LM 216,48
VR 168,18,0
VR 170,18,4096
QK 40,80,16,60
EX 32
QK 40,84,20,40
VR 172,19,0
VR 174,19,4096
QK 40,88,24,40
EX 33
QK 40,92,28,40
KR 112,8,8192
CV 48,32,33
QK 44,96,16,60
EX 34
QK 44,100,20,44
KR 116,9,8192
KR 120,10,8192
QK 44,104,24,44
EX 35
QK 44,108,28,44
KR 124,11,8192
CV 49,34,35
PV 192,176,52
EX 36
PV 196,180,52
s_add_u32 m0, s26, 49152
KR 128,8,12288
PV 200,184,52
EX 37
PV 204,188,52
KR 132,9,12288
CV 50,36,37
PV 208,192,52
EX 38
PV 212,196,52
KR 136,10,12288
KR 140,11,12288
PV 216,200,52
EX 39
PV 220,204,52
CV 51,38,39
LM 220,52
buffer_load_dwordx4 v20, s[12:15], s28 offen offset:0 nt lds
QK 32,80,32,64
EX 40
QK 32,84,36,32
buffer_load_dwordx4 v21, s[12:15], s28 offen offset:1024 nt lds
QK 32,88,40,32
EX 41
QK 32,92,44,32
VR 176,12,8192
CV 52,40,41
QK 36,96,32,64
EX 42
QK 36,100,36,36
buffer_load_dwordx4 v22, s[12:15], s28 offen offset:2048 nt lds
QK 36,104,40,36
EX 43
QK 36,108,44,36
VR 178,12,12288
CV 53,42,43
s_waitcnt lgkmcnt(10)
PV 96,144,48
EX 44
PV 100,148,48
buffer_load_dwordx4 v23, s[12:15], s28 offen offset:3072 nt lds
PV 104,152,48
EX 45
PV 108,156,48
s_add_u32 s28, s28, 0x40000
CV 54,44,45
PV 112,160,48
EX 46
PV 116,164,48
VR 180,13,8192
VR 182,13,12288
PV 120,168,48
EX 47
PV 124,172,48
VR 184,14,8192
CV 55,46,47
LM 208,48
VR 186,14,12288
VR 188,15,8192
QK 40,80,48,68
EX 32
QK 40,84,52,40
VR 190,15,12288
VR 192,16,8192
QK 40,88,56,40
EX 33
QK 40,92,60,40
VR 194,16,12288
CV 48,32,33
QK 44,96,48,68
EX 34
QK 44,100,52,44
VR 196,17,8192
VR 198,17,12288
QK 44,104,56,44
EX 35
QK 44,108,60,44
VR 200,18,8192
CV 49,34,35
PV 128,144,52
EX 36
PV 132,148,52
VR 202,18,12288
VR 204,19,8192
PV 136,152,52
EX 37
PV 140,156,52
VR 206,19,12288
CV 50,36,37
PV 144,160,52
EX 38
PV 148,164,52
PV 152,168,52
EX 39
PV 156,172,52
CV 51,38,39
LM 212,52
s_waitcnt vmcnt(12) lgkmcnt(15)
s_barrier
v_add_f32 v32, v56, v76
v_add_f32 v33, v56, v77
v_add_f32 v34, v56, v78
v_add_f32 v35, v56, v79
v_add_f32 v36, v56, v80
v_add_f32 v37, v56, v81
v_add_f32 v38, v56, v82
v_add_f32 v39, v56, v83
s_nop 1
QK 32,112,0,32
EX 40
QK 32,116,4,32
KR 80,8,16384
KR 84,9,16384
QK 32,120,8,32
EX 41
QK 32,124,12,32
KR 88,10,16384
CV 52,40,41
QK 36,128,0,36
EX 42
QK 36,132,4,36
KR 92,11,16384
s_add_u32 m0, s27, 49152
QK 36,136,8,36
EX 43
QK 36,140,12,36
KR 96,8,20480
CV 53,42,43
PV 160,144,48
EX 44
PV 164,148,48
KR 100,9,20480
KR 104,10,20480
PV 168,152,48
EX 45
PV 172,156,48
KR 108,11,20480
CV 54,44,45
PV 176,160,48
EX 46
PV 180,164,48
buffer_load_dwordx4 v24, s[16:19], s29 offen offset:0 nt lds
PV 184,168,48
EX 47
PV 188,172,48
CV 55,46,47
LM 216,48
buffer_load_dwordx4 v25, s[16:19], s29 offen offset:1024 nt lds
v_add_f32 v40, v60, v76
v_add_f32 v41, v60, v77
v_add_f32 v42, v60, v78
v_add_f32 v43, v60, v79
v_add_f32 v44, v60, v80
v_add_f32 v45, v60, v81
v_add_f32 v46, v60, v82
v_add_f32 v47, v60, v83
s_nop 1
QK 40,112,16,40
EX 32
QK 40,116,20,40
buffer_load_dwordx4 v26, s[16:19], s29 offen offset:2048 nt lds
QK 40,120,24,40
EX 33
QK 40,124,28,40
CV 48,32,33
QK 44,128,16,44
EX 34
QK 44,132,20,44
buffer_load_dwordx4 v27, s[16:19], s29 offen offset:3072 nt lds
QK 44,136,24,44
EX 35
QK 44,140,28,44
s_add_u32 s29, s29, 0x40000
CV 49,34,35
PV 192,144,52
EX 36
PV 196,148,52
PV 200,152,52
EX 37
PV 204,156,52
CV 50,36,37
PV 208,160,52
EX 38
PV 212,164,52
PV 216,168,52
EX 39
PV 220,172,52
CV 51,38,39
LM 220,52
v_add_f32 v32, v64, v76
v_add_f32 v33, v64, v77
v_add_f32 v34, v64, v78
v_add_f32 v35, v64, v79
v_add_f32 v36, v64, v80
v_add_f32 v37, v64, v81
v_add_f32 v38, v64, v82
v_add_f32 v39, v64, v83
s_nop 1
QK 32,112,32,32
EX 40
QK 32,116,36,32
QK 32,120,40,32
EX 41
QK 32,124,44,32
CV 52,40,41
QK 36,128,32,36
EX 42
QK 36,132,36,36
QK 36,136,40,36
EX 43
QK 36,140,44,36
CV 53,42,43
s_waitcnt lgkmcnt(8)
PV 96,176,48
EX 44
PV 100,180,48
PV 104,184,48
EX 45
PV 108,188,48
CV 54,44,45
PV 112,192,48
EX 46
PV 116,196,48
PV 120,200,48
EX 47
PV 124,204,48
CV 55,46,47
LM 208,48
v_add_f32 v40, v68, v76
v_add_f32 v41, v68, v77
v_add_f32 v42, v68, v78
v_add_f32 v43, v68, v79
v_add_f32 v44, v68, v80
v_add_f32 v45, v68, v81
v_add_f32 v46, v68, v82
v_add_f32 v47, v68, v83
s_nop 1
QK 40,112,48,40
EX 32
QK 40,116,52,40
QK 40,120,56,40
EX 33
QK 40,124,60,40
CV 48,32,33
QK 44,128,48,44
EX 34
QK 44,132,52,44
QK 44,136,56,44
EX 35
QK 44,140,60,44
CV 49,34,35
PV 128,176,52
EX 36
PV 132,180,52
PV 136,184,52
EX 37
PV 140,188,52
CV 50,36,37
PV 144,192,52
EX 38
PV 148,196,52
PV 152,200,52
EX 39
PV 156,204,52
CV 51,38,39
LM 212,52
s_waitcnt lgkmcnt(0)
PV 160,176,48
EX 40
PV 164,180,48
EX 41
PV 168,184,48
EX 42
PV 172,188,48
EX 43
PV 176,192,48
EX 44
PV 180,196,48
EX 45
PV 184,200,48
EX 46
PV 188,204,48
EX 47
LM 216,48
CV 52,40,41
CV 53,42,43
CV 54,44,45
CV 55,46,47
s_nop 1
LM 220,52
PV 192,176,52
PV 196,180,52
PV 200,184,52
PV 204,188,52
PV 208,192,52
PV 212,196,52
PV 216,200,52
PV 220,204,52
s_mov_b32 s72, 1
s_branch EPI_V400
TAIL_V400_1:
s_waitcnt lgkmcnt(0)
QK 32,80,0,56
EX 40
QK 32,84,4,32
VR 144,12,16384
VR 146,12,20480
QK 32,88,8,32
EX 41
QK 32,92,12,32
VR 148,13,16384
CV 52,40,41
QK 36,96,0,56
EX 42
QK 36,100,4,36
VR 150,13,20480
VR 152,14,16384
QK 36,104,8,36
EX 43
QK 36,108,12,36
VR 154,14,20480
CV 53,42,43
PV 160,176,48
EX 44
PV 164,180,48
VR 156,15,16384
VR 158,15,20480
PV 168,184,48
EX 45
PV 172,188,48
VR 160,16,16384
CV 54,44,45
PV 176,192,48
EX 46
PV 180,196,48
VR 162,16,20480
VR 164,17,16384
PV 184,200,48
EX 47
PV 188,204,48
VR 166,17,20480
CV 55,46,47
LM 216,48
VR 168,18,16384
VR 170,18,20480
QK 40,80,16,60
EX 32
QK 40,84,20,40
VR 172,19,16384
VR 174,19,20480
QK 40,88,24,40
EX 33
QK 40,92,28,40
KR 112,8,24576
CV 48,32,33
QK 44,96,16,60
EX 34
QK 44,100,20,44
KR 116,9,24576
KR 120,10,24576
QK 44,104,24,44
EX 35
QK 44,108,28,44
KR 124,11,24576
CV 49,34,35
PV 192,176,52
EX 36
PV 196,180,52
s_add_u32 m0, s26, 0
KR 128,8,28672
PV 200,184,52
EX 37
PV 204,188,52
KR 132,9,28672
CV 50,36,37
PV 208,192,52
EX 38
PV 212,196,52
KR 136,10,28672
KR 140,11,28672
PV 216,200,52
EX 39
PV 220,204,52
CV 51,38,39
LM 220,52
buffer_load_dwordx4 v20, s[12:15], s28 offen offset:0 nt lds
QK 32,80,32,64
EX 40
QK 32,84,36,32
buffer_load_dwordx4 v21, s[12:15], s28 offen offset:1024 nt lds
QK 32,88,40,32
EX 41
QK 32,92,44,32
VR 176,12,24576
CV 52,40,41
QK 36,96,32,64
EX 42
QK 36,100,36,36
buffer_load_dwordx4 v22, s[12:15], s28 offen offset:2048 nt lds
QK 36,104,40,36
EX 43
QK 36,108,44,36
VR 178,12,28672
CV 53,42,43
s_waitcnt lgkmcnt(10)
PV 96,144,48
EX 44
PV 100,148,48
buffer_load_dwordx4 v23, s[12:15], s28 offen offset:3072 nt lds
PV 104,152,48
EX 45
PV 108,156,48
s_add_u32 s28, s28, 0x40000
CV 54,44,45
PV 112,160,48
EX 46
PV 116,164,48
VR 180,13,24576
VR 182,13,28672
PV 120,168,48
EX 47
PV 124,172,48
VR 184,14,24576
CV 55,46,47
LM 208,48
VR 186,14,28672
VR 188,15,24576
QK 40,80,48,68
EX 32
QK 40,84,52,40
VR 190,15,28672
VR 192,16,24576
QK 40,88,56,40
EX 33
QK 40,92,60,40
VR 194,16,28672
CV 48,32,33
QK 44,96,48,68
EX 34
QK 44,100,52,44
VR 196,17,24576
VR 198,17,28672
QK 44,104,56,44
EX 35
QK 44,108,60,44
VR 200,18,24576
CV 49,34,35
PV 128,144,52
EX 36
PV 132,148,52
VR 202,18,28672
VR 204,19,24576
PV 136,152,52
EX 37
PV 140,156,52
VR 206,19,28672
CV 50,36,37
PV 144,160,52
EX 38
PV 148,164,52
PV 152,168,52
EX 39
PV 156,172,52
CV 51,38,39
LM 212,52
s_waitcnt vmcnt(12) lgkmcnt(15)
s_barrier
v_add_f32 v32, v56, v76
v_add_f32 v33, v56, v77
v_add_f32 v34, v56, v78
v_add_f32 v35, v56, v79
v_add_f32 v36, v56, v80
v_add_f32 v37, v56, v81
v_add_f32 v38, v56, v82
v_add_f32 v39, v56, v83
s_nop 1
QK 32,112,0,32
EX 40
QK 32,116,4,32
KR 80,8,32768
KR 84,9,32768
QK 32,120,8,32
EX 41
QK 32,124,12,32
KR 88,10,32768
CV 52,40,41
QK 36,128,0,36
EX 42
QK 36,132,4,36
KR 92,11,32768
s_add_u32 m0, s27, 0
QK 36,136,8,36
EX 43
QK 36,140,12,36
KR 96,8,36864
CV 53,42,43
PV 160,144,48
EX 44
PV 164,148,48
KR 100,9,36864
KR 104,10,36864
PV 168,152,48
EX 45
PV 172,156,48
KR 108,11,36864
CV 54,44,45
PV 176,160,48
EX 46
PV 180,164,48
buffer_load_dwordx4 v24, s[16:19], s29 offen offset:0 nt lds
PV 184,168,48
EX 47
PV 188,172,48
CV 55,46,47
LM 216,48
buffer_load_dwordx4 v25, s[16:19], s29 offen offset:1024 nt lds
v_add_f32 v40, v60, v76
v_add_f32 v41, v60, v77
v_add_f32 v42, v60, v78
v_add_f32 v43, v60, v79
v_add_f32 v44, v60, v80
v_add_f32 v45, v60, v81
v_add_f32 v46, v60, v82
v_add_f32 v47, v60, v83
s_nop 1
QK 40,112,16,40
EX 32
QK 40,116,20,40
buffer_load_dwordx4 v26, s[16:19], s29 offen offset:2048 nt lds
QK 40,120,24,40
EX 33
QK 40,124,28,40
CV 48,32,33
QK 44,128,16,44
EX 34
QK 44,132,20,44
buffer_load_dwordx4 v27, s[16:19], s29 offen offset:3072 nt lds
QK 44,136,24,44
EX 35
QK 44,140,28,44
s_add_u32 s29, s29, 0x40000
CV 49,34,35
PV 192,144,52
EX 36
PV 196,148,52
PV 200,152,52
EX 37
PV 204,156,52
CV 50,36,37
PV 208,160,52
EX 38
PV 212,164,52
PV 216,168,52
EX 39
PV 220,172,52
CV 51,38,39
LM 220,52
v_add_f32 v32, v64, v76
v_add_f32 v33, v64, v77
v_add_f32 v34, v64, v78
v_add_f32 v35, v64, v79
v_add_f32 v36, v64, v80
v_add_f32 v37, v64, v81
v_add_f32 v38, v64, v82
v_add_f32 v39, v64, v83
s_nop 1
QK 32,112,32,32
EX 40
QK 32,116,36,32
QK 32,120,40,32
EX 41
QK 32,124,44,32
CV 52,40,41
QK 36,128,32,36
EX 42
QK 36,132,36,36
QK 36,136,40,36
EX 43
QK 36,140,44,36
CV 53,42,43
s_waitcnt lgkmcnt(8)
PV 96,176,48
EX 44
PV 100,180,48
PV 104,184,48
EX 45
PV 108,188,48
CV 54,44,45
PV 112,192,48
EX 46
PV 116,196,48
PV 120,200,48
EX 47
PV 124,204,48
CV 55,46,47
LM 208,48
v_add_f32 v40, v68, v76
v_add_f32 v41, v68, v77
v_add_f32 v42, v68, v78
v_add_f32 v43, v68, v79
v_add_f32 v44, v68, v80
v_add_f32 v45, v68, v81
v_add_f32 v46, v68, v82
v_add_f32 v47, v68, v83
s_nop 1
QK 40,112,48,40
EX 32
QK 40,116,52,40
QK 40,120,56,40
EX 33
QK 40,124,60,40
CV 48,32,33
QK 44,128,48,44
EX 34
QK 44,132,52,44
QK 44,136,56,44
EX 35
QK 44,140,60,44
CV 49,34,35
PV 128,176,52
EX 36
PV 132,180,52
PV 136,184,52
EX 37
PV 140,188,52
CV 50,36,37
PV 144,192,52
EX 38
PV 148,196,52
PV 152,200,52
EX 39
PV 156,204,52
CV 51,38,39
LM 212,52
s_waitcnt lgkmcnt(0)
PV 160,176,48
EX 40
PV 164,180,48
EX 41
PV 168,184,48
EX 42
PV 172,188,48
EX 43
PV 176,192,48
EX 44
PV 180,196,48
EX 45
PV 184,200,48
EX 46
PV 188,204,48
EX 47
LM 216,48
CV 52,40,41
CV 53,42,43
CV 54,44,45
CV 55,46,47
s_nop 1
LM 220,52
PV 192,176,52
PV 196,180,52
PV 200,184,52
PV 204,188,52
PV 208,192,52
PV 212,196,52
PV 216,200,52
PV 220,204,52
s_mov_b32 s72, 2
s_branch EPI_V400
TAIL_V400_2:
s_waitcnt lgkmcnt(0)
QK 32,80,0,56
EX 40
QK 32,84,4,32
VR 144,12,32768
VR 146,12,36864
QK 32,88,8,32
EX 41
QK 32,92,12,32
VR 148,13,32768
CV 52,40,41
QK 36,96,0,56
EX 42
QK 36,100,4,36
VR 150,13,36864
VR 152,14,32768
QK 36,104,8,36
EX 43
QK 36,108,12,36
VR 154,14,36864
CV 53,42,43
PV 160,176,48
EX 44
PV 164,180,48
VR 156,15,32768
VR 158,15,36864
PV 168,184,48
EX 45
PV 172,188,48
VR 160,16,32768
CV 54,44,45
PV 176,192,48
EX 46
PV 180,196,48
VR 162,16,36864
VR 164,17,32768
PV 184,200,48
EX 47
PV 188,204,48
VR 166,17,36864
CV 55,46,47
LM 216,48
VR 168,18,32768
VR 170,18,36864
QK 40,80,16,60
EX 32
QK 40,84,20,40
VR 172,19,32768
VR 174,19,36864
QK 40,88,24,40
EX 33
QK 40,92,28,40
KR 112,8,40960
CV 48,32,33
QK 44,96,16,60
EX 34
QK 44,100,20,44
KR 116,9,40960
KR 120,10,40960
QK 44,104,24,44
EX 35
QK 44,108,28,44
KR 124,11,40960
CV 49,34,35
PV 192,176,52
EX 36
PV 196,180,52
s_add_u32 m0, s26, 16384
KR 128,8,45056
PV 200,184,52
EX 37
PV 204,188,52
KR 132,9,45056
CV 50,36,37
PV 208,192,52
EX 38
PV 212,196,52
KR 136,10,45056
KR 140,11,45056
PV 216,200,52
EX 39
PV 220,204,52
CV 51,38,39
LM 220,52
buffer_load_dwordx4 v20, s[12:15], s28 offen offset:0 nt lds
QK 32,80,32,64
EX 40
QK 32,84,36,32
buffer_load_dwordx4 v21, s[12:15], s28 offen offset:1024 nt lds
QK 32,88,40,32
EX 41
QK 32,92,44,32
VR 176,12,40960
CV 52,40,41
QK 36,96,32,64
EX 42
QK 36,100,36,36
buffer_load_dwordx4 v22, s[12:15], s28 offen offset:2048 nt lds
QK 36,104,40,36
EX 43
QK 36,108,44,36
VR 178,12,45056
CV 53,42,43
s_waitcnt lgkmcnt(10)
PV 96,144,48
EX 44
PV 100,148,48
buffer_load_dwordx4 v23, s[12:15], s28 offen offset:3072 nt lds
PV 104,152,48
EX 45
PV 108,156,48
s_add_u32 s28, s28, 0x40000
CV 54,44,45
PV 112,160,48
EX 46
PV 116,164,48
VR 180,13,40960
VR 182,13,45056
PV 120,168,48
EX 47
PV 124,172,48
VR 184,14,40960
CV 55,46,47
LM 208,48
VR 186,14,45056
VR 188,15,40960
QK 40,80,48,68
EX 32
QK 40,84,52,40
VR 190,15,45056
VR 192,16,40960
QK 40,88,56,40
EX 33
QK 40,92,60,40
VR 194,16,45056
CV 48,32,33
QK 44,96,48,68
EX 34
QK 44,100,52,44
VR 196,17,40960
VR 198,17,45056
QK 44,104,56,44
EX 35
QK 44,108,60,44
VR 200,18,40960
CV 49,34,35
PV 128,144,52
EX 36
PV 132,148,52
VR 202,18,45056
VR 204,19,40960
PV 136,152,52
EX 37
PV 140,156,52
VR 206,19,45056
CV 50,36,37
PV 144,160,52
EX 38
PV 148,164,52
PV 152,168,52
EX 39
PV 156,172,52
CV 51,38,39
LM 212,52
s_waitcnt vmcnt(12) lgkmcnt(15)
s_barrier
v_add_f32 v32, v56, v76
v_add_f32 v33, v56, v77
v_add_f32 v34, v56, v78
v_add_f32 v35, v56, v79
v_add_f32 v36, v56, v80
v_add_f32 v37, v56, v81
v_add_f32 v38, v56, v82
v_add_f32 v39, v56, v83
s_nop 1
QK 32,112,0,32
EX 40
QK 32,116,4,32
KR 80,8,49152
KR 84,9,49152
QK 32,120,8,32
EX 41
QK 32,124,12,32
KR 88,10,49152
CV 52,40,41
QK 36,128,0,36
EX 42
QK 36,132,4,36
KR 92,11,49152
s_add_u32 m0, s27, 16384
QK 36,136,8,36
EX 43
QK 36,140,12,36
KR 96,8,53248
CV 53,42,43
PV 160,144,48
EX 44
PV 164,148,48
KR 100,9,53248
KR 104,10,53248
PV 168,152,48
EX 45
PV 172,156,48
KR 108,11,53248
CV 54,44,45
PV 176,160,48
EX 46
PV 180,164,48
buffer_load_dwordx4 v24, s[16:19], s29 offen offset:0 nt lds
PV 184,168,48
EX 47
PV 188,172,48
CV 55,46,47
LM 216,48
buffer_load_dwordx4 v25, s[16:19], s29 offen offset:1024 nt lds
v_add_f32 v40, v60, v76
v_add_f32 v41, v60, v77
v_add_f32 v42, v60, v78
v_add_f32 v43, v60, v79
v_add_f32 v44, v60, v80
v_add_f32 v45, v60, v81
v_add_f32 v46, v60, v82
v_add_f32 v47, v60, v83
s_nop 1
QK 40,112,16,40
EX 32
QK 40,116,20,40
buffer_load_dwordx4 v26, s[16:19], s29 offen offset:2048 nt lds
QK 40,120,24,40
EX 33
QK 40,124,28,40
CV 48,32,33
QK 44,128,16,44
EX 34
QK 44,132,20,44
buffer_load_dwordx4 v27, s[16:19], s29 offen offset:3072 nt lds
QK 44,136,24,44
EX 35
QK 44,140,28,44
s_add_u32 s29, s29, 0x40000
CV 49,34,35
PV 192,144,52
EX 36
PV 196,148,52
PV 200,152,52
EX 37
PV 204,156,52
CV 50,36,37
PV 208,160,52
EX 38
PV 212,164,52
PV 216,168,52
EX 39
PV 220,172,52
CV 51,38,39
LM 220,52
v_add_f32 v32, v64, v76
v_add_f32 v33, v64, v77
v_add_f32 v34, v64, v78
v_add_f32 v35, v64, v79
v_add_f32 v36, v64, v80
v_add_f32 v37, v64, v81
v_add_f32 v38, v64, v82
v_add_f32 v39, v64, v83
s_nop 1
QK 32,112,32,32
EX 40
QK 32,116,36,32
QK 32,120,40,32
EX 41
QK 32,124,44,32
CV 52,40,41
QK 36,128,32,36
EX 42
QK 36,132,36,36
QK 36,136,40,36
EX 43
QK 36,140,44,36
CV 53,42,43
s_waitcnt lgkmcnt(8)
PV 96,176,48
EX 44
PV 100,180,48
PV 104,184,48
EX 45
PV 108,188,48
CV 54,44,45
PV 112,192,48
EX 46
PV 116,196,48
PV 120,200,48
EX 47
PV 124,204,48
CV 55,46,47
LM 208,48
v_add_f32 v40, v68, v76
v_add_f32 v41, v68, v77
v_add_f32 v42, v68, v78
v_add_f32 v43, v68, v79
v_add_f32 v44, v68, v80
v_add_f32 v45, v68, v81
v_add_f32 v46, v68, v82
v_add_f32 v47, v68, v83
s_nop 1
QK 40,112,48,40
EX 32
QK 40,116,52,40
QK 40,120,56,40
EX 33
QK 40,124,60,40
CV 48,32,33
QK 44,128,48,44
EX 34
QK 44,132,52,44
QK 44,136,56,44
EX 35
QK 44,140,60,44
CV 49,34,35
PV 128,176,52
EX 36
PV 132,180,52
PV 136,184,52
EX 37
PV 140,188,52
CV 50,36,37
PV 144,192,52
EX 38
PV 148,196,52
PV 152,200,52
EX 39
PV 156,204,52
CV 51,38,39
LM 212,52
s_waitcnt lgkmcnt(0)
PV 160,176,48
EX 40
PV 164,180,48
EX 41
PV 168,184,48
EX 42
PV 172,188,48
EX 43
PV 176,192,48
EX 44
PV 180,196,48
EX 45
PV 184,200,48
EX 46
PV 188,204,48
EX 47
LM 216,48
CV 52,40,41
CV 53,42,43
CV 54,44,45
CV 55,46,47
s_nop 1
LM 220,52
PV 192,176,52
PV 196,180,52
PV 200,184,52
PV 204,188,52
PV 208,192,52
PV 212,196,52
PV 216,200,52
PV 220,204,52
s_mov_b32 s72, 3
s_branch EPI_V400
TAIL_V400_3:
s_waitcnt lgkmcnt(0)
QK 32,80,0,56
EX 40
QK 32,84,4,32
VR 144,12,49152
VR 146,12,53248
QK 32,88,8,32
EX 41
QK 32,92,12,32
VR 148,13,49152
CV 52,40,41
QK 36,96,0,56
EX 42
QK 36,100,4,36
VR 150,13,53248
VR 152,14,49152
QK 36,104,8,36
EX 43
QK 36,108,12,36
VR 154,14,53248
CV 53,42,43
PV 160,176,48
EX 44
PV 164,180,48
VR 156,15,49152
VR 158,15,53248
PV 168,184,48
EX 45
PV 172,188,48
VR 160,16,49152
CV 54,44,45
PV 176,192,48
EX 46
PV 180,196,48
VR 162,16,53248
VR 164,17,49152
PV 184,200,48
EX 47
PV 188,204,48
VR 166,17,53248
CV 55,46,47
LM 216,48
VR 168,18,49152
VR 170,18,53248
QK 40,80,16,60
EX 32
QK 40,84,20,40
VR 172,19,49152
VR 174,19,53248
QK 40,88,24,40
EX 33
QK 40,92,28,40
KR 112,8,57344
CV 48,32,33
QK 44,96,16,60
EX 34
QK 44,100,20,44
KR 116,9,57344
KR 120,10,57344
QK 44,104,24,44
EX 35
QK 44,108,28,44
KR 124,11,57344
CV 49,34,35
PV 192,176,52
EX 36
PV 196,180,52
s_add_u32 m0, s26, 32768
KR 128,8,61440
PV 200,184,52
EX 37
PV 204,188,52
KR 132,9,61440
CV 50,36,37
PV 208,192,52
EX 38
PV 212,196,52
KR 136,10,61440
KR 140,11,61440
PV 216,200,52
EX 39
PV 220,204,52
CV 51,38,39
LM 220,52
buffer_load_dwordx4 v20, s[12:15], s28 offen offset:0 nt lds
QK 32,80,32,64
EX 40
QK 32,84,36,32
buffer_load_dwordx4 v21, s[12:15], s28 offen offset:1024 nt lds
QK 32,88,40,32
EX 41
QK 32,92,44,32
VR 176,12,57344
CV 52,40,41
QK 36,96,32,64
EX 42
QK 36,100,36,36
buffer_load_dwordx4 v22, s[12:15], s28 offen offset:2048 nt lds
QK 36,104,40,36
EX 43
QK 36,108,44,36
VR 178,12,61440
CV 53,42,43
s_waitcnt lgkmcnt(10)
PV 96,144,48
EX 44
PV 100,148,48
buffer_load_dwordx4 v23, s[12:15], s28 offen offset:3072 nt lds
PV 104,152,48
EX 45
PV 108,156,48
s_add_u32 s28, s28, 0x40000
CV 54,44,45
PV 112,160,48
EX 46
PV 116,164,48
VR 180,13,57344
VR 182,13,61440
PV 120,168,48
EX 47
PV 124,172,48
VR 184,14,57344
CV 55,46,47
LM 208,48
VR 186,14,61440
VR 188,15,57344
QK 40,80,48,68
EX 32
QK 40,84,52,40
VR 190,15,61440
VR 192,16,57344
QK 40,88,56,40
EX 33
QK 40,92,60,40
VR 194,16,61440
CV 48,32,33
QK 44,96,48,68
EX 34
QK 44,100,52,44
VR 196,17,57344
VR 198,17,61440
QK 44,104,56,44
EX 35
QK 44,108,60,44
VR 200,18,57344
CV 49,34,35
PV 128,144,52
EX 36
PV 132,148,52
VR 202,18,61440
VR 204,19,57344
PV 136,152,52
EX 37
PV 140,156,52
VR 206,19,61440
CV 50,36,37
PV 144,160,52
EX 38
PV 148,164,52
PV 152,168,52
EX 39
PV 156,172,52
CV 51,38,39
LM 212,52
s_waitcnt vmcnt(12) lgkmcnt(15)
s_barrier
v_add_f32 v32, v56, v76
v_add_f32 v33, v56, v77
v_add_f32 v34, v56, v78
v_add_f32 v35, v56, v79
v_add_f32 v36, v56, v80
v_add_f32 v37, v56, v81
v_add_f32 v38, v56, v82
v_add_f32 v39, v56, v83
s_nop 1
QK 32,112,0,32
EX 40
QK 32,116,4,32
KR 80,8,0
KR 84,9,0
QK 32,120,8,32
EX 41
QK 32,124,12,32
KR 88,10,0
CV 52,40,41
QK 36,128,0,36
EX 42
QK 36,132,4,36
KR 92,11,0
s_add_u32 m0, s27, 32768
QK 36,136,8,36
EX 43
QK 36,140,12,36
KR 96,8,4096
CV 53,42,43
PV 160,144,48
EX 44
PV 164,148,48
KR 100,9,4096
KR 104,10,4096
PV 168,152,48
EX 45
PV 172,156,48
KR 108,11,4096
CV 54,44,45
PV 176,160,48
EX 46
PV 180,164,48
buffer_load_dwordx4 v24, s[16:19], s29 offen offset:0 nt lds
PV 184,168,48
EX 47
PV 188,172,48
CV 55,46,47
LM 216,48
buffer_load_dwordx4 v25, s[16:19], s29 offen offset:1024 nt lds
v_add_f32 v40, v60, v76
v_add_f32 v41, v60, v77
v_add_f32 v42, v60, v78
v_add_f32 v43, v60, v79
v_add_f32 v44, v60, v80
v_add_f32 v45, v60, v81
v_add_f32 v46, v60, v82
v_add_f32 v47, v60, v83
s_nop 1
QK 40,112,16,40
EX 32
QK 40,116,20,40
buffer_load_dwordx4 v26, s[16:19], s29 offen offset:2048 nt lds
QK 40,120,24,40
EX 33
QK 40,124,28,40
CV 48,32,33
QK 44,128,16,44
EX 34
QK 44,132,20,44
buffer_load_dwordx4 v27, s[16:19], s29 offen offset:3072 nt lds
QK 44,136,24,44
EX 35
QK 44,140,28,44
s_add_u32 s29, s29, 0x40000
CV 49,34,35
PV 192,144,52
EX 36
PV 196,148,52
PV 200,152,52
EX 37
PV 204,156,52
CV 50,36,37
PV 208,160,52
EX 38
PV 212,164,52
PV 216,168,52
EX 39
PV 220,172,52
CV 51,38,39
LM 220,52
v_add_f32 v32, v64, v76
v_add_f32 v33, v64, v77
v_add_f32 v34, v64, v78
v_add_f32 v35, v64, v79
v_add_f32 v36, v64, v80
v_add_f32 v37, v64, v81
v_add_f32 v38, v64, v82
v_add_f32 v39, v64, v83
s_nop 1
QK 32,112,32,32
EX 40
QK 32,116,36,32
QK 32,120,40,32
EX 41
QK 32,124,44,32
CV 52,40,41
QK 36,128,32,36
EX 42
QK 36,132,36,36
QK 36,136,40,36
EX 43
QK 36,140,44,36
CV 53,42,43
s_waitcnt lgkmcnt(8)
PV 96,176,48
EX 44
PV 100,180,48
PV 104,184,48
EX 45
PV 108,188,48
CV 54,44,45
PV 112,192,48
EX 46
PV 116,196,48
PV 120,200,48
EX 47
PV 124,204,48
CV 55,46,47
LM 208,48
v_add_f32 v40, v68, v76
v_add_f32 v41, v68, v77
v_add_f32 v42, v68, v78
v_add_f32 v43, v68, v79
v_add_f32 v44, v68, v80
v_add_f32 v45, v68, v81
v_add_f32 v46, v68, v82
v_add_f32 v47, v68, v83
s_nop 1
QK 40,112,48,40
EX 32
QK 40,116,52,40
QK 40,120,56,40
EX 33
QK 40,124,60,40
CV 48,32,33
QK 44,128,48,44
EX 34
QK 44,132,52,44
QK 44,136,56,44
EX 35
QK 44,140,60,44
CV 49,34,35
PV 128,176,52
EX 36
PV 132,180,52
PV 136,184,52
EX 37
PV 140,188,52
CV 50,36,37
PV 144,192,52
EX 38
PV 148,196,52
PV 152,200,52
EX 39
PV 156,204,52
CV 51,38,39
LM 212,52
s_waitcnt lgkmcnt(0)
PV 160,176,48
EX 40
PV 164,180,48
EX 41
PV 168,184,48
EX 42
PV 172,188,48
EX 43
PV 176,192,48
EX 44
PV 180,196,48
EX 45
PV 184,200,48
EX 46
PV 188,204,48
EX 47
LM 216,48
CV 52,40,41
CV 53,42,43
CV 54,44,45
CV 55,46,47
s_nop 1
LM 220,52
PV 192,176,52
PV 196,180,52
PV 200,184,52
PV 204,188,52
PV 208,192,52
PV 212,196,52
PV 216,200,52
PV 220,204,52
s_mov_b32 s72, 0
EPI_V400:
s_add_u32 s88, s40, 135424
v_mov_b32 v42, s88
v_add_u32 v44, s40, v4
v_add_u32 v45, s40, v3
v_add_u32 v46, s40, v1
v_accvgpr_read_b32 v50, a208
v_accvgpr_read_b32 v51, a212
v_accvgpr_read_b32 v52, a216
v_accvgpr_read_b32 v53, a220
v_cmp_nge_f32 s[78:79], s76, v50
v_cmp_nge_f32 s[80:81], s76, v51
v_cmp_nge_f32 s[82:83], s76, v52
v_cmp_nge_f32 s[84:85], s76, v53
v_rcp_f32 v32, v50
v_rcp_f32 v34, v51
v_rcp_f32 v36, v52
v_rcp_f32 v38, v53
s_or_b64 s[78:79], s[78:79], s[80:81]
s_or_b64 s[78:79], s[78:79], s[82:83]
s_or_b64 s[78:79], s[78:79], s[84:85]
s_cmp_lg_u64 s[78:79], 0
s_cselect_b32 s90, 1, 0
v_mov_b32 v43, s90
ds_write_b32 v42, v43
s_nop 3
v_pk_mul_f32 v[96:97], v[96:97], v[32:33] op_sel_hi:[1,0]
v_pk_mul_f32 v[98:99], v[98:99], v[32:33] op_sel_hi:[1,0]
CV 96,96,97
CV 97,98,99
v_pk_mul_f32 v[100:101], v[100:101], v[32:33] op_sel_hi:[1,0]
v_pk_mul_f32 v[102:103], v[102:103], v[32:33] op_sel_hi:[1,0]
CV 100,100,101
CV 101,102,103
v_pk_mul_f32 v[104:105], v[104:105], v[32:33] op_sel_hi:[1,0]
v_pk_mul_f32 v[106:107], v[106:107], v[32:33] op_sel_hi:[1,0]
CV 104,104,105
CV 105,106,107
v_pk_mul_f32 v[108:109], v[108:109], v[32:33] op_sel_hi:[1,0]
v_pk_mul_f32 v[110:111], v[110:111], v[32:33] op_sel_hi:[1,0]
CV 108,108,109
CV 109,110,111
v_pk_mul_f32 v[112:113], v[112:113], v[32:33] op_sel_hi:[1,0]
v_pk_mul_f32 v[114:115], v[114:115], v[32:33] op_sel_hi:[1,0]
CV 112,112,113
CV 113,114,115
v_pk_mul_f32 v[116:117], v[116:117], v[32:33] op_sel_hi:[1,0]
v_pk_mul_f32 v[118:119], v[118:119], v[32:33] op_sel_hi:[1,0]
CV 116,116,117
CV 117,118,119
v_pk_mul_f32 v[120:121], v[120:121], v[32:33] op_sel_hi:[1,0]
v_pk_mul_f32 v[122:123], v[122:123], v[32:33] op_sel_hi:[1,0]
CV 120,120,121
CV 121,122,123
v_pk_mul_f32 v[124:125], v[124:125], v[32:33] op_sel_hi:[1,0]
v_pk_mul_f32 v[126:127], v[126:127], v[32:33] op_sel_hi:[1,0]
CV 124,124,125
CV 125,126,127
s_cmp_lg_u32 s57, 0
s_cbranch_scc1 EPI_V400_q
ds_write_b64 v44, v[96:97] offset:0
ds_write_b64 v44, v[100:101] offset:32
ds_write_b64 v44, v[104:105] offset:64
ds_write_b64 v44, v[108:109] offset:96
ds_write_b64 v44, v[112:113] offset:128
ds_write_b64 v44, v[116:117] offset:160
ds_write_b64 v44, v[120:121] offset:192
ds_write_b64 v44, v[124:125] offset:224
v_pk_mul_f32 v[128:129], v[128:129], v[34:35] op_sel_hi:[1,0]
v_pk_mul_f32 v[130:131], v[130:131], v[34:35] op_sel_hi:[1,0]
CV 128,128,129
CV 129,130,131
v_pk_mul_f32 v[132:133], v[132:133], v[34:35] op_sel_hi:[1,0]
v_pk_mul_f32 v[134:135], v[134:135], v[34:35] op_sel_hi:[1,0]
CV 132,132,133
CV 133,134,135
v_pk_mul_f32 v[136:137], v[136:137], v[34:35] op_sel_hi:[1,0]
v_pk_mul_f32 v[138:139], v[138:139], v[34:35] op_sel_hi:[1,0]
CV 136,136,137
CV 137,138,139
v_pk_mul_f32 v[140:141], v[140:141], v[34:35] op_sel_hi:[1,0]
v_pk_mul_f32 v[142:143], v[142:143], v[34:35] op_sel_hi:[1,0]
CV 140,140,141
CV 141,142,143
v_pk_mul_f32 v[144:145], v[144:145], v[34:35] op_sel_hi:[1,0]
v_pk_mul_f32 v[146:147], v[146:147], v[34:35] op_sel_hi:[1,0]
CV 144,144,145
CV 145,146,147
v_pk_mul_f32 v[148:149], v[148:149], v[34:35] op_sel_hi:[1,0]
v_pk_mul_f32 v[150:151], v[150:151], v[34:35] op_sel_hi:[1,0]
CV 148,148,149
CV 149,150,151
v_pk_mul_f32 v[152:153], v[152:153], v[34:35] op_sel_hi:[1,0]
v_pk_mul_f32 v[154:155], v[154:155], v[34:35] op_sel_hi:[1,0]
CV 152,152,153
CV 153,154,155
v_pk_mul_f32 v[156:157], v[156:157], v[34:35] op_sel_hi:[1,0]
v_pk_mul_f32 v[158:159], v[158:159], v[34:35] op_sel_hi:[1,0]
CV 156,156,157
CV 157,158,159
v_pk_mul_f32 v[160:161], v[160:161], v[36:37] op_sel_hi:[1,0]
v_pk_mul_f32 v[162:163], v[162:163], v[36:37] op_sel_hi:[1,0]
CV 160,160,161
CV 161,162,163
v_pk_mul_f32 v[164:165], v[164:165], v[36:37] op_sel_hi:[1,0]
v_pk_mul_f32 v[166:167], v[166:167], v[36:37] op_sel_hi:[1,0]
CV 164,164,165
CV 165,166,167
v_pk_mul_f32 v[168:169], v[168:169], v[36:37] op_sel_hi:[1,0]
v_pk_mul_f32 v[170:171], v[170:171], v[36:37] op_sel_hi:[1,0]
CV 168,168,169
CV 169,170,171
v_pk_mul_f32 v[172:173], v[172:173], v[36:37] op_sel_hi:[1,0]
v_pk_mul_f32 v[174:175], v[174:175], v[36:37] op_sel_hi:[1,0]
CV 172,172,173
CV 173,174,175
v_pk_mul_f32 v[176:177], v[176:177], v[36:37] op_sel_hi:[1,0]
v_pk_mul_f32 v[178:179], v[178:179], v[36:37] op_sel_hi:[1,0]
CV 176,176,177
CV 177,178,179
v_pk_mul_f32 v[180:181], v[180:181], v[36:37] op_sel_hi:[1,0]
v_pk_mul_f32 v[182:183], v[182:183], v[36:37] op_sel_hi:[1,0]
CV 180,180,181
CV 181,182,183
v_pk_mul_f32 v[184:185], v[184:185], v[36:37] op_sel_hi:[1,0]
v_pk_mul_f32 v[186:187], v[186:187], v[36:37] op_sel_hi:[1,0]
CV 184,184,185
CV 185,186,187
v_pk_mul_f32 v[188:189], v[188:189], v[36:37] op_sel_hi:[1,0]
v_pk_mul_f32 v[190:191], v[190:191], v[36:37] op_sel_hi:[1,0]
CV 188,188,189
CV 189,190,191
s_waitcnt lgkmcnt(0)
ds_read_b128 v[112:115], v45 offset:0
ds_read_b128 v[116:119], v45 offset:1088
ds_read_b128 v[120:123], v45 offset:2176
ds_read_b128 v[124:127], v45 offset:3264
s_waitcnt lgkmcnt(0)
ds_write_b64 v44, v[128:129] offset:0
ds_write_b64 v44, v[132:133] offset:32
ds_write_b64 v44, v[136:137] offset:64
ds_write_b64 v44, v[140:141] offset:96
ds_write_b64 v44, v[144:145] offset:128
ds_write_b64 v44, v[148:149] offset:160
ds_write_b64 v44, v[152:153] offset:192
ds_write_b64 v44, v[156:157] offset:224
s_add_u32 s87, s49, 0
buffer_store_dwordx4 v[112:115], v29, s[20:23], s87 offen sc1
s_add_u32 s87, s49, 16384
buffer_store_dwordx4 v[116:119], v29, s[20:23], s87 offen sc1
s_add_u32 s87, s49, 32768
buffer_store_dwordx4 v[120:123], v29, s[20:23], s87 offen sc1
s_add_u32 s87, s49, 49152
buffer_store_dwordx4 v[124:127], v29, s[20:23], s87 offen sc1
v_pk_mul_f32 v[192:193], v[192:193], v[38:39] op_sel_hi:[1,0]
v_pk_mul_f32 v[194:195], v[194:195], v[38:39] op_sel_hi:[1,0]
CV 192,192,193
CV 193,194,195
v_pk_mul_f32 v[196:197], v[196:197], v[38:39] op_sel_hi:[1,0]
v_pk_mul_f32 v[198:199], v[198:199], v[38:39] op_sel_hi:[1,0]
CV 196,196,197
CV 197,198,199
v_pk_mul_f32 v[200:201], v[200:201], v[38:39] op_sel_hi:[1,0]
v_pk_mul_f32 v[202:203], v[202:203], v[38:39] op_sel_hi:[1,0]
CV 200,200,201
CV 201,202,203
v_pk_mul_f32 v[204:205], v[204:205], v[38:39] op_sel_hi:[1,0]
v_pk_mul_f32 v[206:207], v[206:207], v[38:39] op_sel_hi:[1,0]
CV 204,204,205
CV 205,206,207
v_pk_mul_f32 v[208:209], v[208:209], v[38:39] op_sel_hi:[1,0]
v_pk_mul_f32 v[210:211], v[210:211], v[38:39] op_sel_hi:[1,0]
CV 208,208,209
CV 209,210,211
v_pk_mul_f32 v[212:213], v[212:213], v[38:39] op_sel_hi:[1,0]
v_pk_mul_f32 v[214:215], v[214:215], v[38:39] op_sel_hi:[1,0]
CV 212,212,213
CV 213,214,215
v_pk_mul_f32 v[216:217], v[216:217], v[38:39] op_sel_hi:[1,0]
v_pk_mul_f32 v[218:219], v[218:219], v[38:39] op_sel_hi:[1,0]
CV 216,216,217
CV 217,218,219
v_pk_mul_f32 v[220:221], v[220:221], v[38:39] op_sel_hi:[1,0]
v_pk_mul_f32 v[222:223], v[222:223], v[38:39] op_sel_hi:[1,0]
CV 220,220,221
CV 221,222,223
s_waitcnt lgkmcnt(0)
ds_read_b128 v[144:147], v45 offset:0
ds_read_b128 v[148:151], v45 offset:1088
ds_read_b128 v[152:155], v45 offset:2176
ds_read_b128 v[156:159], v45 offset:3264
s_waitcnt lgkmcnt(0)
ds_write_b64 v44, v[160:161] offset:0
ds_write_b64 v44, v[164:165] offset:32
ds_write_b64 v44, v[168:169] offset:64
ds_write_b64 v44, v[172:173] offset:96
ds_write_b64 v44, v[176:177] offset:128
ds_write_b64 v44, v[180:181] offset:160
ds_write_b64 v44, v[184:185] offset:192
ds_write_b64 v44, v[188:189] offset:224
s_add_u32 s87, s50, 0
buffer_store_dwordx4 v[144:147], v29, s[20:23], s87 offen sc1
s_add_u32 s87, s50, 16384
buffer_store_dwordx4 v[148:151], v29, s[20:23], s87 offen sc1
s_add_u32 s87, s50, 32768
buffer_store_dwordx4 v[152:155], v29, s[20:23], s87 offen sc1
s_add_u32 s87, s50, 49152
buffer_store_dwordx4 v[156:159], v29, s[20:23], s87 offen sc1
s_waitcnt lgkmcnt(0)
ds_read_b128 v[176:179], v45 offset:0
ds_read_b128 v[180:183], v45 offset:1088
ds_read_b128 v[184:187], v45 offset:2176
ds_read_b128 v[188:191], v45 offset:3264
s_waitcnt lgkmcnt(0)
ds_write_b64 v44, v[192:193] offset:0
ds_write_b64 v44, v[196:197] offset:32
ds_write_b64 v44, v[200:201] offset:64
ds_write_b64 v44, v[204:205] offset:96
ds_write_b64 v44, v[208:209] offset:128
ds_write_b64 v44, v[212:213] offset:160
ds_write_b64 v44, v[216:217] offset:192
ds_write_b64 v44, v[220:221] offset:224
s_add_u32 s87, s51, 0
buffer_store_dwordx4 v[176:179], v29, s[20:23], s87 offen sc1
s_add_u32 s87, s51, 16384
buffer_store_dwordx4 v[180:183], v29, s[20:23], s87 offen sc1
s_add_u32 s87, s51, 32768
buffer_store_dwordx4 v[184:187], v29, s[20:23], s87 offen sc1
s_add_u32 s87, s51, 49152
buffer_store_dwordx4 v[188:191], v29, s[20:23], s87 offen sc1
s_waitcnt lgkmcnt(0)
ds_read_b128 v[208:211], v45 offset:0
ds_read_b128 v[212:215], v45 offset:1088
ds_read_b128 v[216:219], v45 offset:2176
ds_read_b128 v[220:223], v45 offset:3264
s_waitcnt lgkmcnt(0)
s_add_u32 s87, s52, 0
buffer_store_dwordx4 v[208:211], v29, s[20:23], s87 offen sc1
s_add_u32 s87, s52, 16384
buffer_store_dwordx4 v[212:215], v29, s[20:23], s87 offen sc1
s_add_u32 s87, s52, 32768
buffer_store_dwordx4 v[216:219], v29, s[20:23], s87 offen sc1
s_add_u32 s87, s52, 49152
buffer_store_dwordx4 v[220:223], v29, s[20:23], s87 offen sc1
s_barrier
ds_read_b32 v43, v28
s_waitcnt lgkmcnt(0)
v_cmp_ne_u32 s[86:87], 0, v43
s_nop 3
s_cmp_lg_u64 s[86:87], 0
s_cselect_b32 s86, 1, 0
s_andn2_b32 s86, s86, s73
s_cmp_lg_u32 s86, 0
s_cbranch_scc1 MAXPASS
s_endpgm
EPI_V400_q:
s_waitcnt lgkmcnt(0)
s_barrier
ds_read_b32 v43, v28
ds_write_b64 v44, v[96:97] offset:0
ds_write_b64 v44, v[100:101] offset:32
ds_write_b64 v44, v[104:105] offset:64
ds_write_b64 v44, v[108:109] offset:96
ds_write_b64 v44, v[112:113] offset:128
ds_write_b64 v44, v[116:117] offset:160
ds_write_b64 v44, v[120:121] offset:192
ds_write_b64 v44, v[124:125] offset:224
v_pk_mul_f32 v[128:129], v[128:129], v[34:35] op_sel_hi:[1,0]
v_pk_mul_f32 v[130:131], v[130:131], v[34:35] op_sel_hi:[1,0]
CV 128,128,129
CV 129,130,131
v_pk_mul_f32 v[132:133], v[132:133], v[34:35] op_sel_hi:[1,0]
v_pk_mul_f32 v[134:135], v[134:135], v[34:35] op_sel_hi:[1,0]
CV 132,132,133
CV 133,134,135
v_pk_mul_f32 v[136:137], v[136:137], v[34:35] op_sel_hi:[1,0]
v_pk_mul_f32 v[138:139], v[138:139], v[34:35] op_sel_hi:[1,0]
CV 136,136,137
CV 137,138,139
v_pk_mul_f32 v[140:141], v[140:141], v[34:35] op_sel_hi:[1,0]
v_pk_mul_f32 v[142:143], v[142:143], v[34:35] op_sel_hi:[1,0]
CV 140,140,141
CV 141,142,143
v_pk_mul_f32 v[144:145], v[144:145], v[34:35] op_sel_hi:[1,0]
v_pk_mul_f32 v[146:147], v[146:147], v[34:35] op_sel_hi:[1,0]
CV 144,144,145
CV 145,146,147
v_pk_mul_f32 v[148:149], v[148:149], v[34:35] op_sel_hi:[1,0]
v_pk_mul_f32 v[150:151], v[150:151], v[34:35] op_sel_hi:[1,0]
CV 148,148,149
CV 149,150,151
v_pk_mul_f32 v[152:153], v[152:153], v[34:35] op_sel_hi:[1,0]
v_pk_mul_f32 v[154:155], v[154:155], v[34:35] op_sel_hi:[1,0]
CV 152,152,153
CV 153,154,155
v_pk_mul_f32 v[156:157], v[156:157], v[34:35] op_sel_hi:[1,0]
v_pk_mul_f32 v[158:159], v[158:159], v[34:35] op_sel_hi:[1,0]
CV 156,156,157
CV 157,158,159
s_waitcnt lgkmcnt(0)
v_cmp_ne_u32 s[86:87], 0, v43
s_nop 3
s_cmp_lg_u64 s[86:87], 0
s_cselect_b32 s86, 1, 0
s_andn2_b32 s86, s86, s73
s_cmp_lg_u32 s86, 0
s_cbranch_scc1 MAXPASS
v_pk_mul_f32 v[160:161], v[160:161], v[36:37] op_sel_hi:[1,0]
v_pk_mul_f32 v[162:163], v[162:163], v[36:37] op_sel_hi:[1,0]
CV 160,160,161
CV 161,162,163
v_pk_mul_f32 v[164:165], v[164:165], v[36:37] op_sel_hi:[1,0]
v_pk_mul_f32 v[166:167], v[166:167], v[36:37] op_sel_hi:[1,0]
CV 164,164,165
CV 165,166,167
v_pk_mul_f32 v[168:169], v[168:169], v[36:37] op_sel_hi:[1,0]
v_pk_mul_f32 v[170:171], v[170:171], v[36:37] op_sel_hi:[1,0]
CV 168,168,169
CV 169,170,171
v_pk_mul_f32 v[172:173], v[172:173], v[36:37] op_sel_hi:[1,0]
v_pk_mul_f32 v[174:175], v[174:175], v[36:37] op_sel_hi:[1,0]
CV 172,172,173
CV 173,174,175
v_pk_mul_f32 v[176:177], v[176:177], v[36:37] op_sel_hi:[1,0]
v_pk_mul_f32 v[178:179], v[178:179], v[36:37] op_sel_hi:[1,0]
CV 176,176,177
CV 177,178,179
v_pk_mul_f32 v[180:181], v[180:181], v[36:37] op_sel_hi:[1,0]
v_pk_mul_f32 v[182:183], v[182:183], v[36:37] op_sel_hi:[1,0]
CV 180,180,181
CV 181,182,183
v_pk_mul_f32 v[184:185], v[184:185], v[36:37] op_sel_hi:[1,0]
v_pk_mul_f32 v[186:187], v[186:187], v[36:37] op_sel_hi:[1,0]
CV 184,184,185
CV 185,186,187
v_pk_mul_f32 v[188:189], v[188:189], v[36:37] op_sel_hi:[1,0]
v_pk_mul_f32 v[190:191], v[190:191], v[36:37] op_sel_hi:[1,0]
CV 188,188,189
CV 189,190,191
s_waitcnt lgkmcnt(0)
ds_read_b128 v[112:115], v45 offset:0
ds_read_b128 v[116:119], v45 offset:1088
ds_read_b128 v[120:123], v45 offset:2176
ds_read_b128 v[124:127], v45 offset:3264
v_accvgpr_read_b32 v225, a224
v_accvgpr_read_b32 v227, a225
v_accvgpr_read_b32 v229, a226
v_accvgpr_read_b32 v231, a227
v_lshlrev_b32 v224, 16, v225
v_and_b32 v225, 0xffff0000, v225
v_lshlrev_b32 v226, 16, v227
v_and_b32 v227, 0xffff0000, v227
v_lshlrev_b32 v228, 16, v229
v_and_b32 v229, 0xffff0000, v229
v_lshlrev_b32 v230, 16, v231
s_waitcnt lgkmcnt(0)
ds_write_b64 v44, v[128:129] offset:0
ds_write_b64 v44, v[132:133] offset:32
ds_write_b64 v44, v[136:137] offset:64
ds_write_b64 v44, v[140:141] offset:96
ds_write_b64 v44, v[144:145] offset:128
ds_write_b64 v44, v[148:149] offset:160
ds_write_b64 v44, v[152:153] offset:192
ds_write_b64 v44, v[156:157] offset:224
s_add_u32 s87, s49, 0
buffer_store_dwordx4 v[112:115], v29, s[20:23], s87 offen sc1
v_and_b32 v231, 0xffff0000, v231
v_pk_mul_f32 v[224:225], v[224:225], s[74:75]
v_pk_mul_f32 v[226:227], v[226:227], s[74:75]
v_pk_mul_f32 v[228:229], v[228:229], s[74:75]
v_pk_mul_f32 v[230:231], v[230:231], s[74:75]
CV 224,224,225
CV 226,226,227
CV 228,228,229
CV 230,230,231
v_accvgpr_write_b32 a0, v224
v_accvgpr_write_b32 a1, v226
s_add_u32 s87, s49, 16384
buffer_store_dwordx4 v[116:119], v29, s[20:23], s87 offen sc1
v_accvgpr_write_b32 a2, v228
v_accvgpr_write_b32 a3, v230
v_accvgpr_read_b32 v225, a228
v_accvgpr_read_b32 v227, a229
v_accvgpr_read_b32 v229, a230
v_accvgpr_read_b32 v231, a231
v_lshlrev_b32 v224, 16, v225
v_and_b32 v225, 0xffff0000, v225
v_lshlrev_b32 v226, 16, v227
v_and_b32 v227, 0xffff0000, v227
v_lshlrev_b32 v228, 16, v229
s_add_u32 s87, s49, 32768
buffer_store_dwordx4 v[120:123], v29, s[20:23], s87 offen sc1
v_and_b32 v229, 0xffff0000, v229
v_lshlrev_b32 v230, 16, v231
v_and_b32 v231, 0xffff0000, v231
v_pk_mul_f32 v[224:225], v[224:225], s[74:75]
v_pk_mul_f32 v[226:227], v[226:227], s[74:75]
v_pk_mul_f32 v[228:229], v[228:229], s[74:75]
v_pk_mul_f32 v[230:231], v[230:231], s[74:75]
CV 224,224,225
CV 226,226,227
CV 228,228,229
CV 230,230,231
s_add_u32 s87, s49, 49152
buffer_store_dwordx4 v[124:127], v29, s[20:23], s87 offen sc1
v_accvgpr_write_b32 a4, v224
v_accvgpr_write_b32 a5, v226
v_accvgpr_write_b32 a6, v228
v_accvgpr_write_b32 a7, v230
v_accvgpr_read_b32 v225, a232
v_accvgpr_read_b32 v227, a233
v_accvgpr_read_b32 v229, a234
v_accvgpr_read_b32 v231, a235
v_lshlrev_b32 v224, 16, v225
v_and_b32 v225, 0xffff0000, v225
v_lshlrev_b32 v226, 16, v227
v_pk_mul_f32 v[192:193], v[192:193], v[38:39] op_sel_hi:[1,0]
v_pk_mul_f32 v[194:195], v[194:195], v[38:39] op_sel_hi:[1,0]
CV 192,192,193
CV 193,194,195
v_pk_mul_f32 v[196:197], v[196:197], v[38:39] op_sel_hi:[1,0]
v_pk_mul_f32 v[198:199], v[198:199], v[38:39] op_sel_hi:[1,0]
CV 196,196,197
CV 197,198,199
v_pk_mul_f32 v[200:201], v[200:201], v[38:39] op_sel_hi:[1,0]
v_pk_mul_f32 v[202:203], v[202:203], v[38:39] op_sel_hi:[1,0]
CV 200,200,201
CV 201,202,203
v_pk_mul_f32 v[204:205], v[204:205], v[38:39] op_sel_hi:[1,0]
v_pk_mul_f32 v[206:207], v[206:207], v[38:39] op_sel_hi:[1,0]
CV 204,204,205
CV 205,206,207
v_pk_mul_f32 v[208:209], v[208:209], v[38:39] op_sel_hi:[1,0]
v_pk_mul_f32 v[210:211], v[210:211], v[38:39] op_sel_hi:[1,0]
CV 208,208,209
CV 209,210,211
v_pk_mul_f32 v[212:213], v[212:213], v[38:39] op_sel_hi:[1,0]
v_pk_mul_f32 v[214:215], v[214:215], v[38:39] op_sel_hi:[1,0]
CV 212,212,213
CV 213,214,215
v_pk_mul_f32 v[216:217], v[216:217], v[38:39] op_sel_hi:[1,0]
v_pk_mul_f32 v[218:219], v[218:219], v[38:39] op_sel_hi:[1,0]
CV 216,216,217
CV 217,218,219
v_pk_mul_f32 v[220:221], v[220:221], v[38:39] op_sel_hi:[1,0]
v_pk_mul_f32 v[222:223], v[222:223], v[38:39] op_sel_hi:[1,0]
CV 220,220,221
CV 221,222,223
s_waitcnt lgkmcnt(0)
ds_read_b128 v[144:147], v45 offset:0
ds_read_b128 v[148:151], v45 offset:1088
ds_read_b128 v[152:155], v45 offset:2176
ds_read_b128 v[156:159], v45 offset:3264
v_and_b32 v227, 0xffff0000, v227
v_lshlrev_b32 v228, 16, v229
v_and_b32 v229, 0xffff0000, v229
v_lshlrev_b32 v230, 16, v231
v_and_b32 v231, 0xffff0000, v231
v_pk_mul_f32 v[224:225], v[224:225], s[74:75]
v_pk_mul_f32 v[226:227], v[226:227], s[74:75]
v_pk_mul_f32 v[228:229], v[228:229], s[74:75]
v_pk_mul_f32 v[230:231], v[230:231], s[74:75]
CV 224,224,225
CV 226,226,227
s_waitcnt lgkmcnt(0)
ds_write_b64 v44, v[160:161] offset:0
ds_write_b64 v44, v[164:165] offset:32
ds_write_b64 v44, v[168:169] offset:64
ds_write_b64 v44, v[172:173] offset:96
ds_write_b64 v44, v[176:177] offset:128
ds_write_b64 v44, v[180:181] offset:160
ds_write_b64 v44, v[184:185] offset:192
ds_write_b64 v44, v[188:189] offset:224
s_add_u32 s87, s50, 0
buffer_store_dwordx4 v[144:147], v29, s[20:23], s87 offen sc1
CV 228,228,229
CV 230,230,231
v_accvgpr_write_b32 a8, v224
v_accvgpr_write_b32 a9, v226
v_accvgpr_write_b32 a10, v228
v_accvgpr_write_b32 a11, v230
v_accvgpr_read_b32 v225, a236
v_accvgpr_read_b32 v227, a237
v_accvgpr_read_b32 v229, a238
v_accvgpr_read_b32 v231, a239
v_lshlrev_b32 v224, 16, v225
s_add_u32 s87, s50, 16384
buffer_store_dwordx4 v[148:151], v29, s[20:23], s87 offen sc1
v_and_b32 v225, 0xffff0000, v225
v_lshlrev_b32 v226, 16, v227
v_and_b32 v227, 0xffff0000, v227
v_lshlrev_b32 v228, 16, v229
v_and_b32 v229, 0xffff0000, v229
v_lshlrev_b32 v230, 16, v231
v_and_b32 v231, 0xffff0000, v231
v_pk_mul_f32 v[224:225], v[224:225], s[74:75]
v_pk_mul_f32 v[226:227], v[226:227], s[74:75]
v_pk_mul_f32 v[228:229], v[228:229], s[74:75]
v_pk_mul_f32 v[230:231], v[230:231], s[74:75]
s_add_u32 s87, s50, 32768
buffer_store_dwordx4 v[152:155], v29, s[20:23], s87 offen sc1
CV 224,224,225
CV 226,226,227
CV 228,228,229
CV 230,230,231
v_accvgpr_write_b32 a12, v224
v_accvgpr_write_b32 a13, v226
v_accvgpr_write_b32 a14, v228
v_accvgpr_write_b32 a15, v230
v_accvgpr_read_b32 v225, a240
v_accvgpr_read_b32 v227, a241
v_accvgpr_read_b32 v229, a242
s_add_u32 s87, s50, 49152
buffer_store_dwordx4 v[156:159], v29, s[20:23], s87 offen sc1
v_accvgpr_read_b32 v231, a243
v_lshlrev_b32 v224, 16, v225
v_and_b32 v225, 0xffff0000, v225
v_lshlrev_b32 v226, 16, v227
v_and_b32 v227, 0xffff0000, v227
v_lshlrev_b32 v228, 16, v229
v_and_b32 v229, 0xffff0000, v229
v_lshlrev_b32 v230, 16, v231
v_and_b32 v231, 0xffff0000, v231
v_pk_mul_f32 v[224:225], v[224:225], s[74:75]
v_pk_mul_f32 v[226:227], v[226:227], s[74:75]
v_pk_mul_f32 v[228:229], v[228:229], s[74:75]
v_pk_mul_f32 v[230:231], v[230:231], s[74:75]
CV 224,224,225
CV 226,226,227
CV 228,228,229
CV 230,230,231
v_accvgpr_write_b32 a16, v224
v_accvgpr_write_b32 a17, v226
v_accvgpr_write_b32 a18, v228
v_accvgpr_write_b32 a19, v230
v_accvgpr_read_b32 v225, a244
s_waitcnt lgkmcnt(0)
ds_read_b128 v[176:179], v45 offset:0
ds_read_b128 v[180:183], v45 offset:1088
ds_read_b128 v[184:187], v45 offset:2176
ds_read_b128 v[188:191], v45 offset:3264
v_accvgpr_read_b32 v227, a245
v_accvgpr_read_b32 v229, a246
v_accvgpr_read_b32 v231, a247
v_lshlrev_b32 v224, 16, v225
v_and_b32 v225, 0xffff0000, v225
v_lshlrev_b32 v226, 16, v227
v_and_b32 v227, 0xffff0000, v227
v_lshlrev_b32 v228, 16, v229
v_and_b32 v229, 0xffff0000, v229
v_lshlrev_b32 v230, 16, v231
v_and_b32 v231, 0xffff0000, v231
s_waitcnt lgkmcnt(0)
ds_write_b64 v44, v[192:193] offset:0
ds_write_b64 v44, v[196:197] offset:32
ds_write_b64 v44, v[200:201] offset:64
ds_write_b64 v44, v[204:205] offset:96
ds_write_b64 v44, v[208:209] offset:128
ds_write_b64 v44, v[212:213] offset:160
ds_write_b64 v44, v[216:217] offset:192
ds_write_b64 v44, v[220:221] offset:224
s_add_u32 s87, s51, 0
buffer_store_dwordx4 v[176:179], v29, s[20:23], s87 offen sc1
v_pk_mul_f32 v[224:225], v[224:225], s[74:75]
v_pk_mul_f32 v[226:227], v[226:227], s[74:75]
v_pk_mul_f32 v[228:229], v[228:229], s[74:75]
v_pk_mul_f32 v[230:231], v[230:231], s[74:75]
CV 224,224,225
CV 226,226,227
CV 228,228,229
CV 230,230,231
v_accvgpr_write_b32 a20, v224
v_accvgpr_write_b32 a21, v226
v_accvgpr_write_b32 a22, v228
s_add_u32 s87, s51, 16384
buffer_store_dwordx4 v[180:183], v29, s[20:23], s87 offen sc1
v_accvgpr_write_b32 a23, v230
v_accvgpr_read_b32 v225, a248
v_accvgpr_read_b32 v227, a249
v_accvgpr_read_b32 v229, a250
v_accvgpr_read_b32 v231, a251
v_lshlrev_b32 v224, 16, v225
v_and_b32 v225, 0xffff0000, v225
v_lshlrev_b32 v226, 16, v227
v_and_b32 v227, 0xffff0000, v227
v_lshlrev_b32 v228, 16, v229
v_and_b32 v229, 0xffff0000, v229
s_add_u32 s87, s51, 32768
buffer_store_dwordx4 v[184:187], v29, s[20:23], s87 offen sc1
v_lshlrev_b32 v230, 16, v231
v_and_b32 v231, 0xffff0000, v231
v_pk_mul_f32 v[224:225], v[224:225], s[74:75]
v_pk_mul_f32 v[226:227], v[226:227], s[74:75]
v_pk_mul_f32 v[228:229], v[228:229], s[74:75]
v_pk_mul_f32 v[230:231], v[230:231], s[74:75]
CV 224,224,225
CV 226,226,227
CV 228,228,229
CV 230,230,231
v_accvgpr_write_b32 a24, v224
s_add_u32 s87, s51, 49152
buffer_store_dwordx4 v[188:191], v29, s[20:23], s87 offen sc1
v_accvgpr_write_b32 a25, v226
v_accvgpr_write_b32 a26, v228
v_accvgpr_write_b32 a27, v230
v_accvgpr_read_b32 v225, a252
v_accvgpr_read_b32 v227, a253
v_accvgpr_read_b32 v229, a254
v_accvgpr_read_b32 v231, a255
v_lshlrev_b32 v224, 16, v225
v_and_b32 v225, 0xffff0000, v225
v_lshlrev_b32 v226, 16, v227
v_and_b32 v227, 0xffff0000, v227
v_lshlrev_b32 v228, 16, v229
v_and_b32 v229, 0xffff0000, v229
v_lshlrev_b32 v230, 16, v231
v_and_b32 v231, 0xffff0000, v231
v_pk_mul_f32 v[224:225], v[224:225], s[74:75]
v_pk_mul_f32 v[226:227], v[226:227], s[74:75]
v_pk_mul_f32 v[228:229], v[228:229], s[74:75]
v_pk_mul_f32 v[230:231], v[230:231], s[74:75]
CV 224,224,225
CV 226,226,227
CV 228,228,229
s_waitcnt lgkmcnt(0)
ds_read_b128 v[208:211], v45 offset:0
ds_read_b128 v[212:215], v45 offset:1088
ds_read_b128 v[216:219], v45 offset:2176
ds_read_b128 v[220:223], v45 offset:3264
CV 230,230,231
v_accvgpr_write_b32 a28, v224
v_accvgpr_write_b32 a29, v226
v_accvgpr_write_b32 a30, v228
v_accvgpr_write_b32 a31, v230
v_accvgpr_write_b32 a176, 0
v_accvgpr_write_b32 a177, 0
v_accvgpr_write_b32 a178, 0
v_accvgpr_write_b32 a179, 0
v_accvgpr_write_b32 a180, 0
v_accvgpr_write_b32 a181, 0
s_waitcnt lgkmcnt(0)
s_add_u32 s87, s52, 0
buffer_store_dwordx4 v[208:211], v29, s[20:23], s87 offen sc1
v_accvgpr_write_b32 a182, 0
v_accvgpr_write_b32 a183, 0
v_accvgpr_write_b32 a184, 0
v_accvgpr_write_b32 a185, 0
v_accvgpr_write_b32 a186, 0
v_accvgpr_write_b32 a187, 0
v_accvgpr_write_b32 a188, 0
v_accvgpr_write_b32 a189, 0
v_accvgpr_write_b32 a190, 0
v_accvgpr_write_b32 a191, 0
v_accvgpr_write_b32 a192, 0
s_add_u32 s87, s52, 16384
buffer_store_dwordx4 v[212:215], v29, s[20:23], s87 offen sc1
v_accvgpr_write_b32 a193, 0
v_accvgpr_write_b32 a194, 0
v_accvgpr_write_b32 a195, 0
v_accvgpr_write_b32 a196, 0
v_accvgpr_write_b32 a197, 0
v_accvgpr_write_b32 a198, 0
v_accvgpr_write_b32 a199, 0
v_accvgpr_write_b32 a200, 0
v_accvgpr_write_b32 a201, 0
v_accvgpr_write_b32 a202, 0
v_accvgpr_write_b32 a203, 0
s_add_u32 s87, s52, 32768
buffer_store_dwordx4 v[216:219], v29, s[20:23], s87 offen sc1
v_accvgpr_write_b32 a204, 0
v_accvgpr_write_b32 a205, 0
v_accvgpr_write_b32 a206, 0
v_accvgpr_write_b32 a207, 0
v_accvgpr_write_b32 a208, 0
v_accvgpr_write_b32 a209, 0
v_accvgpr_write_b32 a210, 0
v_accvgpr_write_b32 a211, 0
v_accvgpr_write_b32 a212, 0
v_accvgpr_write_b32 a213, 0
v_accvgpr_write_b32 a214, 0
s_add_u32 s87, s52, 49152
buffer_store_dwordx4 v[220:223], v29, s[20:23], s87 offen sc1
v_accvgpr_write_b32 a215, 0
v_accvgpr_write_b32 a216, 0
v_accvgpr_write_b32 a217, 0
v_accvgpr_write_b32 a218, 0
v_accvgpr_write_b32 a219, 0
v_accvgpr_write_b32 a220, 0
v_accvgpr_write_b32 a221, 0
v_accvgpr_write_b32 a222, 0
v_accvgpr_write_b32 a223, 0
v_accvgpr_write_b32 a224, 0
v_accvgpr_write_b32 a225, 0
v_accvgpr_write_b32 a226, 0
v_accvgpr_write_b32 a227, 0
s_branch NEXT_PASS
VE_16:
PRO_V500:
s_cmp_lg_u32 s73, 0
s_cbranch_scc1 PRO_V500_skipmax
s_waitcnt lgkmcnt(0)
v_mfma_f32_16x16x32_bf16 v[96:99], a[80:83], a[0:3], 0
v_mov_b64 v[160:161], 0
v_mov_b64 v[162:163], 0
QK 96,84,4,96
v_mov_b64 v[164:165], 0
v_mov_b64 v[166:167], 0
QK 96,88,8,96
v_mov_b64 v[168:169], 0
v_mov_b64 v[170:171], 0
QK 96,92,12,96
v_mov_b64 v[172:173], 0
v_mov_b64 v[174:175], 0
v_mfma_f32_16x16x32_bf16 v[100:103], a[96:99], a[0:3], 0
v_mov_b64 v[176:177], 0
v_mov_b64 v[178:179], 0
QK 100,100,4,100
v_mov_b64 v[180:181], 0
v_mov_b64 v[182:183], 0
QK 100,104,8,100
v_mov_b64 v[184:185], 0
v_mov_b64 v[186:187], 0
QK 100,108,12,100
v_mov_b64 v[188:189], 0
v_mov_b64 v[190:191], 0
v_mfma_f32_16x16x32_bf16 v[104:107], a[80:83], a[16:19], 0
v_mov_b64 v[192:193], 0
v_mov_b64 v[194:195], 0
QK 104,84,20,104
v_mov_b64 v[196:197], 0
v_mov_b64 v[198:199], 0
QK 104,88,24,104
v_mov_b64 v[200:201], 0
v_mov_b64 v[202:203], 0
QK 104,92,28,104
v_mov_b64 v[204:205], 0
v_mov_b64 v[206:207], 0
v_mfma_f32_16x16x32_bf16 v[108:111], a[96:99], a[16:19], 0
v_mov_b64 v[208:209], 0
v_mov_b64 v[210:211], 0
QK 108,100,20,108
v_mov_b64 v[212:213], 0
v_mov_b64 v[214:215], 0
QK 108,104,24,108
v_mov_b64 v[216:217], 0
v_mov_b64 v[218:219], 0
QK 108,108,28,108
v_mov_b64 v[220:221], 0
v_mov_b64 v[222:223], 0
v_mfma_f32_16x16x32_bf16 v[112:115], a[80:83], a[32:35], 0
v_mov_b64 v[224:225], 0
v_mov_b64 v[226:227], 0
QK 112,84,36,112
v_mov_b64 v[228:229], 0
v_mov_b64 v[230:231], 0
QK 112,88,40,112
v_mov_b64 v[232:233], 0
v_mov_b64 v[234:235], 0
QK 112,92,44,112
v_mov_b64 v[236:237], 0
v_mov_b64 v[238:239], 0
v_mfma_f32_16x16x32_bf16 v[116:119], a[96:99], a[32:35], 0
v_mov_b64 v[240:241], 0
v_mov_b64 v[242:243], 0
QK 116,100,36,116
v_mov_b64 v[244:245], 0
v_mov_b64 v[246:247], 0
QK 116,104,40,116
v_mov_b64 v[248:249], 0
v_mov_b64 v[250:251], 0
QK 116,108,44,116
v_mov_b64 v[252:253], 0
v_mov_b64 v[254:255], 0
v_mfma_f32_16x16x32_bf16 v[120:123], a[80:83], a[48:51], 0
QK 120,84,52,120
QK 120,88,56,120
QK 120,92,60,120
v_mfma_f32_16x16x32_bf16 v[124:127], a[96:99], a[48:51], 0
QK 124,100,52,124
QK 124,104,56,124
QK 124,108,60,124
v_mfma_f32_16x16x32_bf16 v[128:131], a[80:83], a[64:67], 0
QK 128,84,68,128
QK 128,88,72,128
QK 128,92,76,128
v_mfma_f32_16x16x32_bf16 v[132:135], a[96:99], a[64:67], 0
QK 132,100,68,132
QK 132,104,72,132
QK 132,108,76,132
s_nop 8
v_max3_f32 v32, v96, v97, v98
v_max3_f32 v33, v104, v105, v106
v_max3_f32 v34, v112, v113, v114
v_max3_f32 v35, v120, v121, v122
v_max3_f32 v36, v128, v129, v130
v_max3_f32 v32, v32, v99, v100
v_max3_f32 v33, v33, v107, v108
v_max3_f32 v34, v34, v115, v116
v_max3_f32 v35, v35, v123, v124
v_max3_f32 v36, v36, v131, v132
v_max3_f32 v32, v32, v101, v102
v_max3_f32 v33, v33, v109, v110
v_max3_f32 v34, v34, v117, v118
v_max3_f32 v35, v35, v125, v126
v_max3_f32 v36, v36, v133, v134
v_max_f32 v32, v32, v103
v_max_f32 v33, v33, v111
v_max_f32 v34, v34, v119
v_max_f32 v35, v35, v127
v_max_f32 v36, v36, v135
v_mov_b32 v40, v32
v_mov_b32 v41, v33
v_mov_b32 v42, v34
v_mov_b32 v43, v35
v_mov_b32 v44, v36
s_nop 1
v_permlane16_swap_b32 v32, v40
v_permlane16_swap_b32 v33, v41
v_permlane16_swap_b32 v34, v42
v_permlane16_swap_b32 v35, v43
v_permlane16_swap_b32 v36, v44
s_nop 1
v_max_f32 v32, v32, v40
v_max_f32 v33, v33, v41
v_max_f32 v34, v34, v42
v_max_f32 v35, v35, v43
v_max_f32 v36, v36, v44
v_mov_b32 v40, v32
v_mov_b32 v41, v33
v_mov_b32 v42, v34
v_mov_b32 v43, v35
v_mov_b32 v44, v36
s_nop 1
v_permlane32_swap_b32 v32, v40
v_permlane32_swap_b32 v33, v41
v_permlane32_swap_b32 v34, v42
v_permlane32_swap_b32 v35, v43
v_permlane32_swap_b32 v36, v44
s_nop 1
v_max_f32 v32, v32, v40
v_max_f32 v33, v33, v41
v_max_f32 v34, v34, v42
v_max_f32 v35, v35, v43
v_max_f32 v36, v36, v44
v_sub_f32 v56, 0, v32
v_sub_f32 v57, 0, v32
v_sub_f32 v58, 0, v32
v_sub_f32 v59, 0, v32
v_sub_f32 v60, 0, v33
v_sub_f32 v61, 0, v33
v_sub_f32 v62, 0, v33
v_sub_f32 v63, 0, v33
v_sub_f32 v64, 0, v34
v_sub_f32 v65, 0, v34
v_sub_f32 v66, 0, v34
v_sub_f32 v67, 0, v34
v_sub_f32 v68, 0, v35
v_sub_f32 v69, 0, v35
v_sub_f32 v70, 0, v35
v_sub_f32 v71, 0, v35
v_sub_f32 v72, 0, v36
v_sub_f32 v73, 0, v36
v_sub_f32 v74, 0, v36
v_sub_f32 v75, 0, v36
s_branch PRO_V500_go
PRO_V500_skipmax:
v_mov_b64 v[160:161], 0
v_mov_b64 v[162:163], 0
v_mov_b64 v[164:165], 0
v_mov_b64 v[166:167], 0
v_mov_b64 v[168:169], 0
v_mov_b64 v[170:171], 0
v_mov_b64 v[172:173], 0
v_mov_b64 v[174:175], 0
v_mov_b64 v[176:177], 0
v_mov_b64 v[178:179], 0
v_mov_b64 v[180:181], 0
v_mov_b64 v[182:183], 0
v_mov_b64 v[184:185], 0
v_mov_b64 v[186:187], 0
v_mov_b64 v[188:189], 0
v_mov_b64 v[190:191], 0
v_mov_b64 v[192:193], 0
v_mov_b64 v[194:195], 0
v_mov_b64 v[196:197], 0
v_mov_b64 v[198:199], 0
v_mov_b64 v[200:201], 0
v_mov_b64 v[202:203], 0
v_mov_b64 v[204:205], 0
v_mov_b64 v[206:207], 0
v_mov_b64 v[208:209], 0
v_mov_b64 v[210:211], 0
v_mov_b64 v[212:213], 0
v_mov_b64 v[214:215], 0
v_mov_b64 v[216:217], 0
v_mov_b64 v[218:219], 0
v_mov_b64 v[220:221], 0
v_mov_b64 v[222:223], 0
v_mov_b64 v[224:225], 0
v_mov_b64 v[226:227], 0
v_mov_b64 v[228:229], 0
v_mov_b64 v[230:231], 0
v_mov_b64 v[232:233], 0
v_mov_b64 v[234:235], 0
v_mov_b64 v[236:237], 0
v_mov_b64 v[238:239], 0
v_mov_b64 v[240:241], 0
v_mov_b64 v[242:243], 0
v_mov_b64 v[244:245], 0
v_mov_b64 v[246:247], 0
v_mov_b64 v[248:249], 0
v_mov_b64 v[250:251], 0
v_mov_b64 v[252:253], 0
v_mov_b64 v[254:255], 0
s_waitcnt lgkmcnt(0)
PRO_V500_go:
v_mov_b64 v[96:97], 0
v_mov_b64 v[98:99], 0
v_mov_b64 v[100:101], 0
v_mov_b64 v[102:103], 0
v_mov_b64 v[104:105], 0
v_mov_b64 v[106:107], 0
v_mov_b64 v[108:109], 0
v_mov_b64 v[110:111], 0
v_mov_b64 v[112:113], 0
v_mov_b64 v[114:115], 0
v_mov_b64 v[116:117], 0
v_mov_b64 v[118:119], 0
v_mov_b64 v[120:121], 0
v_mov_b64 v[122:123], 0
v_mov_b64 v[124:125], 0
v_mov_b64 v[126:127], 0
v_mov_b64 v[128:129], 0
v_mov_b64 v[130:131], 0
v_mov_b64 v[132:133], 0
v_mov_b64 v[134:135], 0
v_mov_b64 v[136:137], 0
v_mov_b64 v[138:139], 0
v_mov_b64 v[140:141], 0
v_mov_b64 v[142:143], 0
v_mov_b64 v[144:145], 0
v_mov_b64 v[146:147], 0
v_mov_b64 v[148:149], 0
v_mov_b64 v[150:151], 0
v_mov_b64 v[152:153], 0
v_mov_b64 v[154:155], 0
v_mov_b64 v[156:157], 0
v_mov_b64 v[158:159], 0
v_mov_b32 v32, v31
v_mov_b32 v33, v31
v_mov_b32 v34, v31
v_mov_b32 v35, v31
v_mov_b32 v36, v31
v_mov_b32 v37, v31
v_mov_b32 v38, v31
v_mov_b32 v39, v31
v_mov_b32 v40, v31
v_mov_b32 v41, v31
v_mov_b32 v42, v31
v_mov_b32 v43, v31
v_mov_b32 v44, v31
v_mov_b32 v45, v31
v_mov_b32 v46, v31
v_mov_b32 v47, v31
v_mov_b64 v[48:49], 0
v_mov_b64 v[50:51], 0
v_mov_b64 v[52:53], 0
v_mov_b64 v[54:55], 0
s_sub_u32 s71, 3, s45
s_mov_b32 s77, 0
s_sub_u32 s37, s2, s2
s_cmp_eq_u32 s57, 0
s_cselect_b32 s36, 1, -3
s_cmp_eq_u32 s72, 1
s_cbranch_scc1 BODY_V500_1
s_cmp_eq_u32 s72, 2
s_cbranch_scc1 BODY_V500_2
s_cmp_eq_u32 s72, 3
s_cbranch_scc1 BODY_V500_3
BODY_V500_0:
s_waitcnt lgkmcnt(0)
QK 32,80,0,56
EX 40
QK 32,84,4,32
VR 144,12,0
VR 146,12,4096
QK 32,88,8,32
EX 41
QK 32,92,12,32
VR 148,13,0
CV 52,40,41
QK 36,96,0,56
EX 42
QK 36,100,4,36
VR 150,13,4096
VR 152,14,0
QK 36,104,8,36
EX 43
QK 36,108,12,36
VR 154,14,4096
CV 53,42,43
PV 192,176,48
EX 44
PV 196,180,48
VR 156,15,0
VR 158,15,4096
PV 200,184,48
EX 45
PV 204,188,48
VR 160,16,0
CV 54,44,45
PV 208,192,48
EX 46
PV 212,196,48
VR 162,16,4096
VR 164,17,0
PV 216,200,48
EX 47
PV 220,204,48
VR 166,17,4096
CV 55,46,47
LM 220,48
VR 168,18,0
VR 170,18,4096
QK 40,80,16,60
EX 32
QK 40,84,20,40
VR 172,19,0
VR 174,19,4096
QK 40,88,24,40
EX 33
QK 40,92,28,40
KR 112,8,8192
CV 48,32,33
QK 44,96,16,60
EX 34
QK 44,100,20,44
KR 116,9,8192
KR 120,10,8192
QK 44,104,24,44
EX 35
QK 44,108,28,44
KR 124,11,8192
CV 49,34,35
PV 224,176,52
EX 36
PV 228,180,52
s_add_u32 m0, s26, 49152
KR 128,8,12288
PV 232,184,52
EX 37
PV 236,188,52
KR 132,9,12288
CV 50,36,37
PV 240,192,52
EX 38
PV 244,196,52
KR 136,10,12288
KR 140,11,12288
PV 248,200,52
EX 39
PV 252,204,52
CV 51,38,39
LM 224,52
buffer_load_dwordx4 v20, s[12:15], s28 offen offset:0 nt lds
QK 32,80,32,64
EX 40
QK 32,84,36,32
buffer_load_dwordx4 v21, s[12:15], s28 offen offset:1024 nt lds
QK 32,88,40,32
EX 41
QK 32,92,44,32
VR 176,12,8192
CV 52,40,41
QK 36,96,32,64
EX 42
QK 36,100,36,36
buffer_load_dwordx4 v22, s[12:15], s28 offen offset:2048 nt lds
QK 36,104,40,36
EX 43
QK 36,108,44,36
VR 178,12,12288
CV 53,42,43
s_waitcnt lgkmcnt(10)
PV 96,144,48
EX 44
PV 100,148,48
buffer_load_dwordx4 v23, s[12:15], s28 offen offset:3072 nt lds
PV 104,152,48
EX 45
PV 108,156,48
s_add_u32 s28, s28, 0x40000
CV 54,44,45
PV 112,160,48
EX 46
PV 116,164,48
VR 180,13,8192
VR 182,13,12288
PV 120,168,48
EX 47
PV 124,172,48
VR 184,14,8192
CV 55,46,47
LM 208,48
VR 186,14,12288
VR 188,15,8192
QK 40,80,48,68
EX 32
QK 40,84,52,40
VR 190,15,12288
VR 192,16,8192
QK 40,88,56,40
EX 33
QK 40,92,60,40
VR 194,16,12288
CV 48,32,33
QK 44,96,48,68
EX 34
QK 44,100,52,44
VR 196,17,8192
VR 198,17,12288
QK 44,104,56,44
EX 35
QK 44,108,60,44
VR 200,18,8192
CV 49,34,35
PV 128,144,52
EX 36
PV 132,148,52
VR 202,18,12288
VR 204,19,8192
PV 136,152,52
EX 37
PV 140,156,52
VR 206,19,12288
CV 50,36,37
PV 144,160,52
EX 38
PV 148,164,52
PV 152,168,52
EX 39
PV 156,172,52
CV 51,38,39
LM 212,52
QK 32,80,64,72
EX 40
QK 32,84,68,32
QK 32,88,72,32
EX 41
QK 32,92,76,32
CV 52,40,41
QK 36,96,64,72
EX 42
QK 36,100,68,36
QK 36,104,72,36
EX 43
QK 36,108,76,36
CV 53,42,43
PV 160,144,48
EX 44
PV 164,148,48
PV 168,152,48
EX 45
PV 172,156,48
CV 54,44,45
PV 176,160,48
EX 46
PV 180,164,48
PV 184,168,48
EX 47
PV 188,172,48
CV 55,46,47
LM 216,48
s_waitcnt vmcnt(12) lgkmcnt(15)
s_barrier
QK 40,112,0,56
EX 32
QK 40,116,4,40
KR 80,8,16384
KR 84,9,16384
QK 40,120,8,40
EX 33
QK 40,124,12,40
KR 88,10,16384
CV 48,32,33
QK 44,128,0,56
EX 34
QK 44,132,4,44
KR 92,11,16384
s_add_u32 m0, s27, 49152
QK 44,136,8,44
EX 35
QK 44,140,12,44
KR 96,8,20480
CV 49,34,35
PV 192,144,52
EX 36
PV 196,148,52
KR 100,9,20480
KR 104,10,20480
PV 200,152,52
EX 37
PV 204,156,52
KR 108,11,20480
CV 50,36,37
PV 208,160,52
EX 38
PV 212,164,52
buffer_load_dwordx4 v24, s[16:19], s29 offen offset:0 nt lds
PV 216,168,52
EX 39
PV 220,172,52
CV 51,38,39
LM 220,52
buffer_load_dwordx4 v25, s[16:19], s29 offen offset:1024 nt lds
QK 32,112,16,60
EX 40
QK 32,116,20,32
buffer_load_dwordx4 v26, s[16:19], s29 offen offset:2048 nt lds
QK 32,120,24,32
EX 41
QK 32,124,28,32
CV 52,40,41
QK 36,128,16,60
EX 42
QK 36,132,20,36
buffer_load_dwordx4 v27, s[16:19], s29 offen offset:3072 nt lds
QK 36,136,24,36
EX 43
QK 36,140,28,36
s_add_u32 s29, s29, 0x40000
CV 53,42,43
PV 224,144,48
EX 44
PV 228,148,48
PV 232,152,48
EX 45
PV 236,156,48
CV 54,44,45
PV 240,160,48
EX 46
PV 244,164,48
PV 248,168,48
EX 47
PV 252,172,48
CV 55,46,47
LM 224,48
QK 40,112,32,64
EX 32
QK 40,116,36,40
QK 40,120,40,40
EX 33
QK 40,124,44,40
CV 48,32,33
QK 44,128,32,64
EX 34
QK 44,132,36,44
QK 44,136,40,44
EX 35
QK 44,140,44,44
CV 49,34,35
s_waitcnt lgkmcnt(8)
PV 96,176,52
EX 36
PV 100,180,52
PV 104,184,52
EX 37
PV 108,188,52
CV 50,36,37
PV 112,192,52
EX 38
PV 116,196,52
PV 120,200,52
EX 39
PV 124,204,52
CV 51,38,39
LM 208,52
QK 32,112,48,68
EX 40
QK 32,116,52,32
QK 32,120,56,32
EX 41
QK 32,124,60,32
CV 52,40,41
QK 36,128,48,68
EX 42
QK 36,132,52,36
QK 36,136,56,36
EX 43
QK 36,140,60,36
CV 53,42,43
PV 128,176,48
EX 44
PV 132,180,48
PV 136,184,48
EX 45
PV 140,188,48
CV 54,44,45
PV 144,192,48
EX 46
PV 148,196,48
PV 152,200,48
EX 47
PV 156,204,48
CV 55,46,47
LM 212,48
QK 40,112,64,72
EX 32
QK 40,116,68,40
QK 40,120,72,40
EX 33
QK 40,124,76,40
CV 48,32,33
QK 44,128,64,72
EX 34
QK 44,132,68,44
QK 44,136,72,44
EX 35
QK 44,140,76,44
CV 49,34,35
PV 160,176,52
EX 36
PV 164,180,52
PV 168,184,52
EX 37
PV 172,188,52
CV 50,36,37
PV 176,192,52
EX 38
PV 180,196,52
PV 184,200,52
EX 39
PV 188,204,52
CV 51,38,39
LM 216,52
s_add_u32 s71, s71, 1
s_cbranch_scc1 SPEC_V500_0
BODY_V500_1:
s_waitcnt lgkmcnt(0)
QK 32,80,0,56
EX 40
QK 32,84,4,32
VR 144,12,16384
VR 146,12,20480
QK 32,88,8,32
EX 41
QK 32,92,12,32
VR 148,13,16384
CV 52,40,41
QK 36,96,0,56
EX 42
QK 36,100,4,36
VR 150,13,20480
VR 152,14,16384
QK 36,104,8,36
EX 43
QK 36,108,12,36
VR 154,14,20480
CV 53,42,43
PV 192,176,48
EX 44
PV 196,180,48
VR 156,15,16384
VR 158,15,20480
PV 200,184,48
EX 45
PV 204,188,48
VR 160,16,16384
CV 54,44,45
PV 208,192,48
EX 46
PV 212,196,48
VR 162,16,20480
VR 164,17,16384
PV 216,200,48
EX 47
PV 220,204,48
VR 166,17,20480
CV 55,46,47
LM 220,48
VR 168,18,16384
VR 170,18,20480
QK 40,80,16,60
EX 32
QK 40,84,20,40
VR 172,19,16384
VR 174,19,20480
QK 40,88,24,40
EX 33
QK 40,92,28,40
KR 112,8,24576
CV 48,32,33
QK 44,96,16,60
EX 34
QK 44,100,20,44
KR 116,9,24576
KR 120,10,24576
QK 44,104,24,44
EX 35
QK 44,108,28,44
KR 124,11,24576
CV 49,34,35
PV 224,176,52
EX 36
PV 228,180,52
s_add_u32 m0, s26, 0
KR 128,8,28672
PV 232,184,52
EX 37
PV 236,188,52
KR 132,9,28672
CV 50,36,37
PV 240,192,52
EX 38
PV 244,196,52
KR 136,10,28672
KR 140,11,28672
PV 248,200,52
EX 39
PV 252,204,52
CV 51,38,39
LM 224,52
buffer_load_dwordx4 v20, s[12:15], s28 offen offset:0 nt lds
QK 32,80,32,64
EX 40
QK 32,84,36,32
buffer_load_dwordx4 v21, s[12:15], s28 offen offset:1024 nt lds
QK 32,88,40,32
EX 41
QK 32,92,44,32
VR 176,12,24576
CV 52,40,41
QK 36,96,32,64
EX 42
QK 36,100,36,36
buffer_load_dwordx4 v22, s[12:15], s28 offen offset:2048 nt lds
QK 36,104,40,36
EX 43
QK 36,108,44,36
VR 178,12,28672
CV 53,42,43
s_waitcnt lgkmcnt(10)
PV 96,144,48
EX 44
PV 100,148,48
buffer_load_dwordx4 v23, s[12:15], s28 offen offset:3072 nt lds
PV 104,152,48
EX 45
PV 108,156,48
s_add_u32 s28, s28, 0x40000
CV 54,44,45
PV 112,160,48
EX 46
PV 116,164,48
VR 180,13,24576
VR 182,13,28672
PV 120,168,48
EX 47
PV 124,172,48
VR 184,14,24576
CV 55,46,47
LM 208,48
VR 186,14,28672
VR 188,15,24576
QK 40,80,48,68
EX 32
QK 40,84,52,40
VR 190,15,28672
VR 192,16,24576
QK 40,88,56,40
EX 33
QK 40,92,60,40
VR 194,16,28672
CV 48,32,33
QK 44,96,48,68
EX 34
QK 44,100,52,44
VR 196,17,24576
VR 198,17,28672
QK 44,104,56,44
EX 35
QK 44,108,60,44
VR 200,18,24576
CV 49,34,35
PV 128,144,52
EX 36
PV 132,148,52
VR 202,18,28672
VR 204,19,24576
PV 136,152,52
EX 37
PV 140,156,52
VR 206,19,28672
CV 50,36,37
PV 144,160,52
EX 38
PV 148,164,52
PV 152,168,52
EX 39
PV 156,172,52
CV 51,38,39
LM 212,52
QK 32,80,64,72
EX 40
QK 32,84,68,32
QK 32,88,72,32
EX 41
QK 32,92,76,32
CV 52,40,41
QK 36,96,64,72
EX 42
QK 36,100,68,36
QK 36,104,72,36
EX 43
QK 36,108,76,36
CV 53,42,43
PV 160,144,48
EX 44
PV 164,148,48
PV 168,152,48
EX 45
PV 172,156,48
CV 54,44,45
PV 176,160,48
EX 46
PV 180,164,48
PV 184,168,48
EX 47
PV 188,172,48
CV 55,46,47
LM 216,48
s_waitcnt vmcnt(12) lgkmcnt(15)
s_barrier
QK 40,112,0,56
EX 32
QK 40,116,4,40
KR 80,8,32768
KR 84,9,32768
QK 40,120,8,40
EX 33
QK 40,124,12,40
KR 88,10,32768
CV 48,32,33
QK 44,128,0,56
EX 34
QK 44,132,4,44
KR 92,11,32768
s_add_u32 m0, s27, 0
QK 44,136,8,44
EX 35
QK 44,140,12,44
KR 96,8,36864
CV 49,34,35
PV 192,144,52
EX 36
PV 196,148,52
KR 100,9,36864
KR 104,10,36864
PV 200,152,52
EX 37
PV 204,156,52
KR 108,11,36864
CV 50,36,37
PV 208,160,52
EX 38
PV 212,164,52
buffer_load_dwordx4 v24, s[16:19], s29 offen offset:0 nt lds
PV 216,168,52
EX 39
PV 220,172,52
CV 51,38,39
LM 220,52
buffer_load_dwordx4 v25, s[16:19], s29 offen offset:1024 nt lds
QK 32,112,16,60
EX 40
QK 32,116,20,32
buffer_load_dwordx4 v26, s[16:19], s29 offen offset:2048 nt lds
QK 32,120,24,32
EX 41
QK 32,124,28,32
CV 52,40,41
QK 36,128,16,60
EX 42
QK 36,132,20,36
buffer_load_dwordx4 v27, s[16:19], s29 offen offset:3072 nt lds
QK 36,136,24,36
EX 43
QK 36,140,28,36
s_add_u32 s29, s29, 0x40000
CV 53,42,43
PV 224,144,48
EX 44
PV 228,148,48
PV 232,152,48
EX 45
PV 236,156,48
CV 54,44,45
PV 240,160,48
EX 46
PV 244,164,48
PV 248,168,48
EX 47
PV 252,172,48
CV 55,46,47
LM 224,48
QK 40,112,32,64
EX 32
QK 40,116,36,40
QK 40,120,40,40
EX 33
QK 40,124,44,40
CV 48,32,33
QK 44,128,32,64
EX 34
QK 44,132,36,44
QK 44,136,40,44
EX 35
QK 44,140,44,44
CV 49,34,35
s_waitcnt lgkmcnt(8)
PV 96,176,52
EX 36
PV 100,180,52
PV 104,184,52
EX 37
PV 108,188,52
CV 50,36,37
PV 112,192,52
EX 38
PV 116,196,52
PV 120,200,52
EX 39
PV 124,204,52
CV 51,38,39
LM 208,52
QK 32,112,48,68
EX 40
QK 32,116,52,32
QK 32,120,56,32
EX 41
QK 32,124,60,32
CV 52,40,41
QK 36,128,48,68
EX 42
QK 36,132,52,36
QK 36,136,56,36
EX 43
QK 36,140,60,36
CV 53,42,43
PV 128,176,48
EX 44
PV 132,180,48
PV 136,184,48
EX 45
PV 140,188,48
CV 54,44,45
PV 144,192,48
EX 46
PV 148,196,48
PV 152,200,48
EX 47
PV 156,204,48
CV 55,46,47
LM 212,48
QK 40,112,64,72
EX 32
QK 40,116,68,40
QK 40,120,72,40
EX 33
QK 40,124,76,40
CV 48,32,33
QK 44,128,64,72
EX 34
QK 44,132,68,44
QK 44,136,72,44
EX 35
QK 44,140,76,44
CV 49,34,35
PV 160,176,52
EX 36
PV 164,180,52
PV 168,184,52
EX 37
PV 172,188,52
CV 50,36,37
PV 176,192,52
EX 38
PV 180,196,52
PV 184,200,52
EX 39
PV 188,204,52
CV 51,38,39
LM 216,52
s_add_u32 s71, s71, 1
s_cbranch_scc1 SPEC_V500_1
BODY_V500_2:
s_waitcnt lgkmcnt(0)
QK 32,80,0,56
EX 40
QK 32,84,4,32
VR 144,12,32768
VR 146,12,36864
QK 32,88,8,32
EX 41
QK 32,92,12,32
VR 148,13,32768
CV 52,40,41
QK 36,96,0,56
EX 42
QK 36,100,4,36
VR 150,13,36864
VR 152,14,32768
QK 36,104,8,36
EX 43
QK 36,108,12,36
VR 154,14,36864
CV 53,42,43
PV 192,176,48
EX 44
PV 196,180,48
VR 156,15,32768
VR 158,15,36864
PV 200,184,48
EX 45
PV 204,188,48
VR 160,16,32768
CV 54,44,45
PV 208,192,48
EX 46
PV 212,196,48
VR 162,16,36864
VR 164,17,32768
PV 216,200,48
EX 47
PV 220,204,48
VR 166,17,36864
CV 55,46,47
LM 220,48
VR 168,18,32768
VR 170,18,36864
QK 40,80,16,60
EX 32
QK 40,84,20,40
VR 172,19,32768
VR 174,19,36864
QK 40,88,24,40
EX 33
QK 40,92,28,40
KR 112,8,40960
CV 48,32,33
QK 44,96,16,60
EX 34
QK 44,100,20,44
KR 116,9,40960
KR 120,10,40960
QK 44,104,24,44
EX 35
QK 44,108,28,44
KR 124,11,40960
CV 49,34,35
PV 224,176,52
EX 36
PV 228,180,52
s_add_u32 m0, s26, 16384
KR 128,8,45056
PV 232,184,52
EX 37
PV 236,188,52
KR 132,9,45056
CV 50,36,37
PV 240,192,52
EX 38
PV 244,196,52
KR 136,10,45056
KR 140,11,45056
PV 248,200,52
EX 39
PV 252,204,52
CV 51,38,39
LM 224,52
buffer_load_dwordx4 v20, s[12:15], s28 offen offset:0 nt lds
QK 32,80,32,64
EX 40
QK 32,84,36,32
buffer_load_dwordx4 v21, s[12:15], s28 offen offset:1024 nt lds
QK 32,88,40,32
EX 41
QK 32,92,44,32
VR 176,12,40960
CV 52,40,41
QK 36,96,32,64
EX 42
QK 36,100,36,36
buffer_load_dwordx4 v22, s[12:15], s28 offen offset:2048 nt lds
QK 36,104,40,36
EX 43
QK 36,108,44,36
VR 178,12,45056
CV 53,42,43
s_waitcnt lgkmcnt(10)
PV 96,144,48
EX 44
PV 100,148,48
buffer_load_dwordx4 v23, s[12:15], s28 offen offset:3072 nt lds
PV 104,152,48
EX 45
PV 108,156,48
s_add_u32 s28, s28, 0x40000
CV 54,44,45
PV 112,160,48
EX 46
PV 116,164,48
VR 180,13,40960
VR 182,13,45056
PV 120,168,48
EX 47
PV 124,172,48
VR 184,14,40960
CV 55,46,47
LM 208,48
VR 186,14,45056
VR 188,15,40960
QK 40,80,48,68
EX 32
QK 40,84,52,40
VR 190,15,45056
VR 192,16,40960
QK 40,88,56,40
EX 33
QK 40,92,60,40
VR 194,16,45056
CV 48,32,33
QK 44,96,48,68
EX 34
QK 44,100,52,44
VR 196,17,40960
VR 198,17,45056
QK 44,104,56,44
EX 35
QK 44,108,60,44
VR 200,18,40960
CV 49,34,35
PV 128,144,52
EX 36
PV 132,148,52
VR 202,18,45056
VR 204,19,40960
PV 136,152,52
EX 37
PV 140,156,52
VR 206,19,45056
CV 50,36,37
PV 144,160,52
EX 38
PV 148,164,52
PV 152,168,52
EX 39
PV 156,172,52
CV 51,38,39
LM 212,52
QK 32,80,64,72
EX 40
QK 32,84,68,32
QK 32,88,72,32
EX 41
QK 32,92,76,32
CV 52,40,41
QK 36,96,64,72
EX 42
QK 36,100,68,36
QK 36,104,72,36
EX 43
QK 36,108,76,36
CV 53,42,43
PV 160,144,48
EX 44
PV 164,148,48
PV 168,152,48
EX 45
PV 172,156,48
CV 54,44,45
PV 176,160,48
EX 46
PV 180,164,48
PV 184,168,48
EX 47
PV 188,172,48
CV 55,46,47
LM 216,48
s_waitcnt vmcnt(12) lgkmcnt(15)
s_barrier
QK 40,112,0,56
EX 32
QK 40,116,4,40
KR 80,8,49152
KR 84,9,49152
QK 40,120,8,40
EX 33
QK 40,124,12,40
KR 88,10,49152
CV 48,32,33
QK 44,128,0,56
EX 34
QK 44,132,4,44
KR 92,11,49152
s_add_u32 m0, s27, 16384
QK 44,136,8,44
EX 35
QK 44,140,12,44
KR 96,8,53248
CV 49,34,35
PV 192,144,52
EX 36
PV 196,148,52
KR 100,9,53248
KR 104,10,53248
PV 200,152,52
EX 37
PV 204,156,52
KR 108,11,53248
CV 50,36,37
PV 208,160,52
EX 38
PV 212,164,52
buffer_load_dwordx4 v24, s[16:19], s29 offen offset:0 nt lds
PV 216,168,52
EX 39
PV 220,172,52
CV 51,38,39
LM 220,52
buffer_load_dwordx4 v25, s[16:19], s29 offen offset:1024 nt lds
QK 32,112,16,60
EX 40
QK 32,116,20,32
buffer_load_dwordx4 v26, s[16:19], s29 offen offset:2048 nt lds
QK 32,120,24,32
EX 41
QK 32,124,28,32
CV 52,40,41
QK 36,128,16,60
EX 42
QK 36,132,20,36
buffer_load_dwordx4 v27, s[16:19], s29 offen offset:3072 nt lds
QK 36,136,24,36
EX 43
QK 36,140,28,36
s_add_u32 s29, s29, 0x40000
CV 53,42,43
PV 224,144,48
EX 44
PV 228,148,48
PV 232,152,48
EX 45
PV 236,156,48
CV 54,44,45
PV 240,160,48
EX 46
PV 244,164,48
PV 248,168,48
EX 47
PV 252,172,48
CV 55,46,47
LM 224,48
QK 40,112,32,64
EX 32
QK 40,116,36,40
QK 40,120,40,40
EX 33
QK 40,124,44,40
CV 48,32,33
QK 44,128,32,64
EX 34
QK 44,132,36,44
QK 44,136,40,44
EX 35
QK 44,140,44,44
CV 49,34,35
s_waitcnt lgkmcnt(8)
PV 96,176,52
EX 36
PV 100,180,52
PV 104,184,52
EX 37
PV 108,188,52
CV 50,36,37
PV 112,192,52
EX 38
PV 116,196,52
PV 120,200,52
EX 39
PV 124,204,52
CV 51,38,39
LM 208,52
QK 32,112,48,68
EX 40
QK 32,116,52,32
QK 32,120,56,32
EX 41
QK 32,124,60,32
CV 52,40,41
QK 36,128,48,68
EX 42
QK 36,132,52,36
QK 36,136,56,36
EX 43
QK 36,140,60,36
CV 53,42,43
PV 128,176,48
EX 44
PV 132,180,48
PV 136,184,48
EX 45
PV 140,188,48
CV 54,44,45
PV 144,192,48
EX 46
PV 148,196,48
PV 152,200,48
EX 47
PV 156,204,48
CV 55,46,47
LM 212,48
QK 40,112,64,72
EX 32
QK 40,116,68,40
QK 40,120,72,40
EX 33
QK 40,124,76,40
CV 48,32,33
QK 44,128,64,72
EX 34
QK 44,132,68,44
QK 44,136,72,44
EX 35
QK 44,140,76,44
CV 49,34,35
PV 160,176,52
EX 36
PV 164,180,52
PV 168,184,52
EX 37
PV 172,188,52
CV 50,36,37
PV 176,192,52
EX 38
PV 180,196,52
PV 184,200,52
EX 39
PV 188,204,52
CV 51,38,39
LM 216,52
s_add_u32 s71, s71, 1
s_cbranch_scc1 SPEC_V500_2
BODY_V500_3:
s_waitcnt lgkmcnt(0)
QK 32,80,0,56
EX 40
QK 32,84,4,32
VR 144,12,49152
VR 146,12,53248
QK 32,88,8,32
EX 41
QK 32,92,12,32
VR 148,13,49152
CV 52,40,41
QK 36,96,0,56
EX 42
QK 36,100,4,36
VR 150,13,53248
VR 152,14,49152
QK 36,104,8,36
EX 43
QK 36,108,12,36
VR 154,14,53248
CV 53,42,43
PV 192,176,48
EX 44
PV 196,180,48
VR 156,15,49152
VR 158,15,53248
PV 200,184,48
EX 45
PV 204,188,48
VR 160,16,49152
CV 54,44,45
PV 208,192,48
EX 46
PV 212,196,48
VR 162,16,53248
VR 164,17,49152
PV 216,200,48
EX 47
PV 220,204,48
VR 166,17,53248
CV 55,46,47
LM 220,48
VR 168,18,49152
VR 170,18,53248
QK 40,80,16,60
EX 32
QK 40,84,20,40
VR 172,19,49152
VR 174,19,53248
QK 40,88,24,40
EX 33
QK 40,92,28,40
KR 112,8,57344
CV 48,32,33
QK 44,96,16,60
EX 34
QK 44,100,20,44
KR 116,9,57344
KR 120,10,57344
QK 44,104,24,44
EX 35
QK 44,108,28,44
KR 124,11,57344
CV 49,34,35
PV 224,176,52
EX 36
PV 228,180,52
s_add_u32 m0, s26, 32768
KR 128,8,61440
PV 232,184,52
EX 37
PV 236,188,52
KR 132,9,61440
CV 50,36,37
PV 240,192,52
EX 38
PV 244,196,52
KR 136,10,61440
KR 140,11,61440
PV 248,200,52
EX 39
PV 252,204,52
CV 51,38,39
LM 224,52
buffer_load_dwordx4 v20, s[12:15], s28 offen offset:0 nt lds
QK 32,80,32,64
EX 40
QK 32,84,36,32
buffer_load_dwordx4 v21, s[12:15], s28 offen offset:1024 nt lds
QK 32,88,40,32
EX 41
QK 32,92,44,32
VR 176,12,57344
CV 52,40,41
QK 36,96,32,64
EX 42
QK 36,100,36,36
buffer_load_dwordx4 v22, s[12:15], s28 offen offset:2048 nt lds
QK 36,104,40,36
EX 43
QK 36,108,44,36
VR 178,12,61440
CV 53,42,43
s_waitcnt lgkmcnt(10)
PV 96,144,48
EX 44
PV 100,148,48
buffer_load_dwordx4 v23, s[12:15], s28 offen offset:3072 nt lds
PV 104,152,48
EX 45
PV 108,156,48
s_add_u32 s28, s28, 0x40000
CV 54,44,45
PV 112,160,48
EX 46
PV 116,164,48
VR 180,13,57344
VR 182,13,61440
PV 120,168,48
EX 47
PV 124,172,48
VR 184,14,57344
CV 55,46,47
LM 208,48
VR 186,14,61440
VR 188,15,57344
QK 40,80,48,68
EX 32
QK 40,84,52,40
VR 190,15,61440
VR 192,16,57344
QK 40,88,56,40
EX 33
QK 40,92,60,40
VR 194,16,61440
CV 48,32,33
QK 44,96,48,68
EX 34
QK 44,100,52,44
VR 196,17,57344
VR 198,17,61440
QK 44,104,56,44
EX 35
QK 44,108,60,44
VR 200,18,57344
CV 49,34,35
PV 128,144,52
EX 36
PV 132,148,52
VR 202,18,61440
VR 204,19,57344
PV 136,152,52
EX 37
PV 140,156,52
VR 206,19,61440
CV 50,36,37
PV 144,160,52
EX 38
PV 148,164,52
PV 152,168,52
EX 39
PV 156,172,52
CV 51,38,39
LM 212,52
QK 32,80,64,72
EX 40
QK 32,84,68,32
QK 32,88,72,32
EX 41
QK 32,92,76,32
CV 52,40,41
QK 36,96,64,72
EX 42
QK 36,100,68,36
QK 36,104,72,36
EX 43
QK 36,108,76,36
CV 53,42,43
PV 160,144,48
EX 44
PV 164,148,48
PV 168,152,48
EX 45
PV 172,156,48
CV 54,44,45
PV 176,160,48
EX 46
PV 180,164,48
PV 184,168,48
EX 47
PV 188,172,48
CV 55,46,47
LM 216,48
s_waitcnt vmcnt(12) lgkmcnt(15)
s_barrier
QK 40,112,0,56
EX 32
QK 40,116,4,40
KR 80,8,0
KR 84,9,0
QK 40,120,8,40
EX 33
QK 40,124,12,40
KR 88,10,0
CV 48,32,33
QK 44,128,0,56
EX 34
QK 44,132,4,44
KR 92,11,0
s_add_u32 m0, s27, 32768
QK 44,136,8,44
EX 35
QK 44,140,12,44
KR 96,8,4096
CV 49,34,35
PV 192,144,52
EX 36
PV 196,148,52
KR 100,9,4096
KR 104,10,4096
PV 200,152,52
EX 37
PV 204,156,52
KR 108,11,4096
CV 50,36,37
PV 208,160,52
EX 38
PV 212,164,52
buffer_load_dwordx4 v24, s[16:19], s29 offen offset:0 nt lds
PV 216,168,52
EX 39
PV 220,172,52
CV 51,38,39
LM 220,52
buffer_load_dwordx4 v25, s[16:19], s29 offen offset:1024 nt lds
QK 32,112,16,60
EX 40
QK 32,116,20,32
buffer_load_dwordx4 v26, s[16:19], s29 offen offset:2048 nt lds
QK 32,120,24,32
EX 41
QK 32,124,28,32
CV 52,40,41
QK 36,128,16,60
EX 42
QK 36,132,20,36
buffer_load_dwordx4 v27, s[16:19], s29 offen offset:3072 nt lds
QK 36,136,24,36
EX 43
QK 36,140,28,36
s_add_u32 s29, s29, 0x40000
CV 53,42,43
PV 224,144,48
EX 44
PV 228,148,48
PV 232,152,48
EX 45
PV 236,156,48
CV 54,44,45
PV 240,160,48
EX 46
PV 244,164,48
PV 248,168,48
EX 47
PV 252,172,48
CV 55,46,47
LM 224,48
QK 40,112,32,64
EX 32
QK 40,116,36,40
QK 40,120,40,40
EX 33
QK 40,124,44,40
CV 48,32,33
QK 44,128,32,64
EX 34
QK 44,132,36,44
QK 44,136,40,44
EX 35
QK 44,140,44,44
CV 49,34,35
s_waitcnt lgkmcnt(8)
PV 96,176,52
EX 36
PV 100,180,52
PV 104,184,52
EX 37
PV 108,188,52
CV 50,36,37
PV 112,192,52
EX 38
PV 116,196,52
PV 120,200,52
EX 39
PV 124,204,52
CV 51,38,39
LM 208,52
QK 32,112,48,68
EX 40
QK 32,116,52,32
QK 32,120,56,32
EX 41
QK 32,124,60,32
CV 52,40,41
QK 36,128,48,68
EX 42
QK 36,132,52,36
QK 36,136,56,36
EX 43
QK 36,140,60,36
CV 53,42,43
PV 128,176,48
EX 44
PV 132,180,48
PV 136,184,48
EX 45
PV 140,188,48
CV 54,44,45
PV 144,192,48
EX 46
PV 148,196,48
PV 152,200,48
EX 47
PV 156,204,48
CV 55,46,47
LM 212,48
QK 40,112,64,72
EX 32
QK 40,116,68,40
QK 40,120,72,40
EX 33
QK 40,124,76,40
CV 48,32,33
QK 44,128,64,72
EX 34
QK 44,132,68,44
QK 44,136,72,44
EX 35
QK 44,140,76,44
CV 49,34,35
PV 160,176,52
EX 36
PV 164,180,52
PV 168,184,52
EX 37
PV 172,188,52
CV 50,36,37
PV 176,192,52
EX 38
PV 180,196,52
PV 184,200,52
EX 39
PV 188,204,52
CV 51,38,39
LM 216,52
s_add_u32 s71, s71, 1
s_cbranch_scc1 SPEC_V500_3
s_branch BODY_V500_0
SPEC_V500_0:
s_mov_b32 s71, -1
s_add_u32 s77, s77, 1
s_cmp_eq_u32 s77, 3
s_cbranch_scc1 TAIL_V500_1
s_cmp_eq_u32 s77, 2
s_cbranch_scc1 BODY_V500_1
s_mov_b32 s28, s54
s_mov_b32 s29, s54
s_mov_b32 s14, s56
s_mov_b32 s18, s56
s_branch BODY_V500_1
SPEC_V500_1:
s_mov_b32 s71, -1
s_add_u32 s77, s77, 1
s_cmp_eq_u32 s77, 3
s_cbranch_scc1 TAIL_V500_2
s_cmp_eq_u32 s77, 2
s_cbranch_scc1 BODY_V500_2
s_mov_b32 s28, s54
s_mov_b32 s29, s54
s_mov_b32 s14, s56
s_mov_b32 s18, s56
s_branch BODY_V500_2
SPEC_V500_2:
s_mov_b32 s71, -1
s_add_u32 s77, s77, 1
s_cmp_eq_u32 s77, 3
s_cbranch_scc1 TAIL_V500_3
s_cmp_eq_u32 s77, 2
s_cbranch_scc1 BODY_V500_3
s_mov_b32 s28, s54
s_mov_b32 s29, s54
s_mov_b32 s14, s56
s_mov_b32 s18, s56
s_branch BODY_V500_3
SPEC_V500_3:
s_mov_b32 s71, -1
s_add_u32 s77, s77, 1
s_cmp_eq_u32 s77, 3
s_cbranch_scc1 TAIL_V500_0
s_cmp_eq_u32 s77, 2
s_cbranch_scc1 BODY_V500_0
s_mov_b32 s28, s54
s_mov_b32 s29, s54
s_mov_b32 s14, s56
s_mov_b32 s18, s56
s_branch BODY_V500_0
TAIL_V500_0:
s_waitcnt lgkmcnt(0)
QK 32,80,0,56
EX 40
QK 32,84,4,32
VR 144,12,0
VR 146,12,4096
QK 32,88,8,32
EX 41
QK 32,92,12,32
VR 148,13,0
CV 52,40,41
QK 36,96,0,56
EX 42
QK 36,100,4,36
VR 150,13,4096
VR 152,14,0
QK 36,104,8,36
EX 43
QK 36,108,12,36
VR 154,14,4096
CV 53,42,43
PV 192,176,48
EX 44
PV 196,180,48
VR 156,15,0
VR 158,15,4096
PV 200,184,48
EX 45
PV 204,188,48
VR 160,16,0
CV 54,44,45
PV 208,192,48
EX 46
PV 212,196,48
VR 162,16,4096
VR 164,17,0
PV 216,200,48
EX 47
PV 220,204,48
VR 166,17,4096
CV 55,46,47
LM 220,48
VR 168,18,0
VR 170,18,4096
QK 40,80,16,60
EX 32
QK 40,84,20,40
VR 172,19,0
VR 174,19,4096
QK 40,88,24,40
EX 33
QK 40,92,28,40
KR 112,8,8192
CV 48,32,33
QK 44,96,16,60
EX 34
QK 44,100,20,44
KR 116,9,8192
KR 120,10,8192
QK 44,104,24,44
EX 35
QK 44,108,28,44
KR 124,11,8192
CV 49,34,35
PV 224,176,52
EX 36
PV 228,180,52
s_add_u32 m0, s26, 49152
KR 128,8,12288
PV 232,184,52
EX 37
PV 236,188,52
KR 132,9,12288
CV 50,36,37
PV 240,192,52
EX 38
PV 244,196,52
KR 136,10,12288
KR 140,11,12288
PV 248,200,52
EX 39
PV 252,204,52
CV 51,38,39
LM 224,52
buffer_load_dwordx4 v20, s[12:15], s28 offen offset:0 nt lds
QK 32,80,32,64
EX 40
QK 32,84,36,32
buffer_load_dwordx4 v21, s[12:15], s28 offen offset:1024 nt lds
QK 32,88,40,32
EX 41
QK 32,92,44,32
VR 176,12,8192
CV 52,40,41
QK 36,96,32,64
EX 42
QK 36,100,36,36
buffer_load_dwordx4 v22, s[12:15], s28 offen offset:2048 nt lds
QK 36,104,40,36
EX 43
QK 36,108,44,36
VR 178,12,12288
CV 53,42,43
s_waitcnt lgkmcnt(10)
PV 96,144,48
EX 44
PV 100,148,48
buffer_load_dwordx4 v23, s[12:15], s28 offen offset:3072 nt lds
PV 104,152,48
EX 45
PV 108,156,48
s_add_u32 s28, s28, 0x40000
CV 54,44,45
PV 112,160,48
EX 46
PV 116,164,48
VR 180,13,8192
VR 182,13,12288
PV 120,168,48
EX 47
PV 124,172,48
VR 184,14,8192
CV 55,46,47
LM 208,48
VR 186,14,12288
VR 188,15,8192
QK 40,80,48,68
EX 32
QK 40,84,52,40
VR 190,15,12288
VR 192,16,8192
QK 40,88,56,40
EX 33
QK 40,92,60,40
VR 194,16,12288
CV 48,32,33
QK 44,96,48,68
EX 34
QK 44,100,52,44
VR 196,17,8192
VR 198,17,12288
QK 44,104,56,44
EX 35
QK 44,108,60,44
VR 200,18,8192
CV 49,34,35
PV 128,144,52
EX 36
PV 132,148,52
VR 202,18,12288
VR 204,19,8192
PV 136,152,52
EX 37
PV 140,156,52
VR 206,19,12288
CV 50,36,37
PV 144,160,52
EX 38
PV 148,164,52
PV 152,168,52
EX 39
PV 156,172,52
CV 51,38,39
LM 212,52
QK 32,80,64,72
EX 40
QK 32,84,68,32
QK 32,88,72,32
EX 41
QK 32,92,76,32
CV 52,40,41
QK 36,96,64,72
EX 42
QK 36,100,68,36
QK 36,104,72,36
EX 43
QK 36,108,76,36
CV 53,42,43
PV 160,144,48
EX 44
PV 164,148,48
PV 168,152,48
EX 45
PV 172,156,48
CV 54,44,45
PV 176,160,48
EX 46
PV 180,164,48
PV 184,168,48
EX 47
PV 188,172,48
CV 55,46,47
LM 216,48
s_waitcnt vmcnt(12) lgkmcnt(15)
s_barrier
v_add_f32 v40, v56, v76
v_add_f32 v41, v56, v77
v_add_f32 v42, v56, v78
v_add_f32 v43, v56, v79
v_add_f32 v44, v56, v80
v_add_f32 v45, v56, v81
v_add_f32 v46, v56, v82
v_add_f32 v47, v56, v83
s_nop 1
QK 40,112,0,40
EX 32
QK 40,116,4,40
KR 80,8,16384
KR 84,9,16384
QK 40,120,8,40
EX 33
QK 40,124,12,40
KR 88,10,16384
CV 48,32,33
QK 44,128,0,44
EX 34
QK 44,132,4,44
KR 92,11,16384
s_add_u32 m0, s27, 49152
QK 44,136,8,44
EX 35
QK 44,140,12,44
KR 96,8,20480
CV 49,34,35
PV 192,144,52
EX 36
PV 196,148,52
KR 100,9,20480
KR 104,10,20480
PV 200,152,52
EX 37
PV 204,156,52
KR 108,11,20480
CV 50,36,37
PV 208,160,52
EX 38
PV 212,164,52
buffer_load_dwordx4 v24, s[16:19], s29 offen offset:0 nt lds
PV 216,168,52
EX 39
PV 220,172,52
CV 51,38,39
LM 220,52
buffer_load_dwordx4 v25, s[16:19], s29 offen offset:1024 nt lds
v_add_f32 v32, v60, v76
v_add_f32 v33, v60, v77
v_add_f32 v34, v60, v78
v_add_f32 v35, v60, v79
v_add_f32 v36, v60, v80
v_add_f32 v37, v60, v81
v_add_f32 v38, v60, v82
v_add_f32 v39, v60, v83
s_nop 1
QK 32,112,16,32
EX 40
QK 32,116,20,32
buffer_load_dwordx4 v26, s[16:19], s29 offen offset:2048 nt lds
QK 32,120,24,32
EX 41
QK 32,124,28,32
CV 52,40,41
QK 36,128,16,36
EX 42
QK 36,132,20,36
buffer_load_dwordx4 v27, s[16:19], s29 offen offset:3072 nt lds
QK 36,136,24,36
EX 43
QK 36,140,28,36
s_add_u32 s29, s29, 0x40000
CV 53,42,43
PV 224,144,48
EX 44
PV 228,148,48
PV 232,152,48
EX 45
PV 236,156,48
CV 54,44,45
PV 240,160,48
EX 46
PV 244,164,48
PV 248,168,48
EX 47
PV 252,172,48
CV 55,46,47
LM 224,48
v_add_f32 v40, v64, v76
v_add_f32 v41, v64, v77
v_add_f32 v42, v64, v78
v_add_f32 v43, v64, v79
v_add_f32 v44, v64, v80
v_add_f32 v45, v64, v81
v_add_f32 v46, v64, v82
v_add_f32 v47, v64, v83
s_nop 1
QK 40,112,32,40
EX 32
QK 40,116,36,40
QK 40,120,40,40
EX 33
QK 40,124,44,40
CV 48,32,33
QK 44,128,32,44
EX 34
QK 44,132,36,44
QK 44,136,40,44
EX 35
QK 44,140,44,44
CV 49,34,35
s_waitcnt lgkmcnt(8)
PV 96,176,52
EX 36
PV 100,180,52
PV 104,184,52
EX 37
PV 108,188,52
CV 50,36,37
PV 112,192,52
EX 38
PV 116,196,52
PV 120,200,52
EX 39
PV 124,204,52
CV 51,38,39
LM 208,52
v_add_f32 v32, v68, v76
v_add_f32 v33, v68, v77
v_add_f32 v34, v68, v78
v_add_f32 v35, v68, v79
v_add_f32 v36, v68, v80
v_add_f32 v37, v68, v81
v_add_f32 v38, v68, v82
v_add_f32 v39, v68, v83
s_nop 1
QK 32,112,48,32
EX 40
QK 32,116,52,32
QK 32,120,56,32
EX 41
QK 32,124,60,32
CV 52,40,41
QK 36,128,48,36
EX 42
QK 36,132,52,36
QK 36,136,56,36
EX 43
QK 36,140,60,36
CV 53,42,43
PV 128,176,48
EX 44
PV 132,180,48
PV 136,184,48
EX 45
PV 140,188,48
CV 54,44,45
PV 144,192,48
EX 46
PV 148,196,48
PV 152,200,48
EX 47
PV 156,204,48
CV 55,46,47
LM 212,48
v_add_f32 v40, v72, v76
v_add_f32 v41, v72, v77
v_add_f32 v42, v72, v78
v_add_f32 v43, v72, v79
v_add_f32 v44, v72, v80
v_add_f32 v45, v72, v81
v_add_f32 v46, v72, v82
v_add_f32 v47, v72, v83
s_nop 1
QK 40,112,64,40
EX 32
QK 40,116,68,40
QK 40,120,72,40
EX 33
QK 40,124,76,40
CV 48,32,33
QK 44,128,64,44
EX 34
QK 44,132,68,44
QK 44,136,72,44
EX 35
QK 44,140,76,44
CV 49,34,35
PV 160,176,52
EX 36
PV 164,180,52
PV 168,184,52
EX 37
PV 172,188,52
CV 50,36,37
PV 176,192,52
EX 38
PV 180,196,52
PV 184,200,52
EX 39
PV 188,204,52
CV 51,38,39
LM 216,52
s_waitcnt lgkmcnt(0)
PV 192,176,48
EX 40
PV 196,180,48
EX 41
PV 200,184,48
EX 42
PV 204,188,48
EX 43
PV 208,192,48
EX 44
PV 212,196,48
EX 45
PV 216,200,48
EX 46
PV 220,204,48
EX 47
LM 220,48
CV 52,40,41
CV 53,42,43
CV 54,44,45
CV 55,46,47
s_nop 1
LM 224,52
PV 224,176,52
PV 228,180,52
PV 232,184,52
PV 236,188,52
PV 240,192,52
PV 244,196,52
PV 248,200,52
PV 252,204,52
s_mov_b32 s72, 1
s_branch EPI_V500
TAIL_V500_1:
s_waitcnt lgkmcnt(0)
QK 32,80,0,56
EX 40
QK 32,84,4,32
VR 144,12,16384
VR 146,12,20480
QK 32,88,8,32
EX 41
QK 32,92,12,32
VR 148,13,16384
CV 52,40,41
QK 36,96,0,56
EX 42
QK 36,100,4,36
VR 150,13,20480
VR 152,14,16384
QK 36,104,8,36
EX 43
QK 36,108,12,36
VR 154,14,20480
CV 53,42,43
PV 192,176,48
EX 44
PV 196,180,48
VR 156,15,16384
VR 158,15,20480
PV 200,184,48
EX 45
PV 204,188,48
VR 160,16,16384
CV 54,44,45
PV 208,192,48
EX 46
PV 212,196,48
VR 162,16,20480
VR 164,17,16384
PV 216,200,48
EX 47
PV 220,204,48
VR 166,17,20480
CV 55,46,47
LM 220,48
VR 168,18,16384
VR 170,18,20480
QK 40,80,16,60
EX 32
QK 40,84,20,40
VR 172,19,16384
VR 174,19,20480
QK 40,88,24,40
EX 33
QK 40,92,28,40
KR 112,8,24576
CV 48,32,33
QK 44,96,16,60
EX 34
QK 44,100,20,44
KR 116,9,24576
KR 120,10,24576
QK 44,104,24,44
EX 35
QK 44,108,28,44
KR 124,11,24576
CV 49,34,35
PV 224,176,52
EX 36
PV 228,180,52
s_add_u32 m0, s26, 0
KR 128,8,28672
PV 232,184,52
EX 37
PV 236,188,52
KR 132,9,28672
CV 50,36,37
PV 240,192,52
EX 38
PV 244,196,52
KR 136,10,28672
KR 140,11,28672
PV 248,200,52
EX 39
PV 252,204,52
CV 51,38,39
LM 224,52
buffer_load_dwordx4 v20, s[12:15], s28 offen offset:0 nt lds
QK 32,80,32,64
EX 40
QK 32,84,36,32
buffer_load_dwordx4 v21, s[12:15], s28 offen offset:1024 nt lds
QK 32,88,40,32
EX 41
QK 32,92,44,32
VR 176,12,24576
CV 52,40,41
QK 36,96,32,64
EX 42
QK 36,100,36,36
buffer_load_dwordx4 v22, s[12:15], s28 offen offset:2048 nt lds
QK 36,104,40,36
EX 43
QK 36,108,44,36
VR 178,12,28672
CV 53,42,43
s_waitcnt lgkmcnt(10)
PV 96,144,48
EX 44
PV 100,148,48
buffer_load_dwordx4 v23, s[12:15], s28 offen offset:3072 nt lds
PV 104,152,48
EX 45
PV 108,156,48
s_add_u32 s28, s28, 0x40000
CV 54,44,45
PV 112,160,48
EX 46
PV 116,164,48
VR 180,13,24576
VR 182,13,28672
PV 120,168,48
EX 47
PV 124,172,48
VR 184,14,24576
CV 55,46,47
LM 208,48
VR 186,14,28672
VR 188,15,24576
QK 40,80,48,68
EX 32
QK 40,84,52,40
VR 190,15,28672
VR 192,16,24576
QK 40,88,56,40
EX 33
QK 40,92,60,40
VR 194,16,28672
CV 48,32,33
QK 44,96,48,68
EX 34
QK 44,100,52,44
VR 196,17,24576
VR 198,17,28672
QK 44,104,56,44
EX 35
QK 44,108,60,44
VR 200,18,24576
CV 49,34,35
PV 128,144,52
EX 36
PV 132,148,52
VR 202,18,28672
VR 204,19,24576
PV 136,152,52
EX 37
PV 140,156,52
VR 206,19,28672
CV 50,36,37
PV 144,160,52
EX 38
PV 148,164,52
PV 152,168,52
EX 39
PV 156,172,52
CV 51,38,39
LM 212,52
QK 32,80,64,72
EX 40
QK 32,84,68,32
QK 32,88,72,32
EX 41
QK 32,92,76,32
CV 52,40,41
QK 36,96,64,72
EX 42
QK 36,100,68,36
QK 36,104,72,36
EX 43
QK 36,108,76,36
CV 53,42,43
PV 160,144,48
EX 44
PV 164,148,48
PV 168,152,48
EX 45
PV 172,156,48
CV 54,44,45
PV 176,160,48
EX 46
PV 180,164,48
PV 184,168,48
EX 47
PV 188,172,48
CV 55,46,47
LM 216,48
s_waitcnt vmcnt(12) lgkmcnt(15)
s_barrier
v_add_f32 v40, v56, v76
v_add_f32 v41, v56, v77
v_add_f32 v42, v56, v78
v_add_f32 v43, v56, v79
v_add_f32 v44, v56, v80
v_add_f32 v45, v56, v81
v_add_f32 v46, v56, v82
v_add_f32 v47, v56, v83
s_nop 1
QK 40,112,0,40
EX 32
QK 40,116,4,40
KR 80,8,32768
KR 84,9,32768
QK 40,120,8,40
EX 33
QK 40,124,12,40
KR 88,10,32768
CV 48,32,33
QK 44,128,0,44
EX 34
QK 44,132,4,44
KR 92,11,32768
s_add_u32 m0, s27, 0
QK 44,136,8,44
EX 35
QK 44,140,12,44
KR 96,8,36864
CV 49,34,35
PV 192,144,52
EX 36
PV 196,148,52
KR 100,9,36864
KR 104,10,36864
PV 200,152,52
EX 37
PV 204,156,52
KR 108,11,36864
CV 50,36,37
PV 208,160,52
EX 38
PV 212,164,52
buffer_load_dwordx4 v24, s[16:19], s29 offen offset:0 nt lds
PV 216,168,52
EX 39
PV 220,172,52
CV 51,38,39
LM 220,52
buffer_load_dwordx4 v25, s[16:19], s29 offen offset:1024 nt lds
v_add_f32 v32, v60, v76
v_add_f32 v33, v60, v77
v_add_f32 v34, v60, v78
v_add_f32 v35, v60, v79
v_add_f32 v36, v60, v80
v_add_f32 v37, v60, v81
v_add_f32 v38, v60, v82
v_add_f32 v39, v60, v83
s_nop 1
QK 32,112,16,32
EX 40
QK 32,116,20,32
buffer_load_dwordx4 v26, s[16:19], s29 offen offset:2048 nt lds
QK 32,120,24,32
EX 41
QK 32,124,28,32
CV 52,40,41
QK 36,128,16,36
EX 42
QK 36,132,20,36
buffer_load_dwordx4 v27, s[16:19], s29 offen offset:3072 nt lds
QK 36,136,24,36
EX 43
QK 36,140,28,36
s_add_u32 s29, s29, 0x40000
CV 53,42,43
PV 224,144,48
EX 44
PV 228,148,48
PV 232,152,48
EX 45
PV 236,156,48
CV 54,44,45
PV 240,160,48
EX 46
PV 244,164,48
PV 248,168,48
EX 47
PV 252,172,48
CV 55,46,47
LM 224,48
v_add_f32 v40, v64, v76
v_add_f32 v41, v64, v77
v_add_f32 v42, v64, v78
v_add_f32 v43, v64, v79
v_add_f32 v44, v64, v80
v_add_f32 v45, v64, v81
v_add_f32 v46, v64, v82
v_add_f32 v47, v64, v83
s_nop 1
QK 40,112,32,40
EX 32
QK 40,116,36,40
QK 40,120,40,40
EX 33
QK 40,124,44,40
CV 48,32,33
QK 44,128,32,44
EX 34
QK 44,132,36,44
QK 44,136,40,44
EX 35
QK 44,140,44,44
CV 49,34,35
s_waitcnt lgkmcnt(8)
PV 96,176,52
EX 36
PV 100,180,52
PV 104,184,52
EX 37
PV 108,188,52
CV 50,36,37
PV 112,192,52
EX 38
PV 116,196,52
PV 120,200,52
EX 39
PV 124,204,52
CV 51,38,39
LM 208,52
v_add_f32 v32, v68, v76
v_add_f32 v33, v68, v77
v_add_f32 v34, v68, v78
v_add_f32 v35, v68, v79
v_add_f32 v36, v68, v80
v_add_f32 v37, v68, v81
v_add_f32 v38, v68, v82
v_add_f32 v39, v68, v83
s_nop 1
QK 32,112,48,32
EX 40
QK 32,116,52,32
QK 32,120,56,32
EX 41
QK 32,124,60,32
CV 52,40,41
QK 36,128,48,36
EX 42
QK 36,132,52,36
QK 36,136,56,36
EX 43
QK 36,140,60,36
CV 53,42,43
PV 128,176,48
EX 44
PV 132,180,48
PV 136,184,48
EX 45
PV 140,188,48
CV 54,44,45
PV 144,192,48
EX 46
PV 148,196,48
PV 152,200,48
EX 47
PV 156,204,48
CV 55,46,47
LM 212,48
v_add_f32 v40, v72, v76
v_add_f32 v41, v72, v77
v_add_f32 v42, v72, v78
v_add_f32 v43, v72, v79
v_add_f32 v44, v72, v80
v_add_f32 v45, v72, v81
v_add_f32 v46, v72, v82
v_add_f32 v47, v72, v83
s_nop 1
QK 40,112,64,40
EX 32
QK 40,116,68,40
QK 40,120,72,40
EX 33
QK 40,124,76,40
CV 48,32,33
QK 44,128,64,44
EX 34
QK 44,132,68,44
QK 44,136,72,44
EX 35
QK 44,140,76,44
CV 49,34,35
PV 160,176,52
EX 36
PV 164,180,52
PV 168,184,52
EX 37
PV 172,188,52
CV 50,36,37
PV 176,192,52
EX 38
PV 180,196,52
PV 184,200,52
EX 39
PV 188,204,52
CV 51,38,39
LM 216,52
s_waitcnt lgkmcnt(0)
PV 192,176,48
EX 40
PV 196,180,48
EX 41
PV 200,184,48
EX 42
PV 204,188,48
EX 43
PV 208,192,48
EX 44
PV 212,196,48
EX 45
PV 216,200,48
EX 46
PV 220,204,48
EX 47
LM 220,48
CV 52,40,41
CV 53,42,43
CV 54,44,45
CV 55,46,47
s_nop 1
LM 224,52
PV 224,176,52
PV 228,180,52
PV 232,184,52
PV 236,188,52
PV 240,192,52
PV 244,196,52
PV 248,200,52
PV 252,204,52
s_mov_b32 s72, 2
s_branch EPI_V500
TAIL_V500_2:
s_waitcnt lgkmcnt(0)
QK 32,80,0,56
EX 40
QK 32,84,4,32
VR 144,12,32768
VR 146,12,36864
QK 32,88,8,32
EX 41
QK 32,92,12,32
VR 148,13,32768
CV 52,40,41
QK 36,96,0,56
EX 42
QK 36,100,4,36
VR 150,13,36864
VR 152,14,32768
QK 36,104,8,36
EX 43
QK 36,108,12,36
VR 154,14,36864
CV 53,42,43
PV 192,176,48
EX 44
PV 196,180,48
VR 156,15,32768
VR 158,15,36864
PV 200,184,48
EX 45
PV 204,188,48
VR 160,16,32768
CV 54,44,45
PV 208,192,48
EX 46
PV 212,196,48
VR 162,16,36864
VR 164,17,32768
PV 216,200,48
EX 47
PV 220,204,48
VR 166,17,36864
CV 55,46,47
LM 220,48
VR 168,18,32768
VR 170,18,36864
QK 40,80,16,60
EX 32
QK 40,84,20,40
VR 172,19,32768
VR 174,19,36864
QK 40,88,24,40
EX 33
QK 40,92,28,40
KR 112,8,40960
CV 48,32,33
QK 44,96,16,60
EX 34
QK 44,100,20,44
KR 116,9,40960
KR 120,10,40960
QK 44,104,24,44
EX 35
QK 44,108,28,44
KR 124,11,40960
CV 49,34,35
PV 224,176,52
EX 36
PV 228,180,52
s_add_u32 m0, s26, 16384
KR 128,8,45056
PV 232,184,52
EX 37
PV 236,188,52
KR 132,9,45056
CV 50,36,37
PV 240,192,52
EX 38
PV 244,196,52
KR 136,10,45056
KR 140,11,45056
PV 248,200,52
EX 39
PV 252,204,52
CV 51,38,39
LM 224,52
buffer_load_dwordx4 v20, s[12:15], s28 offen offset:0 nt lds
QK 32,80,32,64
EX 40
QK 32,84,36,32
buffer_load_dwordx4 v21, s[12:15], s28 offen offset:1024 nt lds
QK 32,88,40,32
EX 41
QK 32,92,44,32
VR 176,12,40960
CV 52,40,41
QK 36,96,32,64
EX 42
QK 36,100,36,36
buffer_load_dwordx4 v22, s[12:15], s28 offen offset:2048 nt lds
QK 36,104,40,36
EX 43
QK 36,108,44,36
VR 178,12,45056
CV 53,42,43
s_waitcnt lgkmcnt(10)
PV 96,144,48
EX 44
PV 100,148,48
buffer_load_dwordx4 v23, s[12:15], s28 offen offset:3072 nt lds
PV 104,152,48
EX 45
PV 108,156,48
s_add_u32 s28, s28, 0x40000
CV 54,44,45
PV 112,160,48
EX 46
PV 116,164,48
VR 180,13,40960
VR 182,13,45056
PV 120,168,48
EX 47
PV 124,172,48
VR 184,14,40960
CV 55,46,47
LM 208,48
VR 186,14,45056
VR 188,15,40960
QK 40,80,48,68
EX 32
QK 40,84,52,40
VR 190,15,45056
VR 192,16,40960
QK 40,88,56,40
EX 33
QK 40,92,60,40
VR 194,16,45056
CV 48,32,33
QK 44,96,48,68
EX 34
QK 44,100,52,44
VR 196,17,40960
VR 198,17,45056
QK 44,104,56,44
EX 35
QK 44,108,60,44
VR 200,18,40960
CV 49,34,35
PV 128,144,52
EX 36
PV 132,148,52
VR 202,18,45056
VR 204,19,40960
PV 136,152,52
EX 37
PV 140,156,52
VR 206,19,45056
CV 50,36,37
PV 144,160,52
EX 38
PV 148,164,52
PV 152,168,52
EX 39
PV 156,172,52
CV 51,38,39
LM 212,52
QK 32,80,64,72
EX 40
QK 32,84,68,32
QK 32,88,72,32
EX 41
QK 32,92,76,32
CV 52,40,41
QK 36,96,64,72
EX 42
QK 36,100,68,36
QK 36,104,72,36
EX 43
QK 36,108,76,36
CV 53,42,43
PV 160,144,48
EX 44
PV 164,148,48
PV 168,152,48
EX 45
PV 172,156,48
CV 54,44,45
PV 176,160,48
EX 46
PV 180,164,48
PV 184,168,48
EX 47
PV 188,172,48
CV 55,46,47
LM 216,48
s_waitcnt vmcnt(12) lgkmcnt(15)
s_barrier
v_add_f32 v40, v56, v76
v_add_f32 v41, v56, v77
v_add_f32 v42, v56, v78
v_add_f32 v43, v56, v79
v_add_f32 v44, v56, v80
v_add_f32 v45, v56, v81
v_add_f32 v46, v56, v82
v_add_f32 v47, v56, v83
s_nop 1
QK 40,112,0,40
EX 32
QK 40,116,4,40
KR 80,8,49152
KR 84,9,49152
QK 40,120,8,40
EX 33
QK 40,124,12,40
KR 88,10,49152
CV 48,32,33
QK 44,128,0,44
EX 34
QK 44,132,4,44
KR 92,11,49152
s_add_u32 m0, s27, 16384
QK 44,136,8,44
EX 35
QK 44,140,12,44
KR 96,8,53248
CV 49,34,35
PV 192,144,52
EX 36
PV 196,148,52
KR 100,9,53248
KR 104,10,53248
PV 200,152,52
EX 37
PV 204,156,52
KR 108,11,53248
CV 50,36,37
PV 208,160,52
EX 38
PV 212,164,52
buffer_load_dwordx4 v24, s[16:19], s29 offen offset:0 nt lds
PV 216,168,52
EX 39
PV 220,172,52
CV 51,38,39
LM 220,52
buffer_load_dwordx4 v25, s[16:19], s29 offen offset:1024 nt lds
v_add_f32 v32, v60, v76
v_add_f32 v33, v60, v77
v_add_f32 v34, v60, v78
v_add_f32 v35, v60, v79
v_add_f32 v36, v60, v80
v_add_f32 v37, v60, v81
v_add_f32 v38, v60, v82
v_add_f32 v39, v60, v83
s_nop 1
QK 32,112,16,32
EX 40
QK 32,116,20,32
buffer_load_dwordx4 v26, s[16:19], s29 offen offset:2048 nt lds
QK 32,120,24,32
EX 41
QK 32,124,28,32
CV 52,40,41
QK 36,128,16,36
EX 42
QK 36,132,20,36
buffer_load_dwordx4 v27, s[16:19], s29 offen offset:3072 nt lds
QK 36,136,24,36
EX 43
QK 36,140,28,36
s_add_u32 s29, s29, 0x40000
CV 53,42,43
PV 224,144,48
EX 44
PV 228,148,48
PV 232,152,48
EX 45
PV 236,156,48
CV 54,44,45
PV 240,160,48
EX 46
PV 244,164,48
PV 248,168,48
EX 47
PV 252,172,48
CV 55,46,47
LM 224,48
v_add_f32 v40, v64, v76
v_add_f32 v41, v64, v77
v_add_f32 v42, v64, v78
v_add_f32 v43, v64, v79
v_add_f32 v44, v64, v80
v_add_f32 v45, v64, v81
v_add_f32 v46, v64, v82
v_add_f32 v47, v64, v83
s_nop 1
QK 40,112,32,40
EX 32
QK 40,116,36,40
QK 40,120,40,40
EX 33
QK 40,124,44,40
CV 48,32,33
QK 44,128,32,44
EX 34
QK 44,132,36,44
QK 44,136,40,44
EX 35
QK 44,140,44,44
CV 49,34,35
s_waitcnt lgkmcnt(8)
PV 96,176,52
EX 36
PV 100,180,52
PV 104,184,52
EX 37
PV 108,188,52
CV 50,36,37
PV 112,192,52
EX 38
PV 116,196,52
PV 120,200,52
EX 39
PV 124,204,52
CV 51,38,39
LM 208,52
v_add_f32 v32, v68, v76
v_add_f32 v33, v68, v77
v_add_f32 v34, v68, v78
v_add_f32 v35, v68, v79
v_add_f32 v36, v68, v80
v_add_f32 v37, v68, v81
v_add_f32 v38, v68, v82
v_add_f32 v39, v68, v83
s_nop 1
QK 32,112,48,32
EX 40
QK 32,116,52,32
QK 32,120,56,32
EX 41
QK 32,124,60,32
CV 52,40,41
QK 36,128,48,36
EX 42
QK 36,132,52,36
QK 36,136,56,36
EX 43
QK 36,140,60,36
CV 53,42,43
PV 128,176,48
EX 44
PV 132,180,48
PV 136,184,48
EX 45
PV 140,188,48
CV 54,44,45
PV 144,192,48
EX 46
PV 148,196,48
PV 152,200,48
EX 47
PV 156,204,48
CV 55,46,47
LM 212,48
v_add_f32 v40, v72, v76
v_add_f32 v41, v72, v77
v_add_f32 v42, v72, v78
v_add_f32 v43, v72, v79
v_add_f32 v44, v72, v80
v_add_f32 v45, v72, v81
v_add_f32 v46, v72, v82
v_add_f32 v47, v72, v83
s_nop 1
QK 40,112,64,40
EX 32
QK 40,116,68,40
QK 40,120,72,40
EX 33
QK 40,124,76,40
CV 48,32,33
QK 44,128,64,44
EX 34
QK 44,132,68,44
QK 44,136,72,44
EX 35
QK 44,140,76,44
CV 49,34,35
PV 160,176,52
EX 36
PV 164,180,52
PV 168,184,52
EX 37
PV 172,188,52
CV 50,36,37
PV 176,192,52
EX 38
PV 180,196,52
PV 184,200,52
EX 39
PV 188,204,52
CV 51,38,39
LM 216,52
s_waitcnt lgkmcnt(0)
PV 192,176,48
EX 40
PV 196,180,48
EX 41
PV 200,184,48
EX 42
PV 204,188,48
EX 43
PV 208,192,48
EX 44
PV 212,196,48
EX 45
PV 216,200,48
EX 46
PV 220,204,48
EX 47
LM 220,48
CV 52,40,41
CV 53,42,43
CV 54,44,45
CV 55,46,47
s_nop 1
LM 224,52
PV 224,176,52
PV 228,180,52
PV 232,184,52
PV 236,188,52
PV 240,192,52
PV 244,196,52
PV 248,200,52
PV 252,204,52
s_mov_b32 s72, 3
s_branch EPI_V500
TAIL_V500_3:
s_waitcnt lgkmcnt(0)
QK 32,80,0,56
EX 40
QK 32,84,4,32
VR 144,12,49152
VR 146,12,53248
QK 32,88,8,32
EX 41
QK 32,92,12,32
VR 148,13,49152
CV 52,40,41
QK 36,96,0,56
EX 42
QK 36,100,4,36
VR 150,13,53248
VR 152,14,49152
QK 36,104,8,36
EX 43
QK 36,108,12,36
VR 154,14,53248
CV 53,42,43
PV 192,176,48
EX 44
PV 196,180,48
VR 156,15,49152
VR 158,15,53248
PV 200,184,48
EX 45
PV 204,188,48
VR 160,16,49152
CV 54,44,45
PV 208,192,48
EX 46
PV 212,196,48
VR 162,16,53248
VR 164,17,49152
PV 216,200,48
EX 47
PV 220,204,48
VR 166,17,53248
CV 55,46,47
LM 220,48
VR 168,18,49152
VR 170,18,53248
QK 40,80,16,60
EX 32
QK 40,84,20,40
VR 172,19,49152
VR 174,19,53248
QK 40,88,24,40
EX 33
QK 40,92,28,40
KR 112,8,57344
CV 48,32,33
QK 44,96,16,60
EX 34
QK 44,100,20,44
KR 116,9,57344
KR 120,10,57344
QK 44,104,24,44
EX 35
QK 44,108,28,44
KR 124,11,57344
CV 49,34,35
PV 224,176,52
EX 36
PV 228,180,52
s_add_u32 m0, s26, 32768
KR 128,8,61440
PV 232,184,52
EX 37
PV 236,188,52
KR 132,9,61440
CV 50,36,37
PV 240,192,52
EX 38
PV 244,196,52
KR 136,10,61440
KR 140,11,61440
PV 248,200,52
EX 39
PV 252,204,52
CV 51,38,39
LM 224,52
buffer_load_dwordx4 v20, s[12:15], s28 offen offset:0 nt lds
QK 32,80,32,64
EX 40
QK 32,84,36,32
buffer_load_dwordx4 v21, s[12:15], s28 offen offset:1024 nt lds
QK 32,88,40,32
EX 41
QK 32,92,44,32
VR 176,12,57344
CV 52,40,41
QK 36,96,32,64
EX 42
QK 36,100,36,36
buffer_load_dwordx4 v22, s[12:15], s28 offen offset:2048 nt lds
QK 36,104,40,36
EX 43
QK 36,108,44,36
VR 178,12,61440
CV 53,42,43
s_waitcnt lgkmcnt(10)
PV 96,144,48
EX 44
PV 100,148,48
buffer_load_dwordx4 v23, s[12:15], s28 offen offset:3072 nt lds
PV 104,152,48
EX 45
PV 108,156,48
s_add_u32 s28, s28, 0x40000
CV 54,44,45
PV 112,160,48
EX 46
PV 116,164,48
VR 180,13,57344
VR 182,13,61440
PV 120,168,48
EX 47
PV 124,172,48
VR 184,14,57344
CV 55,46,47
LM 208,48
VR 186,14,61440
VR 188,15,57344
QK 40,80,48,68
EX 32
QK 40,84,52,40
VR 190,15,61440
VR 192,16,57344
QK 40,88,56,40
EX 33
QK 40,92,60,40
VR 194,16,61440
CV 48,32,33
QK 44,96,48,68
EX 34
QK 44,100,52,44
VR 196,17,57344
VR 198,17,61440
QK 44,104,56,44
EX 35
QK 44,108,60,44
VR 200,18,57344
CV 49,34,35
PV 128,144,52
EX 36
PV 132,148,52
VR 202,18,61440
VR 204,19,57344
PV 136,152,52
EX 37
PV 140,156,52
VR 206,19,61440
CV 50,36,37
PV 144,160,52
EX 38
PV 148,164,52
PV 152,168,52
EX 39
PV 156,172,52
CV 51,38,39
LM 212,52
QK 32,80,64,72
EX 40
QK 32,84,68,32
QK 32,88,72,32
EX 41
QK 32,92,76,32
CV 52,40,41
QK 36,96,64,72
EX 42
QK 36,100,68,36
QK 36,104,72,36
EX 43
QK 36,108,76,36
CV 53,42,43
PV 160,144,48
EX 44
PV 164,148,48
PV 168,152,48
EX 45
PV 172,156,48
CV 54,44,45
PV 176,160,48
EX 46
PV 180,164,48
PV 184,168,48
EX 47
PV 188,172,48
CV 55,46,47
LM 216,48
s_waitcnt vmcnt(12) lgkmcnt(15)
s_barrier
v_add_f32 v40, v56, v76
v_add_f32 v41, v56, v77
v_add_f32 v42, v56, v78
v_add_f32 v43, v56, v79
v_add_f32 v44, v56, v80
v_add_f32 v45, v56, v81
v_add_f32 v46, v56, v82
v_add_f32 v47, v56, v83
s_nop 1
QK 40,112,0,40
EX 32
QK 40,116,4,40
KR 80,8,0
KR 84,9,0
QK 40,120,8,40
EX 33
QK 40,124,12,40
KR 88,10,0
CV 48,32,33
QK 44,128,0,44
EX 34
QK 44,132,4,44
KR 92,11,0
s_add_u32 m0, s27, 32768
QK 44,136,8,44
EX 35
QK 44,140,12,44
KR 96,8,4096
CV 49,34,35
PV 192,144,52
EX 36
PV 196,148,52
KR 100,9,4096
KR 104,10,4096
PV 200,152,52
EX 37
PV 204,156,52
KR 108,11,4096
CV 50,36,37
PV 208,160,52
EX 38
PV 212,164,52
buffer_load_dwordx4 v24, s[16:19], s29 offen offset:0 nt lds
PV 216,168,52
EX 39
PV 220,172,52
CV 51,38,39
LM 220,52
buffer_load_dwordx4 v25, s[16:19], s29 offen offset:1024 nt lds
v_add_f32 v32, v60, v76
v_add_f32 v33, v60, v77
v_add_f32 v34, v60, v78
v_add_f32 v35, v60, v79
v_add_f32 v36, v60, v80
v_add_f32 v37, v60, v81
v_add_f32 v38, v60, v82
v_add_f32 v39, v60, v83
s_nop 1
QK 32,112,16,32
EX 40
QK 32,116,20,32
buffer_load_dwordx4 v26, s[16:19], s29 offen offset:2048 nt lds
QK 32,120,24,32
EX 41
QK 32,124,28,32
CV 52,40,41
QK 36,128,16,36
EX 42
QK 36,132,20,36
buffer_load_dwordx4 v27, s[16:19], s29 offen offset:3072 nt lds
QK 36,136,24,36
EX 43
QK 36,140,28,36
s_add_u32 s29, s29, 0x40000
CV 53,42,43
PV 224,144,48
EX 44
PV 228,148,48
PV 232,152,48
EX 45
PV 236,156,48
CV 54,44,45
PV 240,160,48
EX 46
PV 244,164,48
PV 248,168,48
EX 47
PV 252,172,48
CV 55,46,47
LM 224,48
v_add_f32 v40, v64, v76
v_add_f32 v41, v64, v77
v_add_f32 v42, v64, v78
v_add_f32 v43, v64, v79
v_add_f32 v44, v64, v80
v_add_f32 v45, v64, v81
v_add_f32 v46, v64, v82
v_add_f32 v47, v64, v83
s_nop 1
QK 40,112,32,40
EX 32
QK 40,116,36,40
QK 40,120,40,40
EX 33
QK 40,124,44,40
CV 48,32,33
QK 44,128,32,44
EX 34
QK 44,132,36,44
QK 44,136,40,44
EX 35
QK 44,140,44,44
CV 49,34,35
s_waitcnt lgkmcnt(8)
PV 96,176,52
EX 36
PV 100,180,52
PV 104,184,52
EX 37
PV 108,188,52
CV 50,36,37
PV 112,192,52
EX 38
PV 116,196,52
PV 120,200,52
EX 39
PV 124,204,52
CV 51,38,39
LM 208,52
v_add_f32 v32, v68, v76
v_add_f32 v33, v68, v77
v_add_f32 v34, v68, v78
v_add_f32 v35, v68, v79
v_add_f32 v36, v68, v80
v_add_f32 v37, v68, v81
v_add_f32 v38, v68, v82
v_add_f32 v39, v68, v83
s_nop 1
QK 32,112,48,32
EX 40
QK 32,116,52,32
QK 32,120,56,32
EX 41
QK 32,124,60,32
CV 52,40,41
QK 36,128,48,36
EX 42
QK 36,132,52,36
QK 36,136,56,36
EX 43
QK 36,140,60,36
CV 53,42,43
PV 128,176,48
EX 44
PV 132,180,48
PV 136,184,48
EX 45
PV 140,188,48
CV 54,44,45
PV 144,192,48
EX 46
PV 148,196,48
PV 152,200,48
EX 47
PV 156,204,48
CV 55,46,47
LM 212,48
v_add_f32 v40, v72, v76
v_add_f32 v41, v72, v77
v_add_f32 v42, v72, v78
v_add_f32 v43, v72, v79
v_add_f32 v44, v72, v80
v_add_f32 v45, v72, v81
v_add_f32 v46, v72, v82
v_add_f32 v47, v72, v83
s_nop 1
QK 40,112,64,40
EX 32
QK 40,116,68,40
QK 40,120,72,40
EX 33
QK 40,124,76,40
CV 48,32,33
QK 44,128,64,44
EX 34
QK 44,132,68,44
QK 44,136,72,44
EX 35
QK 44,140,76,44
CV 49,34,35
PV 160,176,52
EX 36
PV 164,180,52
PV 168,184,52
EX 37
PV 172,188,52
CV 50,36,37
PV 176,192,52
EX 38
PV 180,196,52
PV 184,200,52
EX 39
PV 188,204,52
CV 51,38,39
LM 216,52
s_waitcnt lgkmcnt(0)
PV 192,176,48
EX 40
PV 196,180,48
EX 41
PV 200,184,48
EX 42
PV 204,188,48
EX 43
PV 208,192,48
EX 44
PV 212,196,48
EX 45
PV 216,200,48
EX 46
PV 220,204,48
EX 47
LM 220,48
CV 52,40,41
CV 53,42,43
CV 54,44,45
CV 55,46,47
s_nop 1
LM 224,52
PV 224,176,52
PV 228,180,52
PV 232,184,52
PV 236,188,52
PV 240,192,52
PV 244,196,52
PV 248,200,52
PV 252,204,52
s_mov_b32 s72, 0
EPI_V500:
s_add_u32 s88, s40, 135424
v_mov_b32 v42, s88
v_add_u32 v44, s40, v4
v_add_u32 v45, s40, v3
v_add_u32 v46, s40, v1
v_accvgpr_read_b32 v50, a208
v_accvgpr_read_b32 v51, a212
v_accvgpr_read_b32 v52, a216
v_accvgpr_read_b32 v53, a220
v_accvgpr_read_b32 v54, a224
v_cmp_nge_f32 s[78:79], s76, v50
v_cmp_nge_f32 s[80:81], s76, v51
v_cmp_nge_f32 s[82:83], s76, v52
v_cmp_nge_f32 s[84:85], s76, v53
v_cmp_nge_f32 s[86:87], s76, v54
v_rcp_f32 v32, v50
v_rcp_f32 v34, v51
v_rcp_f32 v36, v52
v_rcp_f32 v38, v53
v_rcp_f32 v40, v54
s_or_b64 s[78:79], s[78:79], s[80:81]
s_or_b64 s[78:79], s[78:79], s[82:83]
s_or_b64 s[78:79], s[78:79], s[84:85]
s_or_b64 s[78:79], s[78:79], s[86:87]
s_cmp_lg_u64 s[78:79], 0
s_cselect_b32 s90, 1, 0
v_mov_b32 v43, s90
ds_write_b32 v42, v43
s_nop 3
v_pk_mul_f32 v[96:97], v[96:97], v[32:33] op_sel_hi:[1,0]
v_pk_mul_f32 v[98:99], v[98:99], v[32:33] op_sel_hi:[1,0]
CV 96,96,97
CV 97,98,99
v_pk_mul_f32 v[100:101], v[100:101], v[32:33] op_sel_hi:[1,0]
v_pk_mul_f32 v[102:103], v[102:103], v[32:33] op_sel_hi:[1,0]
CV 100,100,101
CV 101,102,103
v_pk_mul_f32 v[104:105], v[104:105], v[32:33] op_sel_hi:[1,0]
v_pk_mul_f32 v[106:107], v[106:107], v[32:33] op_sel_hi:[1,0]
CV 104,104,105
CV 105,106,107
v_pk_mul_f32 v[108:109], v[108:109], v[32:33] op_sel_hi:[1,0]
v_pk_mul_f32 v[110:111], v[110:111], v[32:33] op_sel_hi:[1,0]
CV 108,108,109
CV 109,110,111
v_pk_mul_f32 v[112:113], v[112:113], v[32:33] op_sel_hi:[1,0]
v_pk_mul_f32 v[114:115], v[114:115], v[32:33] op_sel_hi:[1,0]
CV 112,112,113
CV 113,114,115
v_pk_mul_f32 v[116:117], v[116:117], v[32:33] op_sel_hi:[1,0]
v_pk_mul_f32 v[118:119], v[118:119], v[32:33] op_sel_hi:[1,0]
CV 116,116,117
CV 117,118,119
v_pk_mul_f32 v[120:121], v[120:121], v[32:33] op_sel_hi:[1,0]
v_pk_mul_f32 v[122:123], v[122:123], v[32:33] op_sel_hi:[1,0]
CV 120,120,121
CV 121,122,123
v_pk_mul_f32 v[124:125], v[124:125], v[32:33] op_sel_hi:[1,0]
v_pk_mul_f32 v[126:127], v[126:127], v[32:33] op_sel_hi:[1,0]
CV 124,124,125
CV 125,126,127
ds_write_b64 v44, v[96:97] offset:0
ds_write_b64 v44, v[100:101] offset:32
ds_write_b64 v44, v[104:105] offset:64
ds_write_b64 v44, v[108:109] offset:96
ds_write_b64 v44, v[112:113] offset:128
ds_write_b64 v44, v[116:117] offset:160
ds_write_b64 v44, v[120:121] offset:192
ds_write_b64 v44, v[124:125] offset:224
v_pk_mul_f32 v[128:129], v[128:129], v[34:35] op_sel_hi:[1,0]
v_pk_mul_f32 v[130:131], v[130:131], v[34:35] op_sel_hi:[1,0]
CV 128,128,129
CV 129,130,131
v_pk_mul_f32 v[132:133], v[132:133], v[34:35] op_sel_hi:[1,0]
v_pk_mul_f32 v[134:135], v[134:135], v[34:35] op_sel_hi:[1,0]
CV 132,132,133
CV 133,134,135
v_pk_mul_f32 v[136:137], v[136:137], v[34:35] op_sel_hi:[1,0]
v_pk_mul_f32 v[138:139], v[138:139], v[34:35] op_sel_hi:[1,0]
CV 136,136,137
CV 137,138,139
v_pk_mul_f32 v[140:141], v[140:141], v[34:35] op_sel_hi:[1,0]
v_pk_mul_f32 v[142:143], v[142:143], v[34:35] op_sel_hi:[1,0]
CV 140,140,141
CV 141,142,143
v_pk_mul_f32 v[144:145], v[144:145], v[34:35] op_sel_hi:[1,0]
v_pk_mul_f32 v[146:147], v[146:147], v[34:35] op_sel_hi:[1,0]
CV 144,144,145
CV 145,146,147
v_pk_mul_f32 v[148:149], v[148:149], v[34:35] op_sel_hi:[1,0]
v_pk_mul_f32 v[150:151], v[150:151], v[34:35] op_sel_hi:[1,0]
CV 148,148,149
CV 149,150,151
v_pk_mul_f32 v[152:153], v[152:153], v[34:35] op_sel_hi:[1,0]
v_pk_mul_f32 v[154:155], v[154:155], v[34:35] op_sel_hi:[1,0]
CV 152,152,153
CV 153,154,155
v_pk_mul_f32 v[156:157], v[156:157], v[34:35] op_sel_hi:[1,0]
v_pk_mul_f32 v[158:159], v[158:159], v[34:35] op_sel_hi:[1,0]
CV 156,156,157
CV 157,158,159
v_pk_mul_f32 v[160:161], v[160:161], v[36:37] op_sel_hi:[1,0]
v_pk_mul_f32 v[162:163], v[162:163], v[36:37] op_sel_hi:[1,0]
CV 160,160,161
CV 161,162,163
v_pk_mul_f32 v[164:165], v[164:165], v[36:37] op_sel_hi:[1,0]
v_pk_mul_f32 v[166:167], v[166:167], v[36:37] op_sel_hi:[1,0]
CV 164,164,165
CV 165,166,167
v_pk_mul_f32 v[168:169], v[168:169], v[36:37] op_sel_hi:[1,0]
v_pk_mul_f32 v[170:171], v[170:171], v[36:37] op_sel_hi:[1,0]
CV 168,168,169
CV 169,170,171
v_pk_mul_f32 v[172:173], v[172:173], v[36:37] op_sel_hi:[1,0]
v_pk_mul_f32 v[174:175], v[174:175], v[36:37] op_sel_hi:[1,0]
CV 172,172,173
CV 173,174,175
v_pk_mul_f32 v[176:177], v[176:177], v[36:37] op_sel_hi:[1,0]
v_pk_mul_f32 v[178:179], v[178:179], v[36:37] op_sel_hi:[1,0]
CV 176,176,177
CV 177,178,179
v_pk_mul_f32 v[180:181], v[180:181], v[36:37] op_sel_hi:[1,0]
v_pk_mul_f32 v[182:183], v[182:183], v[36:37] op_sel_hi:[1,0]
CV 180,180,181
CV 181,182,183
v_pk_mul_f32 v[184:185], v[184:185], v[36:37] op_sel_hi:[1,0]
v_pk_mul_f32 v[186:187], v[186:187], v[36:37] op_sel_hi:[1,0]
CV 184,184,185
CV 185,186,187
v_pk_mul_f32 v[188:189], v[188:189], v[36:37] op_sel_hi:[1,0]
v_pk_mul_f32 v[190:191], v[190:191], v[36:37] op_sel_hi:[1,0]
CV 188,188,189
CV 189,190,191
s_waitcnt lgkmcnt(0)
ds_read_b128 v[112:115], v45 offset:0
ds_read_b128 v[116:119], v45 offset:1088
ds_read_b128 v[120:123], v45 offset:2176
ds_read_b128 v[124:127], v45 offset:3264
s_waitcnt lgkmcnt(0)
ds_write_b64 v44, v[128:129] offset:0
ds_write_b64 v44, v[132:133] offset:32
ds_write_b64 v44, v[136:137] offset:64
ds_write_b64 v44, v[140:141] offset:96
ds_write_b64 v44, v[144:145] offset:128
ds_write_b64 v44, v[148:149] offset:160
ds_write_b64 v44, v[152:153] offset:192
ds_write_b64 v44, v[156:157] offset:224
s_add_u32 s87, s49, 0
buffer_store_dwordx4 v[112:115], v29, s[20:23], s87 offen sc1
s_add_u32 s87, s49, 16384
buffer_store_dwordx4 v[116:119], v29, s[20:23], s87 offen sc1
s_add_u32 s87, s49, 32768
buffer_store_dwordx4 v[120:123], v29, s[20:23], s87 offen sc1
s_add_u32 s87, s49, 49152
buffer_store_dwordx4 v[124:127], v29, s[20:23], s87 offen sc1
v_pk_mul_f32 v[192:193], v[192:193], v[38:39] op_sel_hi:[1,0]
v_pk_mul_f32 v[194:195], v[194:195], v[38:39] op_sel_hi:[1,0]
CV 192,192,193
CV 193,194,195
v_pk_mul_f32 v[196:197], v[196:197], v[38:39] op_sel_hi:[1,0]
v_pk_mul_f32 v[198:199], v[198:199], v[38:39] op_sel_hi:[1,0]
CV 196,196,197
CV 197,198,199
v_pk_mul_f32 v[200:201], v[200:201], v[38:39] op_sel_hi:[1,0]
v_pk_mul_f32 v[202:203], v[202:203], v[38:39] op_sel_hi:[1,0]
CV 200,200,201
CV 201,202,203
v_pk_mul_f32 v[204:205], v[204:205], v[38:39] op_sel_hi:[1,0]
v_pk_mul_f32 v[206:207], v[206:207], v[38:39] op_sel_hi:[1,0]
CV 204,204,205
CV 205,206,207
v_pk_mul_f32 v[208:209], v[208:209], v[38:39] op_sel_hi:[1,0]
v_pk_mul_f32 v[210:211], v[210:211], v[38:39] op_sel_hi:[1,0]
CV 208,208,209
CV 209,210,211
v_pk_mul_f32 v[212:213], v[212:213], v[38:39] op_sel_hi:[1,0]
v_pk_mul_f32 v[214:215], v[214:215], v[38:39] op_sel_hi:[1,0]
CV 212,212,213
CV 213,214,215
v_pk_mul_f32 v[216:217], v[216:217], v[38:39] op_sel_hi:[1,0]
v_pk_mul_f32 v[218:219], v[218:219], v[38:39] op_sel_hi:[1,0]
CV 216,216,217
CV 217,218,219
v_pk_mul_f32 v[220:221], v[220:221], v[38:39] op_sel_hi:[1,0]
v_pk_mul_f32 v[222:223], v[222:223], v[38:39] op_sel_hi:[1,0]
CV 220,220,221
CV 221,222,223
s_waitcnt lgkmcnt(0)
ds_read_b128 v[144:147], v45 offset:0
ds_read_b128 v[148:151], v45 offset:1088
ds_read_b128 v[152:155], v45 offset:2176
ds_read_b128 v[156:159], v45 offset:3264
s_waitcnt lgkmcnt(0)
ds_write_b64 v44, v[160:161] offset:0
ds_write_b64 v44, v[164:165] offset:32
ds_write_b64 v44, v[168:169] offset:64
ds_write_b64 v44, v[172:173] offset:96
ds_write_b64 v44, v[176:177] offset:128
ds_write_b64 v44, v[180:181] offset:160
ds_write_b64 v44, v[184:185] offset:192
ds_write_b64 v44, v[188:189] offset:224
s_add_u32 s87, s50, 0
buffer_store_dwordx4 v[144:147], v29, s[20:23], s87 offen sc1
s_add_u32 s87, s50, 16384
buffer_store_dwordx4 v[148:151], v29, s[20:23], s87 offen sc1
s_add_u32 s87, s50, 32768
buffer_store_dwordx4 v[152:155], v29, s[20:23], s87 offen sc1
s_add_u32 s87, s50, 49152
buffer_store_dwordx4 v[156:159], v29, s[20:23], s87 offen sc1
v_pk_mul_f32 v[224:225], v[224:225], v[40:41] op_sel_hi:[1,0]
v_pk_mul_f32 v[226:227], v[226:227], v[40:41] op_sel_hi:[1,0]
CV 224,224,225
CV 225,226,227
v_pk_mul_f32 v[228:229], v[228:229], v[40:41] op_sel_hi:[1,0]
v_pk_mul_f32 v[230:231], v[230:231], v[40:41] op_sel_hi:[1,0]
CV 228,228,229
CV 229,230,231
v_pk_mul_f32 v[232:233], v[232:233], v[40:41] op_sel_hi:[1,0]
v_pk_mul_f32 v[234:235], v[234:235], v[40:41] op_sel_hi:[1,0]
CV 232,232,233
CV 233,234,235
v_pk_mul_f32 v[236:237], v[236:237], v[40:41] op_sel_hi:[1,0]
v_pk_mul_f32 v[238:239], v[238:239], v[40:41] op_sel_hi:[1,0]
CV 236,236,237
CV 237,238,239
v_pk_mul_f32 v[240:241], v[240:241], v[40:41] op_sel_hi:[1,0]
v_pk_mul_f32 v[242:243], v[242:243], v[40:41] op_sel_hi:[1,0]
CV 240,240,241
CV 241,242,243
v_pk_mul_f32 v[244:245], v[244:245], v[40:41] op_sel_hi:[1,0]
v_pk_mul_f32 v[246:247], v[246:247], v[40:41] op_sel_hi:[1,0]
CV 244,244,245
CV 245,246,247
v_pk_mul_f32 v[248:249], v[248:249], v[40:41] op_sel_hi:[1,0]
v_pk_mul_f32 v[250:251], v[250:251], v[40:41] op_sel_hi:[1,0]
CV 248,248,249
CV 249,250,251
v_pk_mul_f32 v[252:253], v[252:253], v[40:41] op_sel_hi:[1,0]
v_pk_mul_f32 v[254:255], v[254:255], v[40:41] op_sel_hi:[1,0]
CV 252,252,253
CV 253,254,255
s_waitcnt lgkmcnt(0)
ds_read_b128 v[176:179], v45 offset:0
ds_read_b128 v[180:183], v45 offset:1088
ds_read_b128 v[184:187], v45 offset:2176
ds_read_b128 v[188:191], v45 offset:3264
s_waitcnt lgkmcnt(0)
ds_write_b64 v44, v[192:193] offset:0
ds_write_b64 v44, v[196:197] offset:32
ds_write_b64 v44, v[200:201] offset:64
ds_write_b64 v44, v[204:205] offset:96
ds_write_b64 v44, v[208:209] offset:128
ds_write_b64 v44, v[212:213] offset:160
ds_write_b64 v44, v[216:217] offset:192
ds_write_b64 v44, v[220:221] offset:224
s_add_u32 s87, s51, 0
buffer_store_dwordx4 v[176:179], v29, s[20:23], s87 offen sc1
s_add_u32 s87, s51, 16384
buffer_store_dwordx4 v[180:183], v29, s[20:23], s87 offen sc1
s_add_u32 s87, s51, 32768
buffer_store_dwordx4 v[184:187], v29, s[20:23], s87 offen sc1
s_add_u32 s87, s51, 49152
buffer_store_dwordx4 v[188:191], v29, s[20:23], s87 offen sc1
s_waitcnt lgkmcnt(0)
ds_read_b128 v[208:211], v45 offset:0
ds_read_b128 v[212:215], v45 offset:1088
ds_read_b128 v[216:219], v45 offset:2176
ds_read_b128 v[220:223], v45 offset:3264
s_waitcnt lgkmcnt(0)
ds_write_b64 v44, v[224:225] offset:0
ds_write_b64 v44, v[228:229] offset:32
ds_write_b64 v44, v[232:233] offset:64
ds_write_b64 v44, v[236:237] offset:96
ds_write_b64 v44, v[240:241] offset:128
ds_write_b64 v44, v[244:245] offset:160
ds_write_b64 v44, v[248:249] offset:192
ds_write_b64 v44, v[252:253] offset:224
s_add_u32 s87, s52, 0
buffer_store_dwordx4 v[208:211], v29, s[20:23], s87 offen sc1
s_add_u32 s87, s52, 16384
buffer_store_dwordx4 v[212:215], v29, s[20:23], s87 offen sc1
s_add_u32 s87, s52, 32768
buffer_store_dwordx4 v[216:219], v29, s[20:23], s87 offen sc1
s_add_u32 s87, s52, 49152
buffer_store_dwordx4 v[220:223], v29, s[20:23], s87 offen sc1
s_waitcnt lgkmcnt(0)
ds_read_b128 v[240:243], v45 offset:0
ds_read_b128 v[244:247], v45 offset:1088
ds_read_b128 v[248:251], v45 offset:2176
ds_read_b128 v[252:255], v45 offset:3264
s_waitcnt lgkmcnt(0)
s_add_u32 s87, s53, 0
buffer_store_dwordx4 v[240:243], v29, s[20:23], s87 offen sc1
s_add_u32 s87, s53, 16384
buffer_store_dwordx4 v[244:247], v29, s[20:23], s87 offen sc1
s_add_u32 s87, s53, 32768
buffer_store_dwordx4 v[248:251], v29, s[20:23], s87 offen sc1
s_add_u32 s87, s53, 49152
buffer_store_dwordx4 v[252:255], v29, s[20:23], s87 offen sc1
s_barrier
ds_read_b32 v43, v28
s_waitcnt lgkmcnt(0)
v_cmp_ne_u32 s[86:87], 0, v43
s_nop 3
s_cmp_lg_u64 s[86:87], 0
s_cselect_b32 s86, 1, 0
s_andn2_b32 s86, s86, s73
s_cmp_lg_u32 s86, 0
s_cbranch_scc1 MAXPASS
s_endpgm
VE_20:
.section .rodata,"a"
.p2align 6
.amdhsa_kernel standalone__varlen_attn_packed__ragged_kernel
  .amdhsa_next_free_vgpr 512
  .amdhsa_next_free_sgpr 102
  .amdhsa_accum_offset 256
  .amdhsa_group_segment_fixed_size 0
  .amdhsa_kernarg_size 56
  .amdhsa_user_sgpr_count 2
  .amdhsa_user_sgpr_kernarg_segment_ptr 1
  .amdhsa_system_sgpr_workgroup_id_x 1
.end_amdhsa_kernel
```
